```python
import torch

def _softmax(x, axis=-1):
    return torch.softmax(x, dim=axis)
def _gelu(x):
    return torch.nn.functional.gelu(x, approximate="tanh")
def _silu(x):
    return torch.nn.functional.silu(x)
def _sigmoid(x):
    return torch.sigmoid(x)
def _layernorm(x, axis=-1, eps=1e-5):
    m = x.mean(dim=axis, keepdim=True)
    v = x.var(dim=axis, keepdim=True, unbiased=False)
    return (x - m) / torch.sqrt(v + eps)
def _scatter_add(tgt, idx, src, axis=0):
    return tgt.clone().index_add_(axis, idx, src)
def _segment_sum(src, seg, n):
    out = torch.zeros((n,) + src.shape[1:], dtype=src.dtype)
    return out.index_add_(0, seg, src)
def _pad(x, pw):
    flat = tuple(v for pair in reversed(pw) for v in pair)
    return torch.nn.functional.pad(x, flat)

kernel_name = 'concat_heads__mha_block_cached__gqa_block_cached__near_ridge'

def setup_inputs():

    _w = (lambda a: (lambda t: t.to(torch.bfloat16) if t.is_floating_point() else t)(torch.as_tensor(a)))
    def _A_setup():
        B, Sq, D = 8, 96, 640
        H, Sk, Dh = 32, 96, 128
        return {
            "x": _w((lambda *s: torch.randn(*s, dtype=torch.bfloat16) * 0.8)(B, Sq, D)),
            "k_cache": _w((lambda *s: torch.randn(*s, dtype=torch.bfloat16) * 0.8)(B, H, Sk, Dh)),
            "v_cache": _w((lambda *s: torch.randn(*s, dtype=torch.bfloat16) * 0.05)(B, H, Sk, Dh)),
            "wq": _w((lambda *s: torch.randn(*s, dtype=torch.bfloat16) * 0.8)(D, H * Dh) * (D ** -0.5)),
            "wo": _w((lambda *s: torch.randn(*s, dtype=torch.bfloat16) * 0.05)(H * Dh, D) * ((H * Dh) ** -0.5)),
        }
    _A_in = _A_setup()

    def _B_setup():
        B, Sq, D = 8, 96, 640
        Hq, Hkv, Sk, Dh = 32, 32, 96, 128
        assert Hq % Hkv == 0, (Hq, Hkv)
        return {
            "x": _w((lambda *s: torch.randn(*s, dtype=torch.bfloat16) * 0.8)(B, Sq, D)),
            "k_cache": _w((lambda *s: torch.randn(*s, dtype=torch.bfloat16) * 0.8)(B, Hkv, Sk, Dh)),
            "v_cache": _w((lambda *s: torch.randn(*s, dtype=torch.bfloat16) * 0.05)(B, Hkv, Sk, Dh)),
            "wq": _w((lambda *s: torch.randn(*s, dtype=torch.bfloat16) * 0.8)(D, Hq * Dh) * (D ** -0.5)),
            "wo": _w((lambda *s: torch.randn(*s, dtype=torch.bfloat16) * 0.05)(Hq * Dh, D) * ((Hq * Dh) ** -0.5)),
        }
    _B_in = _B_setup()

    return {
        "A_x": _A_in["x"],
        "A_k_cache": _A_in["k_cache"],
        "A_v_cache": _A_in["v_cache"],
        "A_wq": _A_in["wq"],
        "A_wo": _A_in["wo"],
        "B_x": _B_in["x"],
        "B_k_cache": _B_in["k_cache"],
        "B_v_cache": _B_in["v_cache"],
        "B_wq": _B_in["wq"],
        "B_wo": _B_in["wo"],
    }

def reference(A_x, A_k_cache, A_v_cache, A_wq, A_wo, B_x, B_k_cache, B_v_cache, B_wq, B_wo):
    def _A_ref(x, k_cache, v_cache, wq, wo):
        B, Sq, D = x.shape
        H, Dh = 32, 128
        q = (lambda x, *d: x.permute(*d))((x @ wq).reshape(B, Sq, H, Dh), 0, 2, 1, 3)
        scores = torch.einsum("bhqd,bhkd->bhqk", q, k_cache) * (Dh ** -0.5)
        p = _softmax(scores, axis=-1)
        o = torch.einsum("bhqk,bhkd->bhqd", p, v_cache)
        return (lambda x, *d: x.permute(*d))(o, 0, 2, 1, 3).reshape(B, Sq, H * Dh) @ wo

    def _B_ref(x, k_cache, v_cache, wq, wo):
        B, Sq, D = x.shape
        Hq, Dh = 32, 128
        Hkv = k_cache.shape[1]
        rep = Hq // Hkv
        q = (lambda x, *d: x.permute(*d))((x @ wq).reshape(B, Sq, Hq, Dh), 0, 2, 1, 3)
        k = (lambda x, n, axis: torch.repeat_interleave(x, n, dim=axis))(k_cache, rep, axis=1)
        v = (lambda x, n, axis: torch.repeat_interleave(x, n, dim=axis))(v_cache, rep, axis=1)
        scores = torch.einsum("bhqd,bhkd->bhqk", q, k) * (Dh ** -0.5)
        p = _softmax(scores, axis=-1)
        o = torch.einsum("bhqk,bhkd->bhqd", p, v)
        return (lambda x, *d: x.permute(*d))(o, 0, 2, 1, 3).reshape(B, Sq, Hq * Dh) @ wo

    a = _A_ref(A_x, A_k_cache, A_v_cache, A_wq, A_wo)
    b = _B_ref(B_x, B_k_cache, B_v_cache, B_wq, B_wo)
    return torch.concatenate([a, b], axis=-1)
```

```asm
; @launch grid=(256,1,1) block=(512,1,1) lds=163840
.amdgcn_target "amdgcn-amd-amdhsa--gfx950"
.text
.globl concat_heads__mha_block_cached__gqa_block_cached__near_ridge_kernel
.p2align 8
.type concat_heads__mha_block_cached__gqa_block_cached__near_ridge_kernel,@function
concat_heads__mha_block_cached__gqa_block_cached__near_ridge_kernel:
s_cmp_ge_u32 s2, 256
s_cbranch_scc1 L_exit
s_bfe_u32 s3, s2, 0x10001
s_mul_i32 s4, s3, 40
s_add_u32 s14, s0, s4
s_addc_u32 s15, s1, 0
s_load_dwordx8 s[16:23], s[14:15], 0
s_load_dwordx2 s[24:25], s[14:15], 32
s_load_dwordx4 s[36:39], s[0:1], 80
s_load_dwordx2 s[40:41], s[0:1], 96
s_getpc_b64 s[42:43]
L_code_base:
s_lshr_b32 s13, s2, 3
s_lshl_b32 s13, s13, 11
v_lshl_add_u32 v1, v0, 2, s13
v_min_u32 v1, L_code_end-L_code_base-4, v1
global_load_dword v2, v1, s[42:43]
v_lshrrev_b32 v1, 6, v0
s_bfe_u32 s4, s2, 0x10002
s_lshl_b32 s4, s4, 1
s_and_b32 s5, s2, 1
s_or_b32 s4, s4, s5
v_readfirstlane_b32 s8, v1
s_lshr_b32 s5, s2, 5
s_bfe_u32 s6, s2, 0x20003
s_add_u32 s7, s5, s6
s_and_b32 s7, s7, 3
s_lshl_b32 s26, s3, 3
s_add_u32 s26, s26, s5
s_lshl_b32 s26, s26, 14
s_cmp_lt_u32 s8, 4
s_cbranch_scc1 L_compute
s_sub_u32 s9, s8, 4
v_and_b32 v255, 63, v0
s_lshl_b32 s10, s9, 10
s_and_b32 s11, s9, 2
s_add_u32 s11, s11, s9
s_lshl_b32 s12, s4, 3
s_lshl_b32 s13, s6, 1
s_add_u32 s12, s12, s13
v_lshrrev_b32 v254, 4, v255
s_lshl_b32 s13, s9, 2
v_add_u32 v254, s13, v254
v_xor_b32 v253, v254, v255
v_and_b32 v253, 7, v253
v_lshlrev_b32 v253, 4, v253
v_lshrrev_b32 v252, 3, v255
v_mul_u32_u24 v250, 1280, v252
s_mul_i32 s13, s5, 122880
s_mul_i32 s14, s9, 10240
s_add_u32 s13, s13, s14
v_add3_u32 v250, v250, v253, s13
v_lshrrev_b32 v253, 5, v255
s_lshl_b32 s13, s9, 2
v_lshl_add_u32 v251, v253, 1, s13
v_xor_b32 v251, v251, v255
v_and_b32 v251, 31, v251
v_lshlrev_b32 v251, 4, v251
v_lshl_add_u32 v251, v253, 13, v251
s_lshl_b32 s13, s11, 14
s_lshl_b32 s14, s12, 8
s_add_u32 s13, s13, s14
v_add_u32 v251, s13, v251
s_lshl_b32 s11, s11, 10
s_mov_b32 s46, 0xf0000
s_mov_b32 s47, 0x20000
s_mov_b32 s50, 0x500000
s_mov_b32 s51, 0x20000
s_lshl_b32 s81, s6, 1
s_add_u32 s81, s81, s5
s_and_b32 s81, s81, 7
s_lshl_b32 s13, s81, 2
s_lshr_b32 s13, 0x10020001, s13
s_and_b32 s13, s13, 15
s_lshl_b32 s14, s4, 2
s_lshr_b32 s80, 0x7350, s14
s_and_b32 s80, s80, 15
s_add_u32 s13, s13, s80
s_lshl_b32 s78, s13, 7
s_lshl_b32 s79, s13, 19
s_waitcnt lgkmcnt(0)
s_mov_b32 s44, s16
s_mov_b32 s45, s17
s_mov_b32 s48, s22
s_mov_b32 s49, s23
s_add_u32 m0, s10, 0xc000
s_add_u32 s15, s78, 0x0
buffer_load_dwordx4 v250, s[44:47], s15 offen offset:0 lds
s_add_u32 m0, s10, 0xd000
s_add_u32 s15, s78, 0xa000
buffer_load_dwordx4 v250, s[44:47], s15 offen offset:0 lds
s_add_u32 m0, s10, 0xe000
s_add_u32 s15, s78, 0x14000
buffer_load_dwordx4 v250, s[44:47], s15 offen offset:0 lds
s_add_u32 m0, s11, 0x18000
s_add_u32 s15, s79, 0x0
buffer_load_dwordx4 v251, s[48:51], s15 offen offset:0 lds
s_add_u32 m0, s11, 0x18800
s_add_u32 s15, s79, 0x8000
buffer_load_dwordx4 v251, s[48:51], s15 offen offset:0 lds
s_add_u32 m0, s11, 0x1a000
s_add_u32 s15, s79, 0x20000
buffer_load_dwordx4 v251, s[48:51], s15 offen offset:0 lds
s_add_u32 m0, s11, 0x1a800
s_add_u32 s15, s79, 0x28000
buffer_load_dwordx4 v251, s[48:51], s15 offen offset:0 lds
s_mov_b32 s52, s18
s_mov_b32 s53, s19
s_mov_b32 s54, 0x600000
s_mov_b32 s55, 0x20000
s_mov_b32 s56, s20
s_mov_b32 s57, s21
s_mov_b32 s58, 0x600000
s_mov_b32 s59, 0x20000
s_lshl_b32 s13, s5, 5
s_add_u32 s13, s13, s12
s_mul_i32 s13, s13, 24576
v_xor_b32 v253, v254, v255
v_and_b32 v253, 15, v253
v_lshlrev_b32 v253, 4, v253
v_lshl_add_u32 v249, v254, 8, v253
v_add_u32 v249, s13, v249
v_and_b32 v253, 6, v252
v_xor_b32 v253, v253, v255
v_and_b32 v253, 7, v253
v_lshlrev_b32 v253, 4, v253
v_lshl_add_u32 v248, v252, 8, v253
s_lshl_b32 s14, s9, 11
s_add_u32 s13, s13, s14
v_add_u32 v248, s13, v248
v_mul_u32_u24 v252, 1280, v252
v_add_u32 v239, v253, v252
s_mov_b32 s60, s24
s_mov_b32 s61, s25
s_mov_b32 s62, 0x500000
s_mov_b32 s63, 0x20000
s_mov_b32 s72, s40
s_mov_b32 s73, s41
s_mov_b32 s74, 0x10000000
s_mov_b32 s75, 0x20000
s_mov_b32 s68, s38
s_mov_b32 s69, s39
s_mov_b32 s70, 0x100
s_mov_b32 s71, 0x20000
s_mov_b32 s64, s36
s_mov_b32 s65, s37
s_mov_b32 s66, 0x1e0000
s_mov_b32 s67, 0x20000
s_lshr_b32 s90, s26, 10
v_mov_b32 v244, 0
s_mul_i32 s77, s9, 3072
v_lshlrev_b32 v241, 4, v255
v_add_u32 v245, s77, v241
s_lshl_b32 s27, s4, 2
s_mul_i32 s14, s26, 12
s_xor_b32 s13, s6, 0
s_mul_i32 s82, s13, 327680
s_lshl_b32 s28, s13, 7
s_add_u32 s13, s13, s27
s_mul_i32 s13, s13, 12288
s_add_u32 s86, s13, s14
s_xor_b32 s13, s6, 2
s_mul_i32 s83, s13, 327680
s_lshl_b32 s29, s13, 7
s_add_u32 s13, s13, s27
s_mul_i32 s13, s13, 12288
s_add_u32 s87, s13, s14
s_xor_b32 s13, s6, 1
s_mul_i32 s84, s13, 327680
s_lshl_b32 s30, s13, 7
s_add_u32 s13, s13, s27
s_mul_i32 s13, s13, 12288
s_add_u32 s88, s13, s14
s_xor_b32 s13, s6, 3
s_mul_i32 s85, s13, 327680
s_lshl_b32 s31, s13, 7
s_add_u32 s13, s13, s27
s_mul_i32 s13, s13, 12288
s_add_u32 s89, s13, s14
s_add_u32 s13, s27, s9
s_lshl_b32 s13, s13, 9
s_add_u32 s13, s13, s26
s_add_u32 s13, s13, 0x2002000
s_add_u32 s92, s40, s13
s_addc_u32 s93, s41, 0
s_lshl_b32 s13, s4, 7
s_add_u32 s13, s13, s9
s_mul_i32 s13, s13, 10240
s_lshr_b32 s14, s7, 1
s_mul_i32 s14, s14, 640
s_add_u32 s13, s13, s14
s_add_u32 s14, s13, 256
v_add_u32 v238, s14, v239
s_and_b32 s14, s7, 1
s_mul_i32 s14, s14, 384
s_add_u32 s13, s13, s14
v_add_u32 v239, s13, v239
s_lshr_b32 s14, s5, 2
s_mul_i32 s14, s14, 40960
s_sub_u32 s13, 40960, s14
v_add_u32 v237, s13, v239
v_add_u32 v239, s14, v239
v_add_u32 v236, s13, v238
v_add_u32 v238, s14, v238
v_cmp_lt_u32 vcc, 31, v255
v_mov_b32 v253, 0x40000000
s_nop 0
v_cndmask_b32 v240, v241, v253, vcc
v_lshlrev_b32 v254, 7, v255
s_lshl_b32 s13, s4, 3
s_add_u32 s13, s13, s5
s_mul_i32 s13, s13, 163840
s_lshl_b32 s14, s6, 2
s_add_u32 s14, s14, s9
s_mul_i32 s14, s14, 2560
s_add_u32 s13, s13, s14
s_mov_b32 s14, 20
s_add_u32 s94, s24, s13
s_addc_u32 s95, s25, 0
v_cmp_le_u32 vcc, s14, v255
v_add_u32 v254, s13, v254
v_mov_b32 v253, 0x40000000
v_cndmask_b32 v247, v254, v253, vcc
s_add_u32 m0, s11, 0x1c000
s_add_u32 s15, s79, 0x40000
buffer_load_dwordx4 v251, s[48:51], s15 offen offset:0 lds
s_add_u32 m0, s11, 0x1c800
s_add_u32 s15, s79, 0x48000
buffer_load_dwordx4 v251, s[48:51], s15 offen offset:0 lds
s_add_u32 m0, s11, 0x1e000
s_add_u32 s15, s79, 0x60000
buffer_load_dwordx4 v251, s[48:51], s15 offen offset:0 lds
s_add_u32 m0, s11, 0x1e800
s_add_u32 s15, s79, 0x68000
buffer_load_dwordx4 v251, s[48:51], s15 offen offset:0 lds
s_cmp_eq_u32 s81, 1
s_cbranch_scc1 L_var1
s_cmp_eq_u32 s81, 2
s_cbranch_scc1 L_var2
s_cmp_eq_u32 s81, 3
s_cbranch_scc1 L_var3
s_cmp_eq_u32 s81, 4
s_cbranch_scc1 L_var4
s_cmp_eq_u32 s81, 5
s_cbranch_scc1 L_var5
s_cmp_eq_u32 s81, 6
s_cbranch_scc1 L_var6
s_cmp_eq_u32 s81, 7
s_cbranch_scc1 L_var7
L_var0:
s_cmp_ge_u32 s80, 10
s_cselect_b32 s13, -10, 0
s_add_u32 s13, s13, s80
s_lshl_b32 s78, s13, 7
s_lshl_b32 s79, s13, 19
s_add_u32 m0, s10, 0xf000
s_add_u32 s15, s78, 0x0
buffer_load_dwordx4 v250, s[44:47], s15 offen offset:0 lds
s_add_u32 m0, s10, 0x10000
s_add_u32 s15, s78, 0xa000
buffer_load_dwordx4 v250, s[44:47], s15 offen offset:0 lds
s_add_u32 m0, s10, 0x11000
s_add_u32 s15, s78, 0x14000
buffer_load_dwordx4 v250, s[44:47], s15 offen offset:0 lds
s_waitcnt vmcnt(7)
s_barrier
s_add_u32 m0, s11, 0x20000
s_add_u32 s15, s79, 0x0
buffer_load_dwordx4 v251, s[48:51], s15 offen offset:0 lds
s_add_u32 m0, s11, 0x20800
s_add_u32 s15, s79, 0x8000
buffer_load_dwordx4 v251, s[48:51], s15 offen offset:0 lds
s_add_u32 m0, s11, 0x22000
s_add_u32 s15, s79, 0x20000
buffer_load_dwordx4 v251, s[48:51], s15 offen offset:0 lds
s_add_u32 m0, s11, 0x22800
s_add_u32 s15, s79, 0x28000
buffer_load_dwordx4 v251, s[48:51], s15 offen offset:0 lds
s_add_u32 m0, s10, 0x0
s_mov_b32 s15, 0x0
buffer_load_dwordx4 v249, s[52:55], s15 offen offset:0 nt lds
s_add_u32 m0, s10, 0x1000
s_mov_b32 s15, 0x1000
buffer_load_dwordx4 v249, s[52:55], s15 offen offset:0 nt lds
s_add_u32 m0, s10, 0x2000
s_mov_b32 s15, 0x2000
buffer_load_dwordx4 v249, s[52:55], s15 offen offset:0 nt lds
s_waitcnt vmcnt(10)
s_barrier
s_add_u32 m0, s10, 0x3000
s_mov_b32 s15, 0x3000
buffer_load_dwordx4 v249, s[52:55], s15 offen offset:0 nt lds
s_add_u32 m0, s10, 0x4000
s_mov_b32 s15, 0x4000
buffer_load_dwordx4 v249, s[52:55], s15 offen offset:0 nt lds
s_add_u32 m0, s10, 0x5000
s_mov_b32 s15, 0x5000
buffer_load_dwordx4 v249, s[52:55], s15 offen offset:0 nt lds
s_add_u32 m0, s10, 0x6000
s_mov_b32 s15, 0x6000
buffer_load_dwordx4 v249, s[52:55], s15 offen offset:0 nt lds
s_add_u32 m0, s10, 0x7000
s_mov_b32 s15, 0x7000
buffer_load_dwordx4 v249, s[52:55], s15 offen offset:0 nt lds
s_add_u32 m0, s11, 0x24000
s_add_u32 s15, s79, 0x40000
buffer_load_dwordx4 v251, s[48:51], s15 offen offset:0 lds
s_add_u32 m0, s11, 0x24800
s_add_u32 s15, s79, 0x48000
buffer_load_dwordx4 v251, s[48:51], s15 offen offset:0 lds
s_waitcnt vmcnt(10)
s_barrier
s_add_u32 m0, s11, 0x26000
s_add_u32 s15, s79, 0x60000
buffer_load_dwordx4 v251, s[48:51], s15 offen offset:0 lds
s_add_u32 m0, s11, 0x26800
s_add_u32 s15, s79, 0x68000
buffer_load_dwordx4 v251, s[48:51], s15 offen offset:0 lds
s_cmp_ge_u32 s80, 8
s_cselect_b32 s13, -8, 2
s_add_u32 s13, s13, s80
s_lshl_b32 s78, s13, 7
s_lshl_b32 s79, s13, 19
s_add_u32 m0, s10, 0x12000
s_add_u32 s15, s78, 0x0
buffer_load_dwordx4 v250, s[44:47], s15 offen offset:0 lds
s_add_u32 m0, s10, 0x13000
s_add_u32 s15, s78, 0xa000
buffer_load_dwordx4 v250, s[44:47], s15 offen offset:0 lds
s_add_u32 m0, s10, 0x14000
s_add_u32 s15, s78, 0x14000
buffer_load_dwordx4 v250, s[44:47], s15 offen offset:0 lds
s_add_u32 m0, s11, 0x18000
s_add_u32 s15, s79, 0x0
buffer_load_dwordx4 v251, s[48:51], s15 offen offset:0 lds
s_add_u32 m0, s11, 0x18800
s_add_u32 s15, s79, 0x8000
buffer_load_dwordx4 v251, s[48:51], s15 offen offset:0 lds
s_waitcnt vmcnt(5)
s_barrier
s_add_u32 m0, s11, 0x1a000
s_add_u32 s15, s79, 0x20000
buffer_load_dwordx4 v251, s[48:51], s15 offen offset:0 lds
s_add_u32 m0, s11, 0x1a800
s_add_u32 s15, s79, 0x28000
buffer_load_dwordx4 v251, s[48:51], s15 offen offset:0 lds
s_add_u32 m0, s11, 0x1c000
s_add_u32 s15, s79, 0x40000
buffer_load_dwordx4 v251, s[48:51], s15 offen offset:0 lds
s_add_u32 m0, s11, 0x1c800
s_add_u32 s15, s79, 0x48000
buffer_load_dwordx4 v251, s[48:51], s15 offen offset:0 lds
s_add_u32 m0, s11, 0x1e000
s_add_u32 s15, s79, 0x60000
buffer_load_dwordx4 v251, s[48:51], s15 offen offset:0 lds
s_add_u32 m0, s11, 0x1e800
s_add_u32 s15, s79, 0x68000
buffer_load_dwordx4 v251, s[48:51], s15 offen offset:0 lds
s_mov_b32 s15, 0x1e000
buffer_load_dword v246, v247, s[60:63], s15 offen
s_waitcnt vmcnt(5)
s_barrier
s_mov_b32 s15, 0x14000
buffer_load_dword v246, v247, s[60:63], s15 offen
s_cmp_ge_u32 s80, 7
s_cselect_b32 s13, -7, 3
s_add_u32 s13, s13, s80
s_lshl_b32 s78, s13, 7
s_lshl_b32 s79, s13, 19
s_add_u32 m0, s10, 0x15000
s_add_u32 s15, s78, 0x0
buffer_load_dwordx4 v250, s[44:47], s15 offen offset:0 lds
s_add_u32 m0, s10, 0x16000
s_add_u32 s15, s78, 0xa000
buffer_load_dwordx4 v250, s[44:47], s15 offen offset:0 lds
s_add_u32 m0, s10, 0x17000
s_add_u32 s15, s78, 0x14000
buffer_load_dwordx4 v250, s[44:47], s15 offen offset:0 lds
s_add_u32 m0, s11, 0x20000
s_add_u32 s15, s79, 0x0
buffer_load_dwordx4 v251, s[48:51], s15 offen offset:0 lds
s_add_u32 m0, s11, 0x20800
s_add_u32 s15, s79, 0x8000
buffer_load_dwordx4 v251, s[48:51], s15 offen offset:0 lds
s_add_u32 m0, s11, 0x22000
s_add_u32 s15, s79, 0x20000
buffer_load_dwordx4 v251, s[48:51], s15 offen offset:0 lds
s_waitcnt vmcnt(8)
s_barrier
s_add_u32 m0, s11, 0x22800
s_add_u32 s15, s79, 0x28000
buffer_load_dwordx4 v251, s[48:51], s15 offen offset:0 lds
s_add_u32 m0, s11, 0x24000
s_add_u32 s15, s79, 0x40000
buffer_load_dwordx4 v251, s[48:51], s15 offen offset:0 lds
s_add_u32 m0, s11, 0x24800
s_add_u32 s15, s79, 0x48000
buffer_load_dwordx4 v251, s[48:51], s15 offen offset:0 lds
s_add_u32 m0, s11, 0x26000
s_add_u32 s15, s79, 0x60000
buffer_load_dwordx4 v251, s[48:51], s15 offen offset:0 lds
s_add_u32 m0, s11, 0x26800
s_add_u32 s15, s79, 0x68000
buffer_load_dwordx4 v251, s[48:51], s15 offen offset:0 lds
s_cmp_ge_u32 s80, 6
s_cselect_b32 s13, -6, 4
s_add_u32 s13, s13, s80
s_lshl_b32 s78, s13, 7
s_lshl_b32 s79, s13, 19
s_add_u32 m0, s10, 0xc000
s_add_u32 s15, s78, 0x0
buffer_load_dwordx4 v250, s[44:47], s15 offen offset:0 lds
s_add_u32 m0, s10, 0xd000
s_add_u32 s15, s78, 0xa000
buffer_load_dwordx4 v250, s[44:47], s15 offen offset:0 lds
s_waitcnt vmcnt(6)
s_barrier
s_add_u32 m0, s10, 0xe000
s_add_u32 s15, s78, 0x14000
buffer_load_dwordx4 v250, s[44:47], s15 offen offset:0 lds
s_add_u32 m0, s11, 0x18000
s_add_u32 s15, s79, 0x0
buffer_load_dwordx4 v251, s[48:51], s15 offen offset:0 lds
s_add_u32 m0, s11, 0x18800
s_add_u32 s15, s79, 0x8000
buffer_load_dwordx4 v251, s[48:51], s15 offen offset:0 lds
s_add_u32 m0, s11, 0x1a000
s_add_u32 s15, s79, 0x20000
buffer_load_dwordx4 v251, s[48:51], s15 offen offset:0 lds
s_add_u32 m0, s11, 0x1a800
s_add_u32 s15, s79, 0x28000
buffer_load_dwordx4 v251, s[48:51], s15 offen offset:0 lds
s_add_u32 m0, s10, 0x8000
s_mov_b32 s15, 0x8000
buffer_load_dwordx4 v249, s[52:55], s15 offen offset:0 nt lds
s_add_u32 m0, s10, 0x9000
s_mov_b32 s15, 0x9000
buffer_load_dwordx4 v249, s[52:55], s15 offen offset:0 nt lds
s_waitcnt vmcnt(9)
s_barrier
s_add_u32 m0, s10, 0xa000
s_mov_b32 s15, 0xa000
buffer_load_dwordx4 v249, s[52:55], s15 offen offset:0 nt lds
s_add_u32 m0, s10, 0xb000
s_mov_b32 s15, 0xb000
buffer_load_dwordx4 v249, s[52:55], s15 offen offset:0 nt lds
s_add_u32 m0, s11, 0x1c000
s_add_u32 s15, s79, 0x40000
buffer_load_dwordx4 v251, s[48:51], s15 offen offset:0 lds
s_add_u32 m0, s11, 0x1c800
s_add_u32 s15, s79, 0x48000
buffer_load_dwordx4 v251, s[48:51], s15 offen offset:0 lds
s_add_u32 m0, s11, 0x1e000
s_add_u32 s15, s79, 0x60000
buffer_load_dwordx4 v251, s[48:51], s15 offen offset:0 lds
s_add_u32 m0, s11, 0x1e800
s_add_u32 s15, s79, 0x68000
buffer_load_dwordx4 v251, s[48:51], s15 offen offset:0 lds
s_cmp_ge_u32 s80, 5
s_cselect_b32 s13, -5, 5
s_add_u32 s13, s13, s80
s_lshl_b32 s78, s13, 7
s_lshl_b32 s79, s13, 19
s_add_u32 m0, s10, 0x12000
s_add_u32 s15, s78, 0x0
buffer_load_dwordx4 v250, s[44:47], s15 offen offset:0 lds
s_waitcnt vmcnt(9)
s_barrier
s_add_u32 m0, s10, 0x13000
s_add_u32 s15, s78, 0xa000
buffer_load_dwordx4 v250, s[44:47], s15 offen offset:0 lds
s_add_u32 m0, s10, 0x14000
s_add_u32 s15, s78, 0x14000
buffer_load_dwordx4 v250, s[44:47], s15 offen offset:0 lds
s_add_u32 m0, s11, 0x20000
s_add_u32 s15, s79, 0x0
buffer_load_dwordx4 v251, s[48:51], s15 offen offset:0 lds
s_add_u32 m0, s11, 0x20800
s_add_u32 s15, s79, 0x8000
buffer_load_dwordx4 v251, s[48:51], s15 offen offset:0 lds
s_add_u32 m0, s11, 0x22000
s_add_u32 s15, s79, 0x20000
buffer_load_dwordx4 v251, s[48:51], s15 offen offset:0 lds
s_add_u32 m0, s11, 0x22800
s_add_u32 s15, s79, 0x28000
buffer_load_dwordx4 v251, s[48:51], s15 offen offset:0 lds
s_add_u32 m0, s11, 0x24000
s_add_u32 s15, s79, 0x40000
buffer_load_dwordx4 v251, s[48:51], s15 offen offset:0 lds
s_waitcnt vmcnt(8)
s_barrier
s_add_u32 m0, s11, 0x24800
s_add_u32 s15, s79, 0x48000
buffer_load_dwordx4 v251, s[48:51], s15 offen offset:0 lds
s_add_u32 m0, s11, 0x26000
s_add_u32 s15, s79, 0x60000
buffer_load_dwordx4 v251, s[48:51], s15 offen offset:0 lds
s_add_u32 m0, s11, 0x26800
s_add_u32 s15, s79, 0x68000
buffer_load_dwordx4 v251, s[48:51], s15 offen offset:0 lds
s_cmp_ge_u32 s80, 4
s_cselect_b32 s13, -4, 6
s_add_u32 s13, s13, s80
s_lshl_b32 s78, s13, 7
s_lshl_b32 s79, s13, 19
s_add_u32 m0, s10, 0x15000
s_add_u32 s15, s78, 0x0
buffer_load_dwordx4 v250, s[44:47], s15 offen offset:0 lds
s_add_u32 m0, s10, 0x16000
s_add_u32 s15, s78, 0xa000
buffer_load_dwordx4 v250, s[44:47], s15 offen offset:0 lds
s_add_u32 m0, s10, 0x17000
s_add_u32 s15, s78, 0x14000
buffer_load_dwordx4 v250, s[44:47], s15 offen offset:0 lds
s_add_u32 m0, s11, 0x18000
s_add_u32 s15, s79, 0x0
buffer_load_dwordx4 v251, s[48:51], s15 offen offset:0 lds
s_waitcnt vmcnt(8)
s_barrier
s_add_u32 m0, s11, 0x18800
s_add_u32 s15, s79, 0x8000
buffer_load_dwordx4 v251, s[48:51], s15 offen offset:0 lds
s_add_u32 m0, s11, 0x1a000
s_add_u32 s15, s79, 0x20000
buffer_load_dwordx4 v251, s[48:51], s15 offen offset:0 lds
s_add_u32 m0, s11, 0x1a800
s_add_u32 s15, s79, 0x28000
buffer_load_dwordx4 v251, s[48:51], s15 offen offset:0 lds
s_add_u32 m0, s11, 0x1c000
s_add_u32 s15, s79, 0x40000
buffer_load_dwordx4 v251, s[48:51], s15 offen offset:0 lds
s_add_u32 m0, s11, 0x1c800
s_add_u32 s15, s79, 0x48000
buffer_load_dwordx4 v251, s[48:51], s15 offen offset:0 lds
s_add_u32 m0, s11, 0x1e000
s_add_u32 s15, s79, 0x60000
buffer_load_dwordx4 v251, s[48:51], s15 offen offset:0 lds
s_add_u32 m0, s11, 0x1e800
s_add_u32 s15, s79, 0x68000
buffer_load_dwordx4 v251, s[48:51], s15 offen offset:0 lds
s_waitcnt vmcnt(11)
s_barrier
s_cmp_ge_u32 s80, 1
s_cselect_b32 s13, -1, 9
s_add_u32 s13, s13, s80
s_lshl_b32 s78, s13, 7
s_lshl_b32 s79, s13, 19
s_add_u32 m0, s10, 0xf000
s_add_u32 s15, s78, 0x0
buffer_load_dwordx4 v250, s[44:47], s15 offen offset:0 lds
s_add_u32 m0, s10, 0x10000
s_add_u32 s15, s78, 0xa000
buffer_load_dwordx4 v250, s[44:47], s15 offen offset:0 lds
s_add_u32 m0, s10, 0x11000
s_add_u32 s15, s78, 0x14000
buffer_load_dwordx4 v250, s[44:47], s15 offen offset:0 lds
s_add_u32 m0, s11, 0x20000
s_add_u32 s15, s79, 0x0
buffer_load_dwordx4 v251, s[48:51], s15 offen offset:0 lds
s_add_u32 m0, s11, 0x20800
s_add_u32 s15, s79, 0x8000
buffer_load_dwordx4 v251, s[48:51], s15 offen offset:0 lds
s_add_u32 m0, s11, 0x22000
s_add_u32 s15, s79, 0x20000
buffer_load_dwordx4 v251, s[48:51], s15 offen offset:0 lds
s_add_u32 m0, s11, 0x22800
s_add_u32 s15, s79, 0x28000
buffer_load_dwordx4 v251, s[48:51], s15 offen offset:0 lds
s_waitcnt vmcnt(11)
s_barrier
s_add_u32 m0, s11, 0x24000
s_add_u32 s15, s79, 0x40000
buffer_load_dwordx4 v251, s[48:51], s15 offen offset:0 lds
s_add_u32 m0, s11, 0x24800
s_add_u32 s15, s79, 0x48000
buffer_load_dwordx4 v251, s[48:51], s15 offen offset:0 lds
s_add_u32 m0, s11, 0x26000
s_add_u32 s15, s79, 0x60000
buffer_load_dwordx4 v251, s[48:51], s15 offen offset:0 lds
s_add_u32 m0, s11, 0x26800
s_add_u32 s15, s79, 0x68000
buffer_load_dwordx4 v251, s[48:51], s15 offen offset:0 lds
s_cmp_ge_u32 s80, 3
s_cselect_b32 s13, -3, 7
s_add_u32 s13, s13, s80
s_lshl_b32 s78, s13, 7
s_lshl_b32 s79, s13, 19
s_add_u32 m0, s10, 0xc000
s_add_u32 s15, s78, 0x0
buffer_load_dwordx4 v250, s[44:47], s15 offen offset:0 lds
s_add_u32 m0, s10, 0xd000
s_add_u32 s15, s78, 0xa000
buffer_load_dwordx4 v250, s[44:47], s15 offen offset:0 lds
s_add_u32 m0, s10, 0xe000
s_add_u32 s15, s78, 0x14000
buffer_load_dwordx4 v250, s[44:47], s15 offen offset:0 lds
s_waitcnt vmcnt(14)
s_barrier
s_add_u32 m0, s11, 0x18000
s_add_u32 s15, s79, 0x0
buffer_load_dwordx4 v251, s[48:51], s15 offen offset:0 lds
s_add_u32 m0, s11, 0x18800
s_add_u32 s15, s79, 0x8000
buffer_load_dwordx4 v251, s[48:51], s15 offen offset:0 lds
s_add_u32 m0, s11, 0x1a000
s_add_u32 s15, s79, 0x20000
buffer_load_dwordx4 v251, s[48:51], s15 offen offset:0 lds
s_add_u32 m0, s11, 0x1a800
s_add_u32 s15, s79, 0x28000
buffer_load_dwordx4 v251, s[48:51], s15 offen offset:0 lds
s_add_u32 m0, s10, 0x12000
s_mov_b32 s15, 0x0
buffer_load_dwordx4 v248, s[56:59], s15 offen offset:0 nt lds
s_add_u32 m0, s10, 0x13000
s_mov_b32 s15, 0x2000
buffer_load_dwordx4 v248, s[56:59], s15 offen offset:0 nt lds
s_add_u32 m0, s10, 0x14000
s_mov_b32 s15, 0x4000
buffer_load_dwordx4 v248, s[56:59], s15 offen offset:0 nt lds
s_waitcnt vmcnt(14)
s_barrier
s_add_u32 m0, s10, 0x15000
s_mov_b32 s15, 0x6000
buffer_load_dwordx4 v248, s[56:59], s15 offen offset:0 nt lds
s_add_u32 m0, s10, 0x16000
s_mov_b32 s15, 0x8000
buffer_load_dwordx4 v248, s[56:59], s15 offen offset:0 nt lds
s_add_u32 m0, s10, 0x17000
s_mov_b32 s15, 0xa000
buffer_load_dwordx4 v248, s[56:59], s15 offen offset:0 nt lds
s_add_u32 m0, s11, 0x1c000
s_add_u32 s15, s79, 0x40000
buffer_load_dwordx4 v251, s[48:51], s15 offen offset:0 lds
s_add_u32 m0, s11, 0x1c800
s_add_u32 s15, s79, 0x48000
buffer_load_dwordx4 v251, s[48:51], s15 offen offset:0 lds
s_add_u32 m0, s11, 0x1e000
s_add_u32 s15, s79, 0x60000
buffer_load_dwordx4 v251, s[48:51], s15 offen offset:0 lds
s_add_u32 m0, s11, 0x1e800
s_add_u32 s15, s79, 0x68000
buffer_load_dwordx4 v251, s[48:51], s15 offen offset:0 lds
s_waitcnt vmcnt(17)
s_barrier
s_waitcnt vmcnt(10)
s_barrier
s_cmp_ge_u32 s80, 2
s_cselect_b32 s13, -2, 8
s_add_u32 s13, s13, s80
s_lshl_b32 s78, s13, 7
s_lshl_b32 s79, s13, 19
s_add_u32 m0, s10, 0xf000
s_add_u32 s15, s78, 0x0
buffer_load_dwordx4 v250, s[44:47], s15 offen offset:0 lds
s_add_u32 m0, s10, 0x10000
s_add_u32 s15, s78, 0xa000
buffer_load_dwordx4 v250, s[44:47], s15 offen offset:0 lds
s_add_u32 m0, s10, 0x11000
s_add_u32 s15, s78, 0x14000
buffer_load_dwordx4 v250, s[44:47], s15 offen offset:0 lds
s_add_u32 m0, s11, 0x20000
s_add_u32 s15, s79, 0x0
buffer_load_dwordx4 v251, s[48:51], s15 offen offset:0 lds
s_add_u32 m0, s11, 0x20800
s_add_u32 s15, s79, 0x8000
buffer_load_dwordx4 v251, s[48:51], s15 offen offset:0 lds
s_add_u32 m0, s11, 0x22000
s_add_u32 s15, s79, 0x20000
buffer_load_dwordx4 v251, s[48:51], s15 offen offset:0 lds
s_add_u32 m0, s11, 0x22800
s_add_u32 s15, s79, 0x28000
buffer_load_dwordx4 v251, s[48:51], s15 offen offset:0 lds
s_add_u32 m0, s11, 0x24000
s_add_u32 s15, s79, 0x40000
buffer_load_dwordx4 v251, s[48:51], s15 offen offset:0 lds
s_add_u32 m0, s11, 0x24800
s_add_u32 s15, s79, 0x48000
buffer_load_dwordx4 v251, s[48:51], s15 offen offset:0 lds
s_add_u32 m0, s11, 0x26000
s_add_u32 s15, s79, 0x60000
buffer_load_dwordx4 v251, s[48:51], s15 offen offset:0 lds
s_add_u32 m0, s11, 0x26800
s_add_u32 s15, s79, 0x68000
buffer_load_dwordx4 v251, s[48:51], s15 offen offset:0 lds
s_waitcnt vmcnt(11)
s_branch L_join
L_var1:
s_cmp_ge_u32 s80, 7
s_cselect_b32 s13, -7, 3
s_add_u32 s13, s13, s80
s_lshl_b32 s78, s13, 7
s_lshl_b32 s79, s13, 19
s_add_u32 m0, s10, 0xf000
s_add_u32 s15, s78, 0x0
buffer_load_dwordx4 v250, s[44:47], s15 offen offset:0 lds
s_add_u32 m0, s10, 0x10000
s_add_u32 s15, s78, 0xa000
buffer_load_dwordx4 v250, s[44:47], s15 offen offset:0 lds
s_add_u32 m0, s10, 0x11000
s_add_u32 s15, s78, 0x14000
buffer_load_dwordx4 v250, s[44:47], s15 offen offset:0 lds
s_waitcnt vmcnt(7)
s_barrier
s_add_u32 m0, s11, 0x20000
s_add_u32 s15, s79, 0x0
buffer_load_dwordx4 v251, s[48:51], s15 offen offset:0 lds
s_add_u32 m0, s11, 0x20800
s_add_u32 s15, s79, 0x8000
buffer_load_dwordx4 v251, s[48:51], s15 offen offset:0 lds
s_add_u32 m0, s11, 0x22000
s_add_u32 s15, s79, 0x20000
buffer_load_dwordx4 v251, s[48:51], s15 offen offset:0 lds
s_add_u32 m0, s11, 0x22800
s_add_u32 s15, s79, 0x28000
buffer_load_dwordx4 v251, s[48:51], s15 offen offset:0 lds
s_add_u32 m0, s11, 0x24000
s_add_u32 s15, s79, 0x40000
buffer_load_dwordx4 v251, s[48:51], s15 offen offset:0 lds
s_add_u32 m0, s11, 0x24800
s_add_u32 s15, s79, 0x48000
buffer_load_dwordx4 v251, s[48:51], s15 offen offset:0 lds
s_add_u32 m0, s11, 0x26000
s_add_u32 s15, s79, 0x60000
buffer_load_dwordx4 v251, s[48:51], s15 offen offset:0 lds
s_waitcnt vmcnt(10)
s_barrier
s_add_u32 m0, s11, 0x26800
s_add_u32 s15, s79, 0x68000
buffer_load_dwordx4 v251, s[48:51], s15 offen offset:0 lds
s_cmp_ge_u32 s80, 9
s_cselect_b32 s13, -9, 1
s_add_u32 s13, s13, s80
s_lshl_b32 s78, s13, 7
s_lshl_b32 s79, s13, 19
s_add_u32 m0, s10, 0x12000
s_add_u32 s15, s78, 0x0
buffer_load_dwordx4 v250, s[44:47], s15 offen offset:0 lds
s_add_u32 m0, s10, 0x13000
s_add_u32 s15, s78, 0xa000
buffer_load_dwordx4 v250, s[44:47], s15 offen offset:0 lds
s_add_u32 m0, s10, 0x14000
s_add_u32 s15, s78, 0x14000
buffer_load_dwordx4 v250, s[44:47], s15 offen offset:0 lds
s_add_u32 m0, s11, 0x18000
s_add_u32 s15, s79, 0x0
buffer_load_dwordx4 v251, s[48:51], s15 offen offset:0 lds
s_add_u32 m0, s11, 0x18800
s_add_u32 s15, s79, 0x8000
buffer_load_dwordx4 v251, s[48:51], s15 offen offset:0 lds
s_add_u32 m0, s11, 0x1a000
s_add_u32 s15, s79, 0x20000
buffer_load_dwordx4 v251, s[48:51], s15 offen offset:0 lds
s_waitcnt vmcnt(10)
s_barrier
s_add_u32 m0, s11, 0x1a800
s_add_u32 s15, s79, 0x28000
buffer_load_dwordx4 v251, s[48:51], s15 offen offset:0 lds
s_add_u32 m0, s10, 0x0
s_mov_b32 s15, 0x0
buffer_load_dwordx4 v249, s[52:55], s15 offen offset:0 nt lds
s_add_u32 m0, s10, 0x1000
s_mov_b32 s15, 0x1000
buffer_load_dwordx4 v249, s[52:55], s15 offen offset:0 nt lds
s_add_u32 m0, s10, 0x2000
s_mov_b32 s15, 0x2000
buffer_load_dwordx4 v249, s[52:55], s15 offen offset:0 nt lds
s_add_u32 m0, s10, 0x3000
s_mov_b32 s15, 0x3000
buffer_load_dwordx4 v249, s[52:55], s15 offen offset:0 nt lds
s_add_u32 m0, s10, 0x4000
s_mov_b32 s15, 0x4000
buffer_load_dwordx4 v249, s[52:55], s15 offen offset:0 nt lds
s_add_u32 m0, s10, 0x5000
s_mov_b32 s15, 0x5000
buffer_load_dwordx4 v249, s[52:55], s15 offen offset:0 nt lds
s_waitcnt vmcnt(13)
s_barrier
s_add_u32 m0, s10, 0x6000
s_mov_b32 s15, 0x6000
buffer_load_dwordx4 v249, s[52:55], s15 offen offset:0 nt lds
s_add_u32 m0, s10, 0x7000
s_mov_b32 s15, 0x7000
buffer_load_dwordx4 v249, s[52:55], s15 offen offset:0 nt lds
s_add_u32 m0, s11, 0x1c000
s_add_u32 s15, s79, 0x40000
buffer_load_dwordx4 v251, s[48:51], s15 offen offset:0 lds
s_add_u32 m0, s11, 0x1c800
s_add_u32 s15, s79, 0x48000
buffer_load_dwordx4 v251, s[48:51], s15 offen offset:0 lds
s_add_u32 m0, s11, 0x1e000
s_add_u32 s15, s79, 0x60000
buffer_load_dwordx4 v251, s[48:51], s15 offen offset:0 lds
s_add_u32 m0, s11, 0x1e800
s_add_u32 s15, s79, 0x68000
buffer_load_dwordx4 v251, s[48:51], s15 offen offset:0 lds
s_cmp_ge_u32 s80, 8
s_cselect_b32 s13, -8, 2
s_add_u32 s13, s13, s80
s_lshl_b32 s78, s13, 7
s_lshl_b32 s79, s13, 19
s_add_u32 m0, s10, 0x15000
s_add_u32 s15, s78, 0x0
buffer_load_dwordx4 v250, s[44:47], s15 offen offset:0 lds
s_waitcnt vmcnt(13)
s_barrier
s_add_u32 m0, s10, 0x16000
s_add_u32 s15, s78, 0xa000
buffer_load_dwordx4 v250, s[44:47], s15 offen offset:0 lds
s_add_u32 m0, s10, 0x17000
s_add_u32 s15, s78, 0x14000
buffer_load_dwordx4 v250, s[44:47], s15 offen offset:0 lds
s_add_u32 m0, s11, 0x20000
s_add_u32 s15, s79, 0x0
buffer_load_dwordx4 v251, s[48:51], s15 offen offset:0 lds
s_add_u32 m0, s11, 0x20800
s_add_u32 s15, s79, 0x8000
buffer_load_dwordx4 v251, s[48:51], s15 offen offset:0 lds
s_add_u32 m0, s11, 0x22000
s_add_u32 s15, s79, 0x20000
buffer_load_dwordx4 v251, s[48:51], s15 offen offset:0 lds
s_add_u32 m0, s11, 0x22800
s_add_u32 s15, s79, 0x28000
buffer_load_dwordx4 v251, s[48:51], s15 offen offset:0 lds
s_add_u32 m0, s11, 0x24000
s_add_u32 s15, s79, 0x40000
buffer_load_dwordx4 v251, s[48:51], s15 offen offset:0 lds
s_waitcnt vmcnt(8)
s_barrier
s_add_u32 m0, s11, 0x24800
s_add_u32 s15, s79, 0x48000
buffer_load_dwordx4 v251, s[48:51], s15 offen offset:0 lds
s_add_u32 m0, s11, 0x26000
s_add_u32 s15, s79, 0x60000
buffer_load_dwordx4 v251, s[48:51], s15 offen offset:0 lds
s_add_u32 m0, s11, 0x26800
s_add_u32 s15, s79, 0x68000
buffer_load_dwordx4 v251, s[48:51], s15 offen offset:0 lds
s_mov_b32 s15, 0x1e000
buffer_load_dword v246, v247, s[60:63], s15 offen
s_mov_b32 s15, 0x14000
buffer_load_dword v246, v247, s[60:63], s15 offen
s_cmp_ge_u32 s80, 6
s_cselect_b32 s13, -6, 4
s_add_u32 s13, s13, s80
s_lshl_b32 s78, s13, 7
s_lshl_b32 s79, s13, 19
s_add_u32 m0, s10, 0xc000
s_add_u32 s15, s78, 0x0
buffer_load_dwordx4 v250, s[44:47], s15 offen offset:0 lds
s_add_u32 m0, s10, 0xd000
s_add_u32 s15, s78, 0xa000
buffer_load_dwordx4 v250, s[44:47], s15 offen offset:0 lds
s_waitcnt vmcnt(8)
s_barrier
s_add_u32 m0, s10, 0xe000
s_add_u32 s15, s78, 0x14000
buffer_load_dwordx4 v250, s[44:47], s15 offen offset:0 lds
s_add_u32 m0, s11, 0x18000
s_add_u32 s15, s79, 0x0
buffer_load_dwordx4 v251, s[48:51], s15 offen offset:0 lds
s_add_u32 m0, s11, 0x18800
s_add_u32 s15, s79, 0x8000
buffer_load_dwordx4 v251, s[48:51], s15 offen offset:0 lds
s_add_u32 m0, s11, 0x1a000
s_add_u32 s15, s79, 0x20000
buffer_load_dwordx4 v251, s[48:51], s15 offen offset:0 lds
s_add_u32 m0, s11, 0x1a800
s_add_u32 s15, s79, 0x28000
buffer_load_dwordx4 v251, s[48:51], s15 offen offset:0 lds
s_add_u32 m0, s11, 0x1c000
s_add_u32 s15, s79, 0x40000
buffer_load_dwordx4 v251, s[48:51], s15 offen offset:0 lds
s_add_u32 m0, s11, 0x1c800
s_add_u32 s15, s79, 0x48000
buffer_load_dwordx4 v251, s[48:51], s15 offen offset:0 lds
s_waitcnt vmcnt(11)
s_barrier
s_add_u32 m0, s11, 0x1e000
s_add_u32 s15, s79, 0x60000
buffer_load_dwordx4 v251, s[48:51], s15 offen offset:0 lds
s_add_u32 m0, s11, 0x1e800
s_add_u32 s15, s79, 0x68000
buffer_load_dwordx4 v251, s[48:51], s15 offen offset:0 lds
s_cmp_ge_u32 s80, 5
s_cselect_b32 s13, -5, 5
s_add_u32 s13, s13, s80
s_lshl_b32 s78, s13, 7
s_lshl_b32 s79, s13, 19
s_add_u32 m0, s10, 0x12000
s_add_u32 s15, s78, 0x0
buffer_load_dwordx4 v250, s[44:47], s15 offen offset:0 lds
s_add_u32 m0, s10, 0x13000
s_add_u32 s15, s78, 0xa000
buffer_load_dwordx4 v250, s[44:47], s15 offen offset:0 lds
s_add_u32 m0, s10, 0x14000
s_add_u32 s15, s78, 0x14000
buffer_load_dwordx4 v250, s[44:47], s15 offen offset:0 lds
s_add_u32 m0, s11, 0x20000
s_add_u32 s15, s79, 0x0
buffer_load_dwordx4 v251, s[48:51], s15 offen offset:0 lds
s_add_u32 m0, s11, 0x20800
s_add_u32 s15, s79, 0x8000
buffer_load_dwordx4 v251, s[48:51], s15 offen offset:0 lds
s_waitcnt vmcnt(9)
s_barrier
s_add_u32 m0, s11, 0x22000
s_add_u32 s15, s79, 0x20000
buffer_load_dwordx4 v251, s[48:51], s15 offen offset:0 lds
s_add_u32 m0, s11, 0x22800
s_add_u32 s15, s79, 0x28000
buffer_load_dwordx4 v251, s[48:51], s15 offen offset:0 lds
s_add_u32 m0, s10, 0x8000
s_mov_b32 s15, 0x8000
buffer_load_dwordx4 v249, s[52:55], s15 offen offset:0 nt lds
s_add_u32 m0, s10, 0x9000
s_mov_b32 s15, 0x9000
buffer_load_dwordx4 v249, s[52:55], s15 offen offset:0 nt lds
s_add_u32 m0, s10, 0xa000
s_mov_b32 s15, 0xa000
buffer_load_dwordx4 v249, s[52:55], s15 offen offset:0 nt lds
s_add_u32 m0, s10, 0xb000
s_mov_b32 s15, 0xb000
buffer_load_dwordx4 v249, s[52:55], s15 offen offset:0 nt lds
s_add_u32 m0, s11, 0x24000
s_add_u32 s15, s79, 0x40000
buffer_load_dwordx4 v251, s[48:51], s15 offen offset:0 lds
s_waitcnt vmcnt(12)
s_barrier
s_add_u32 m0, s11, 0x24800
s_add_u32 s15, s79, 0x48000
buffer_load_dwordx4 v251, s[48:51], s15 offen offset:0 lds
s_add_u32 m0, s11, 0x26000
s_add_u32 s15, s79, 0x60000
buffer_load_dwordx4 v251, s[48:51], s15 offen offset:0 lds
s_add_u32 m0, s11, 0x26800
s_add_u32 s15, s79, 0x68000
buffer_load_dwordx4 v251, s[48:51], s15 offen offset:0 lds
s_cmp_ge_u32 s80, 4
s_cselect_b32 s13, -4, 6
s_add_u32 s13, s13, s80
s_lshl_b32 s78, s13, 7
s_lshl_b32 s79, s13, 19
s_add_u32 m0, s10, 0x15000
s_add_u32 s15, s78, 0x0
buffer_load_dwordx4 v250, s[44:47], s15 offen offset:0 lds
s_add_u32 m0, s10, 0x16000
s_add_u32 s15, s78, 0xa000
buffer_load_dwordx4 v250, s[44:47], s15 offen offset:0 lds
s_add_u32 m0, s10, 0x17000
s_add_u32 s15, s78, 0x14000
buffer_load_dwordx4 v250, s[44:47], s15 offen offset:0 lds
s_add_u32 m0, s11, 0x18000
s_add_u32 s15, s79, 0x0
buffer_load_dwordx4 v251, s[48:51], s15 offen offset:0 lds
s_waitcnt vmcnt(12)
s_barrier
s_add_u32 m0, s11, 0x18800
s_add_u32 s15, s79, 0x8000
buffer_load_dwordx4 v251, s[48:51], s15 offen offset:0 lds
s_add_u32 m0, s11, 0x1a000
s_add_u32 s15, s79, 0x20000
buffer_load_dwordx4 v251, s[48:51], s15 offen offset:0 lds
s_add_u32 m0, s11, 0x1a800
s_add_u32 s15, s79, 0x28000
buffer_load_dwordx4 v251, s[48:51], s15 offen offset:0 lds
s_add_u32 m0, s11, 0x1c000
s_add_u32 s15, s79, 0x40000
buffer_load_dwordx4 v251, s[48:51], s15 offen offset:0 lds
s_add_u32 m0, s11, 0x1c800
s_add_u32 s15, s79, 0x48000
buffer_load_dwordx4 v251, s[48:51], s15 offen offset:0 lds
s_add_u32 m0, s11, 0x1e000
s_add_u32 s15, s79, 0x60000
buffer_load_dwordx4 v251, s[48:51], s15 offen offset:0 lds
s_add_u32 m0, s11, 0x1e800
s_add_u32 s15, s79, 0x68000
buffer_load_dwordx4 v251, s[48:51], s15 offen offset:0 lds
s_waitcnt vmcnt(11)
s_barrier
s_cmp_ge_u32 s80, 3
s_cselect_b32 s13, -3, 7
s_add_u32 s13, s13, s80
s_lshl_b32 s78, s13, 7
s_lshl_b32 s79, s13, 19
s_add_u32 m0, s10, 0xf000
s_add_u32 s15, s78, 0x0
buffer_load_dwordx4 v250, s[44:47], s15 offen offset:0 lds
s_add_u32 m0, s10, 0x10000
s_add_u32 s15, s78, 0xa000
buffer_load_dwordx4 v250, s[44:47], s15 offen offset:0 lds
s_add_u32 m0, s10, 0x11000
s_add_u32 s15, s78, 0x14000
buffer_load_dwordx4 v250, s[44:47], s15 offen offset:0 lds
s_add_u32 m0, s11, 0x20000
s_add_u32 s15, s79, 0x0
buffer_load_dwordx4 v251, s[48:51], s15 offen offset:0 lds
s_add_u32 m0, s11, 0x20800
s_add_u32 s15, s79, 0x8000
buffer_load_dwordx4 v251, s[48:51], s15 offen offset:0 lds
s_add_u32 m0, s11, 0x22000
s_add_u32 s15, s79, 0x20000
buffer_load_dwordx4 v251, s[48:51], s15 offen offset:0 lds
s_add_u32 m0, s11, 0x22800
s_add_u32 s15, s79, 0x28000
buffer_load_dwordx4 v251, s[48:51], s15 offen offset:0 lds
s_waitcnt vmcnt(11)
s_barrier
s_add_u32 m0, s11, 0x24000
s_add_u32 s15, s79, 0x40000
buffer_load_dwordx4 v251, s[48:51], s15 offen offset:0 lds
s_add_u32 m0, s11, 0x24800
s_add_u32 s15, s79, 0x48000
buffer_load_dwordx4 v251, s[48:51], s15 offen offset:0 lds
s_add_u32 m0, s11, 0x26000
s_add_u32 s15, s79, 0x60000
buffer_load_dwordx4 v251, s[48:51], s15 offen offset:0 lds
s_add_u32 m0, s11, 0x26800
s_add_u32 s15, s79, 0x68000
buffer_load_dwordx4 v251, s[48:51], s15 offen offset:0 lds
s_cmp_ge_u32 s80, 2
s_cselect_b32 s13, -2, 8
s_add_u32 s13, s13, s80
s_lshl_b32 s78, s13, 7
s_lshl_b32 s79, s13, 19
s_add_u32 m0, s10, 0xc000
s_add_u32 s15, s78, 0x0
buffer_load_dwordx4 v250, s[44:47], s15 offen offset:0 lds
s_add_u32 m0, s10, 0xd000
s_add_u32 s15, s78, 0xa000
buffer_load_dwordx4 v250, s[44:47], s15 offen offset:0 lds
s_add_u32 m0, s10, 0xe000
s_add_u32 s15, s78, 0x14000
buffer_load_dwordx4 v250, s[44:47], s15 offen offset:0 lds
s_waitcnt vmcnt(14)
s_barrier
s_add_u32 m0, s11, 0x18000
s_add_u32 s15, s79, 0x0
buffer_load_dwordx4 v251, s[48:51], s15 offen offset:0 lds
s_add_u32 m0, s11, 0x18800
s_add_u32 s15, s79, 0x8000
buffer_load_dwordx4 v251, s[48:51], s15 offen offset:0 lds
s_add_u32 m0, s11, 0x1a000
s_add_u32 s15, s79, 0x20000
buffer_load_dwordx4 v251, s[48:51], s15 offen offset:0 lds
s_add_u32 m0, s11, 0x1a800
s_add_u32 s15, s79, 0x28000
buffer_load_dwordx4 v251, s[48:51], s15 offen offset:0 lds
s_add_u32 m0, s10, 0x12000
s_mov_b32 s15, 0x0
buffer_load_dwordx4 v248, s[56:59], s15 offen offset:0 nt lds
s_add_u32 m0, s10, 0x13000
s_mov_b32 s15, 0x2000
buffer_load_dwordx4 v248, s[56:59], s15 offen offset:0 nt lds
s_add_u32 m0, s10, 0x14000
s_mov_b32 s15, 0x4000
buffer_load_dwordx4 v248, s[56:59], s15 offen offset:0 nt lds
s_waitcnt vmcnt(14)
s_barrier
s_add_u32 m0, s10, 0x15000
s_mov_b32 s15, 0x6000
buffer_load_dwordx4 v248, s[56:59], s15 offen offset:0 nt lds
s_add_u32 m0, s10, 0x16000
s_mov_b32 s15, 0x8000
buffer_load_dwordx4 v248, s[56:59], s15 offen offset:0 nt lds
s_add_u32 m0, s10, 0x17000
s_mov_b32 s15, 0xa000
buffer_load_dwordx4 v248, s[56:59], s15 offen offset:0 nt lds
s_add_u32 m0, s11, 0x1c000
s_add_u32 s15, s79, 0x40000
buffer_load_dwordx4 v251, s[48:51], s15 offen offset:0 lds
s_add_u32 m0, s11, 0x1c800
s_add_u32 s15, s79, 0x48000
buffer_load_dwordx4 v251, s[48:51], s15 offen offset:0 lds
s_add_u32 m0, s11, 0x1e000
s_add_u32 s15, s79, 0x60000
buffer_load_dwordx4 v251, s[48:51], s15 offen offset:0 lds
s_add_u32 m0, s11, 0x1e800
s_add_u32 s15, s79, 0x68000
buffer_load_dwordx4 v251, s[48:51], s15 offen offset:0 lds
s_waitcnt vmcnt(17)
s_barrier
s_waitcnt vmcnt(10)
s_barrier
s_cmp_ge_u32 s80, 1
s_cselect_b32 s13, -1, 9
s_add_u32 s13, s13, s80
s_lshl_b32 s78, s13, 7
s_lshl_b32 s79, s13, 19
s_add_u32 m0, s10, 0xf000
s_add_u32 s15, s78, 0x0
buffer_load_dwordx4 v250, s[44:47], s15 offen offset:0 lds
s_add_u32 m0, s10, 0x10000
s_add_u32 s15, s78, 0xa000
buffer_load_dwordx4 v250, s[44:47], s15 offen offset:0 lds
s_add_u32 m0, s10, 0x11000
s_add_u32 s15, s78, 0x14000
buffer_load_dwordx4 v250, s[44:47], s15 offen offset:0 lds
s_add_u32 m0, s11, 0x20000
s_add_u32 s15, s79, 0x0
buffer_load_dwordx4 v251, s[48:51], s15 offen offset:0 lds
s_add_u32 m0, s11, 0x20800
s_add_u32 s15, s79, 0x8000
buffer_load_dwordx4 v251, s[48:51], s15 offen offset:0 lds
s_add_u32 m0, s11, 0x22000
s_add_u32 s15, s79, 0x20000
buffer_load_dwordx4 v251, s[48:51], s15 offen offset:0 lds
s_add_u32 m0, s11, 0x22800
s_add_u32 s15, s79, 0x28000
buffer_load_dwordx4 v251, s[48:51], s15 offen offset:0 lds
s_add_u32 m0, s11, 0x24000
s_add_u32 s15, s79, 0x40000
buffer_load_dwordx4 v251, s[48:51], s15 offen offset:0 lds
s_add_u32 m0, s11, 0x24800
s_add_u32 s15, s79, 0x48000
buffer_load_dwordx4 v251, s[48:51], s15 offen offset:0 lds
s_add_u32 m0, s11, 0x26000
s_add_u32 s15, s79, 0x60000
buffer_load_dwordx4 v251, s[48:51], s15 offen offset:0 lds
s_add_u32 m0, s11, 0x26800
s_add_u32 s15, s79, 0x68000
buffer_load_dwordx4 v251, s[48:51], s15 offen offset:0 lds
s_waitcnt vmcnt(11)
s_branch L_join
L_var2:
s_cmp_ge_u32 s80, 9
s_cselect_b32 s13, -9, 1
s_add_u32 s13, s13, s80
s_lshl_b32 s78, s13, 7
s_lshl_b32 s79, s13, 19
s_add_u32 m0, s10, 0xf000
s_add_u32 s15, s78, 0x0
buffer_load_dwordx4 v250, s[44:47], s15 offen offset:0 lds
s_add_u32 m0, s10, 0x10000
s_add_u32 s15, s78, 0xa000
buffer_load_dwordx4 v250, s[44:47], s15 offen offset:0 lds
s_add_u32 m0, s10, 0x11000
s_add_u32 s15, s78, 0x14000
buffer_load_dwordx4 v250, s[44:47], s15 offen offset:0 lds
s_waitcnt vmcnt(7)
s_barrier
s_add_u32 m0, s11, 0x20000
s_add_u32 s15, s79, 0x0
buffer_load_dwordx4 v251, s[48:51], s15 offen offset:0 lds
s_add_u32 m0, s11, 0x20800
s_add_u32 s15, s79, 0x8000
buffer_load_dwordx4 v251, s[48:51], s15 offen offset:0 lds
s_add_u32 m0, s11, 0x22000
s_add_u32 s15, s79, 0x20000
buffer_load_dwordx4 v251, s[48:51], s15 offen offset:0 lds
s_add_u32 m0, s11, 0x22800
s_add_u32 s15, s79, 0x28000
buffer_load_dwordx4 v251, s[48:51], s15 offen offset:0 lds
s_add_u32 m0, s10, 0x0
s_mov_b32 s15, 0x0
buffer_load_dwordx4 v249, s[52:55], s15 offen offset:0 nt lds
s_add_u32 m0, s10, 0x1000
s_mov_b32 s15, 0x1000
buffer_load_dwordx4 v249, s[52:55], s15 offen offset:0 nt lds
s_add_u32 m0, s10, 0x2000
s_mov_b32 s15, 0x2000
buffer_load_dwordx4 v249, s[52:55], s15 offen offset:0 nt lds
s_waitcnt vmcnt(10)
s_barrier
s_add_u32 m0, s10, 0x3000
s_mov_b32 s15, 0x3000
buffer_load_dwordx4 v249, s[52:55], s15 offen offset:0 nt lds
s_add_u32 m0, s10, 0x4000
s_mov_b32 s15, 0x4000
buffer_load_dwordx4 v249, s[52:55], s15 offen offset:0 nt lds
s_add_u32 m0, s10, 0x5000
s_mov_b32 s15, 0x5000
buffer_load_dwordx4 v249, s[52:55], s15 offen offset:0 nt lds
s_add_u32 m0, s10, 0x6000
s_mov_b32 s15, 0x6000
buffer_load_dwordx4 v249, s[52:55], s15 offen offset:0 nt lds
s_add_u32 m0, s10, 0x7000
s_mov_b32 s15, 0x7000
buffer_load_dwordx4 v249, s[52:55], s15 offen offset:0 nt lds
s_add_u32 m0, s11, 0x24000
s_add_u32 s15, s79, 0x40000
buffer_load_dwordx4 v251, s[48:51], s15 offen offset:0 lds
s_add_u32 m0, s11, 0x24800
s_add_u32 s15, s79, 0x48000
buffer_load_dwordx4 v251, s[48:51], s15 offen offset:0 lds
s_waitcnt vmcnt(10)
s_barrier
s_add_u32 m0, s11, 0x26000
s_add_u32 s15, s79, 0x60000
buffer_load_dwordx4 v251, s[48:51], s15 offen offset:0 lds
s_add_u32 m0, s11, 0x26800
s_add_u32 s15, s79, 0x68000
buffer_load_dwordx4 v251, s[48:51], s15 offen offset:0 lds
s_cmp_ge_u32 s80, 6
s_cselect_b32 s13, -6, 4
s_add_u32 s13, s13, s80
s_lshl_b32 s78, s13, 7
s_lshl_b32 s79, s13, 19
s_add_u32 m0, s10, 0x12000
s_add_u32 s15, s78, 0x0
buffer_load_dwordx4 v250, s[44:47], s15 offen offset:0 lds
s_add_u32 m0, s10, 0x13000
s_add_u32 s15, s78, 0xa000
buffer_load_dwordx4 v250, s[44:47], s15 offen offset:0 lds
s_add_u32 m0, s10, 0x14000
s_add_u32 s15, s78, 0x14000
buffer_load_dwordx4 v250, s[44:47], s15 offen offset:0 lds
s_add_u32 m0, s11, 0x18000
s_add_u32 s15, s79, 0x0
buffer_load_dwordx4 v251, s[48:51], s15 offen offset:0 lds
s_add_u32 m0, s11, 0x18800
s_add_u32 s15, s79, 0x8000
buffer_load_dwordx4 v251, s[48:51], s15 offen offset:0 lds
s_waitcnt vmcnt(5)
s_barrier
s_add_u32 m0, s11, 0x1a000
s_add_u32 s15, s79, 0x20000
buffer_load_dwordx4 v251, s[48:51], s15 offen offset:0 lds
s_add_u32 m0, s11, 0x1a800
s_add_u32 s15, s79, 0x28000
buffer_load_dwordx4 v251, s[48:51], s15 offen offset:0 lds
s_add_u32 m0, s11, 0x1c000
s_add_u32 s15, s79, 0x40000
buffer_load_dwordx4 v251, s[48:51], s15 offen offset:0 lds
s_add_u32 m0, s11, 0x1c800
s_add_u32 s15, s79, 0x48000
buffer_load_dwordx4 v251, s[48:51], s15 offen offset:0 lds
s_add_u32 m0, s11, 0x1e000
s_add_u32 s15, s79, 0x60000
buffer_load_dwordx4 v251, s[48:51], s15 offen offset:0 lds
s_add_u32 m0, s11, 0x1e800
s_add_u32 s15, s79, 0x68000
buffer_load_dwordx4 v251, s[48:51], s15 offen offset:0 lds
s_cmp_ge_u32 s80, 8
s_cselect_b32 s13, -8, 2
s_add_u32 s13, s13, s80
s_lshl_b32 s78, s13, 7
s_lshl_b32 s79, s13, 19
s_add_u32 m0, s10, 0x15000
s_add_u32 s15, s78, 0x0
buffer_load_dwordx4 v250, s[44:47], s15 offen offset:0 lds
s_waitcnt vmcnt(5)
s_barrier
s_add_u32 m0, s10, 0x16000
s_add_u32 s15, s78, 0xa000
buffer_load_dwordx4 v250, s[44:47], s15 offen offset:0 lds
s_add_u32 m0, s10, 0x17000
s_add_u32 s15, s78, 0x14000
buffer_load_dwordx4 v250, s[44:47], s15 offen offset:0 lds
s_add_u32 m0, s11, 0x20000
s_add_u32 s15, s79, 0x0
buffer_load_dwordx4 v251, s[48:51], s15 offen offset:0 lds
s_add_u32 m0, s11, 0x20800
s_add_u32 s15, s79, 0x8000
buffer_load_dwordx4 v251, s[48:51], s15 offen offset:0 lds
s_add_u32 m0, s11, 0x22000
s_add_u32 s15, s79, 0x20000
buffer_load_dwordx4 v251, s[48:51], s15 offen offset:0 lds
s_add_u32 m0, s11, 0x22800
s_add_u32 s15, s79, 0x28000
buffer_load_dwordx4 v251, s[48:51], s15 offen offset:0 lds
s_mov_b32 s15, 0x1e000
buffer_load_dword v246, v247, s[60:63], s15 offen
s_waitcnt vmcnt(8)
s_barrier
s_mov_b32 s15, 0x14000
buffer_load_dword v246, v247, s[60:63], s15 offen
s_add_u32 m0, s11, 0x24000
s_add_u32 s15, s79, 0x40000
buffer_load_dwordx4 v251, s[48:51], s15 offen offset:0 lds
s_add_u32 m0, s11, 0x24800
s_add_u32 s15, s79, 0x48000
buffer_load_dwordx4 v251, s[48:51], s15 offen offset:0 lds
s_add_u32 m0, s11, 0x26000
s_add_u32 s15, s79, 0x60000
buffer_load_dwordx4 v251, s[48:51], s15 offen offset:0 lds
s_add_u32 m0, s11, 0x26800
s_add_u32 s15, s79, 0x68000
buffer_load_dwordx4 v251, s[48:51], s15 offen offset:0 lds
s_cmp_ge_u32 s80, 7
s_cselect_b32 s13, -7, 3
s_add_u32 s13, s13, s80
s_lshl_b32 s78, s13, 7
s_lshl_b32 s79, s13, 19
s_add_u32 m0, s10, 0xc000
s_add_u32 s15, s78, 0x0
buffer_load_dwordx4 v250, s[44:47], s15 offen offset:0 lds
s_add_u32 m0, s10, 0xd000
s_add_u32 s15, s78, 0xa000
buffer_load_dwordx4 v250, s[44:47], s15 offen offset:0 lds
s_waitcnt vmcnt(8)
s_barrier
s_add_u32 m0, s10, 0xe000
s_add_u32 s15, s78, 0x14000
buffer_load_dwordx4 v250, s[44:47], s15 offen offset:0 lds
s_add_u32 m0, s11, 0x18000
s_add_u32 s15, s79, 0x0
buffer_load_dwordx4 v251, s[48:51], s15 offen offset:0 lds
s_add_u32 m0, s11, 0x18800
s_add_u32 s15, s79, 0x8000
buffer_load_dwordx4 v251, s[48:51], s15 offen offset:0 lds
s_add_u32 m0, s11, 0x1a000
s_add_u32 s15, s79, 0x20000
buffer_load_dwordx4 v251, s[48:51], s15 offen offset:0 lds
s_add_u32 m0, s11, 0x1a800
s_add_u32 s15, s79, 0x28000
buffer_load_dwordx4 v251, s[48:51], s15 offen offset:0 lds
s_add_u32 m0, s11, 0x1c000
s_add_u32 s15, s79, 0x40000
buffer_load_dwordx4 v251, s[48:51], s15 offen offset:0 lds
s_add_u32 m0, s11, 0x1c800
s_add_u32 s15, s79, 0x48000
buffer_load_dwordx4 v251, s[48:51], s15 offen offset:0 lds
s_waitcnt vmcnt(9)
s_barrier
s_add_u32 m0, s11, 0x1e000
s_add_u32 s15, s79, 0x60000
buffer_load_dwordx4 v251, s[48:51], s15 offen offset:0 lds
s_add_u32 m0, s11, 0x1e800
s_add_u32 s15, s79, 0x68000
buffer_load_dwordx4 v251, s[48:51], s15 offen offset:0 lds
s_add_u32 m0, s10, 0x8000
s_mov_b32 s15, 0x8000
buffer_load_dwordx4 v249, s[52:55], s15 offen offset:0 nt lds
s_add_u32 m0, s10, 0x9000
s_mov_b32 s15, 0x9000
buffer_load_dwordx4 v249, s[52:55], s15 offen offset:0 nt lds
s_add_u32 m0, s10, 0xa000
s_mov_b32 s15, 0xa000
buffer_load_dwordx4 v249, s[52:55], s15 offen offset:0 nt lds
s_add_u32 m0, s10, 0xb000
s_mov_b32 s15, 0xb000
buffer_load_dwordx4 v249, s[52:55], s15 offen offset:0 nt lds
s_cmp_ge_u32 s80, 5
s_cselect_b32 s13, -5, 5
s_add_u32 s13, s13, s80
s_lshl_b32 s78, s13, 7
s_lshl_b32 s79, s13, 19
s_add_u32 m0, s10, 0x12000
s_add_u32 s15, s78, 0x0
buffer_load_dwordx4 v250, s[44:47], s15 offen offset:0 lds
s_waitcnt vmcnt(9)
s_barrier
s_add_u32 m0, s10, 0x13000
s_add_u32 s15, s78, 0xa000
buffer_load_dwordx4 v250, s[44:47], s15 offen offset:0 lds
s_add_u32 m0, s10, 0x14000
s_add_u32 s15, s78, 0x14000
buffer_load_dwordx4 v250, s[44:47], s15 offen offset:0 lds
s_add_u32 m0, s11, 0x20000
s_add_u32 s15, s79, 0x0
buffer_load_dwordx4 v251, s[48:51], s15 offen offset:0 lds
s_add_u32 m0, s11, 0x20800
s_add_u32 s15, s79, 0x8000
buffer_load_dwordx4 v251, s[48:51], s15 offen offset:0 lds
s_add_u32 m0, s11, 0x22000
s_add_u32 s15, s79, 0x20000
buffer_load_dwordx4 v251, s[48:51], s15 offen offset:0 lds
s_add_u32 m0, s11, 0x22800
s_add_u32 s15, s79, 0x28000
buffer_load_dwordx4 v251, s[48:51], s15 offen offset:0 lds
s_add_u32 m0, s11, 0x24000
s_add_u32 s15, s79, 0x40000
buffer_load_dwordx4 v251, s[48:51], s15 offen offset:0 lds
s_waitcnt vmcnt(12)
s_barrier
s_add_u32 m0, s11, 0x24800
s_add_u32 s15, s79, 0x48000
buffer_load_dwordx4 v251, s[48:51], s15 offen offset:0 lds
s_add_u32 m0, s11, 0x26000
s_add_u32 s15, s79, 0x60000
buffer_load_dwordx4 v251, s[48:51], s15 offen offset:0 lds
s_add_u32 m0, s11, 0x26800
s_add_u32 s15, s79, 0x68000
buffer_load_dwordx4 v251, s[48:51], s15 offen offset:0 lds
s_cmp_ge_u32 s80, 4
s_cselect_b32 s13, -4, 6
s_add_u32 s13, s13, s80
s_lshl_b32 s78, s13, 7
s_lshl_b32 s79, s13, 19
s_add_u32 m0, s10, 0x15000
s_add_u32 s15, s78, 0x0
buffer_load_dwordx4 v250, s[44:47], s15 offen offset:0 lds
s_add_u32 m0, s10, 0x16000
s_add_u32 s15, s78, 0xa000
buffer_load_dwordx4 v250, s[44:47], s15 offen offset:0 lds
s_add_u32 m0, s10, 0x17000
s_add_u32 s15, s78, 0x14000
buffer_load_dwordx4 v250, s[44:47], s15 offen offset:0 lds
s_add_u32 m0, s11, 0x18000
s_add_u32 s15, s79, 0x0
buffer_load_dwordx4 v251, s[48:51], s15 offen offset:0 lds
s_waitcnt vmcnt(8)
s_barrier
s_add_u32 m0, s11, 0x18800
s_add_u32 s15, s79, 0x8000
buffer_load_dwordx4 v251, s[48:51], s15 offen offset:0 lds
s_add_u32 m0, s11, 0x1a000
s_add_u32 s15, s79, 0x20000
buffer_load_dwordx4 v251, s[48:51], s15 offen offset:0 lds
s_add_u32 m0, s11, 0x1a800
s_add_u32 s15, s79, 0x28000
buffer_load_dwordx4 v251, s[48:51], s15 offen offset:0 lds
s_add_u32 m0, s11, 0x1c000
s_add_u32 s15, s79, 0x40000
buffer_load_dwordx4 v251, s[48:51], s15 offen offset:0 lds
s_add_u32 m0, s11, 0x1c800
s_add_u32 s15, s79, 0x48000
buffer_load_dwordx4 v251, s[48:51], s15 offen offset:0 lds
s_add_u32 m0, s11, 0x1e000
s_add_u32 s15, s79, 0x60000
buffer_load_dwordx4 v251, s[48:51], s15 offen offset:0 lds
s_add_u32 m0, s11, 0x1e800
s_add_u32 s15, s79, 0x68000
buffer_load_dwordx4 v251, s[48:51], s15 offen offset:0 lds
s_waitcnt vmcnt(11)
s_barrier
s_cmp_ge_u32 s80, 3
s_cselect_b32 s13, -3, 7
s_add_u32 s13, s13, s80
s_lshl_b32 s78, s13, 7
s_lshl_b32 s79, s13, 19
s_add_u32 m0, s10, 0xf000
s_add_u32 s15, s78, 0x0
buffer_load_dwordx4 v250, s[44:47], s15 offen offset:0 lds
s_add_u32 m0, s10, 0x10000
s_add_u32 s15, s78, 0xa000
buffer_load_dwordx4 v250, s[44:47], s15 offen offset:0 lds
s_add_u32 m0, s10, 0x11000
s_add_u32 s15, s78, 0x14000
buffer_load_dwordx4 v250, s[44:47], s15 offen offset:0 lds
s_add_u32 m0, s11, 0x20000
s_add_u32 s15, s79, 0x0
buffer_load_dwordx4 v251, s[48:51], s15 offen offset:0 lds
s_add_u32 m0, s11, 0x20800
s_add_u32 s15, s79, 0x8000
buffer_load_dwordx4 v251, s[48:51], s15 offen offset:0 lds
s_add_u32 m0, s11, 0x22000
s_add_u32 s15, s79, 0x20000
buffer_load_dwordx4 v251, s[48:51], s15 offen offset:0 lds
s_add_u32 m0, s11, 0x22800
s_add_u32 s15, s79, 0x28000
buffer_load_dwordx4 v251, s[48:51], s15 offen offset:0 lds
s_waitcnt vmcnt(11)
s_barrier
s_add_u32 m0, s11, 0x24000
s_add_u32 s15, s79, 0x40000
buffer_load_dwordx4 v251, s[48:51], s15 offen offset:0 lds
s_add_u32 m0, s11, 0x24800
s_add_u32 s15, s79, 0x48000
buffer_load_dwordx4 v251, s[48:51], s15 offen offset:0 lds
s_add_u32 m0, s11, 0x26000
s_add_u32 s15, s79, 0x60000
buffer_load_dwordx4 v251, s[48:51], s15 offen offset:0 lds
s_add_u32 m0, s11, 0x26800
s_add_u32 s15, s79, 0x68000
buffer_load_dwordx4 v251, s[48:51], s15 offen offset:0 lds
s_cmp_ge_u32 s80, 2
s_cselect_b32 s13, -2, 8
s_add_u32 s13, s13, s80
s_lshl_b32 s78, s13, 7
s_lshl_b32 s79, s13, 19
s_add_u32 m0, s10, 0xc000
s_add_u32 s15, s78, 0x0
buffer_load_dwordx4 v250, s[44:47], s15 offen offset:0 lds
s_add_u32 m0, s10, 0xd000
s_add_u32 s15, s78, 0xa000
buffer_load_dwordx4 v250, s[44:47], s15 offen offset:0 lds
s_add_u32 m0, s10, 0xe000
s_add_u32 s15, s78, 0x14000
buffer_load_dwordx4 v250, s[44:47], s15 offen offset:0 lds
s_waitcnt vmcnt(14)
s_barrier
s_add_u32 m0, s11, 0x18000
s_add_u32 s15, s79, 0x0
buffer_load_dwordx4 v251, s[48:51], s15 offen offset:0 lds
s_add_u32 m0, s11, 0x18800
s_add_u32 s15, s79, 0x8000
buffer_load_dwordx4 v251, s[48:51], s15 offen offset:0 lds
s_add_u32 m0, s11, 0x1a000
s_add_u32 s15, s79, 0x20000
buffer_load_dwordx4 v251, s[48:51], s15 offen offset:0 lds
s_add_u32 m0, s11, 0x1a800
s_add_u32 s15, s79, 0x28000
buffer_load_dwordx4 v251, s[48:51], s15 offen offset:0 lds
s_waitcnt vmcnt(11)
s_barrier
s_add_u32 m0, s11, 0x1c000
s_add_u32 s15, s79, 0x40000
buffer_load_dwordx4 v251, s[48:51], s15 offen offset:0 lds
s_add_u32 m0, s11, 0x1c800
s_add_u32 s15, s79, 0x48000
buffer_load_dwordx4 v251, s[48:51], s15 offen offset:0 lds
s_add_u32 m0, s11, 0x1e000
s_add_u32 s15, s79, 0x60000
buffer_load_dwordx4 v251, s[48:51], s15 offen offset:0 lds
s_add_u32 m0, s11, 0x1e800
s_add_u32 s15, s79, 0x68000
buffer_load_dwordx4 v251, s[48:51], s15 offen offset:0 lds
s_add_u32 m0, s10, 0x12000
s_mov_b32 s15, 0x0
buffer_load_dwordx4 v248, s[56:59], s15 offen offset:0 nt lds
s_add_u32 m0, s10, 0x13000
s_mov_b32 s15, 0x2000
buffer_load_dwordx4 v248, s[56:59], s15 offen offset:0 nt lds
s_add_u32 m0, s10, 0x14000
s_mov_b32 s15, 0x4000
buffer_load_dwordx4 v248, s[56:59], s15 offen offset:0 nt lds
s_waitcnt vmcnt(14)
s_barrier
s_add_u32 m0, s10, 0x15000
s_mov_b32 s15, 0x6000
buffer_load_dwordx4 v248, s[56:59], s15 offen offset:0 nt lds
s_add_u32 m0, s10, 0x16000
s_mov_b32 s15, 0x8000
buffer_load_dwordx4 v248, s[56:59], s15 offen offset:0 nt lds
s_add_u32 m0, s10, 0x17000
s_mov_b32 s15, 0xa000
buffer_load_dwordx4 v248, s[56:59], s15 offen offset:0 nt lds
s_waitcnt vmcnt(10)
s_barrier
s_cmp_ge_u32 s80, 1
s_cselect_b32 s13, -1, 9
s_add_u32 s13, s13, s80
s_lshl_b32 s78, s13, 7
s_lshl_b32 s79, s13, 19
s_add_u32 m0, s10, 0xf000
s_add_u32 s15, s78, 0x0
buffer_load_dwordx4 v250, s[44:47], s15 offen offset:0 lds
s_add_u32 m0, s10, 0x10000
s_add_u32 s15, s78, 0xa000
buffer_load_dwordx4 v250, s[44:47], s15 offen offset:0 lds
s_add_u32 m0, s10, 0x11000
s_add_u32 s15, s78, 0x14000
buffer_load_dwordx4 v250, s[44:47], s15 offen offset:0 lds
s_add_u32 m0, s11, 0x20000
s_add_u32 s15, s79, 0x0
buffer_load_dwordx4 v251, s[48:51], s15 offen offset:0 lds
s_add_u32 m0, s11, 0x20800
s_add_u32 s15, s79, 0x8000
buffer_load_dwordx4 v251, s[48:51], s15 offen offset:0 lds
s_add_u32 m0, s11, 0x22000
s_add_u32 s15, s79, 0x20000
buffer_load_dwordx4 v251, s[48:51], s15 offen offset:0 lds
s_add_u32 m0, s11, 0x22800
s_add_u32 s15, s79, 0x28000
buffer_load_dwordx4 v251, s[48:51], s15 offen offset:0 lds
s_add_u32 m0, s11, 0x24000
s_add_u32 s15, s79, 0x40000
buffer_load_dwordx4 v251, s[48:51], s15 offen offset:0 lds
s_add_u32 m0, s11, 0x24800
s_add_u32 s15, s79, 0x48000
buffer_load_dwordx4 v251, s[48:51], s15 offen offset:0 lds
s_add_u32 m0, s11, 0x26000
s_add_u32 s15, s79, 0x60000
buffer_load_dwordx4 v251, s[48:51], s15 offen offset:0 lds
s_add_u32 m0, s11, 0x26800
s_add_u32 s15, s79, 0x68000
buffer_load_dwordx4 v251, s[48:51], s15 offen offset:0 lds
s_waitcnt vmcnt(17)
s_branch L_join
L_var3:
s_cmp_ge_u32 s80, 9
s_cselect_b32 s13, -9, 1
s_add_u32 s13, s13, s80
s_lshl_b32 s78, s13, 7
s_lshl_b32 s79, s13, 19
s_add_u32 m0, s10, 0xf000
s_add_u32 s15, s78, 0x0
buffer_load_dwordx4 v250, s[44:47], s15 offen offset:0 lds
s_add_u32 m0, s10, 0x10000
s_add_u32 s15, s78, 0xa000
buffer_load_dwordx4 v250, s[44:47], s15 offen offset:0 lds
s_add_u32 m0, s10, 0x11000
s_add_u32 s15, s78, 0x14000
buffer_load_dwordx4 v250, s[44:47], s15 offen offset:0 lds
s_waitcnt vmcnt(7)
s_barrier
s_add_u32 m0, s11, 0x20000
s_add_u32 s15, s79, 0x0
buffer_load_dwordx4 v251, s[48:51], s15 offen offset:0 lds
s_add_u32 m0, s11, 0x20800
s_add_u32 s15, s79, 0x8000
buffer_load_dwordx4 v251, s[48:51], s15 offen offset:0 lds
s_add_u32 m0, s11, 0x22000
s_add_u32 s15, s79, 0x20000
buffer_load_dwordx4 v251, s[48:51], s15 offen offset:0 lds
s_add_u32 m0, s11, 0x22800
s_add_u32 s15, s79, 0x28000
buffer_load_dwordx4 v251, s[48:51], s15 offen offset:0 lds
s_add_u32 m0, s11, 0x24000
s_add_u32 s15, s79, 0x40000
buffer_load_dwordx4 v251, s[48:51], s15 offen offset:0 lds
s_add_u32 m0, s11, 0x24800
s_add_u32 s15, s79, 0x48000
buffer_load_dwordx4 v251, s[48:51], s15 offen offset:0 lds
s_add_u32 m0, s11, 0x26000
s_add_u32 s15, s79, 0x60000
buffer_load_dwordx4 v251, s[48:51], s15 offen offset:0 lds
s_waitcnt vmcnt(10)
s_barrier
s_add_u32 m0, s11, 0x26800
s_add_u32 s15, s79, 0x68000
buffer_load_dwordx4 v251, s[48:51], s15 offen offset:0 lds
s_cmp_ge_u32 s80, 8
s_cselect_b32 s13, -8, 2
s_add_u32 s13, s13, s80
s_lshl_b32 s78, s13, 7
s_lshl_b32 s79, s13, 19
s_add_u32 m0, s10, 0x12000
s_add_u32 s15, s78, 0x0
buffer_load_dwordx4 v250, s[44:47], s15 offen offset:0 lds
s_add_u32 m0, s10, 0x13000
s_add_u32 s15, s78, 0xa000
buffer_load_dwordx4 v250, s[44:47], s15 offen offset:0 lds
s_add_u32 m0, s10, 0x14000
s_add_u32 s15, s78, 0x14000
buffer_load_dwordx4 v250, s[44:47], s15 offen offset:0 lds
s_add_u32 m0, s11, 0x18000
s_add_u32 s15, s79, 0x0
buffer_load_dwordx4 v251, s[48:51], s15 offen offset:0 lds
s_add_u32 m0, s11, 0x18800
s_add_u32 s15, s79, 0x8000
buffer_load_dwordx4 v251, s[48:51], s15 offen offset:0 lds
s_add_u32 m0, s11, 0x1a000
s_add_u32 s15, s79, 0x20000
buffer_load_dwordx4 v251, s[48:51], s15 offen offset:0 lds
s_waitcnt vmcnt(10)
s_barrier
s_add_u32 m0, s11, 0x1a800
s_add_u32 s15, s79, 0x28000
buffer_load_dwordx4 v251, s[48:51], s15 offen offset:0 lds
s_add_u32 m0, s10, 0x0
s_mov_b32 s15, 0x0
buffer_load_dwordx4 v249, s[52:55], s15 offen offset:0 nt lds
s_add_u32 m0, s10, 0x1000
s_mov_b32 s15, 0x1000
buffer_load_dwordx4 v249, s[52:55], s15 offen offset:0 nt lds
s_add_u32 m0, s10, 0x2000
s_mov_b32 s15, 0x2000
buffer_load_dwordx4 v249, s[52:55], s15 offen offset:0 nt lds
s_add_u32 m0, s10, 0x3000
s_mov_b32 s15, 0x3000
buffer_load_dwordx4 v249, s[52:55], s15 offen offset:0 nt lds
s_add_u32 m0, s10, 0x4000
s_mov_b32 s15, 0x4000
buffer_load_dwordx4 v249, s[52:55], s15 offen offset:0 nt lds
s_add_u32 m0, s10, 0x5000
s_mov_b32 s15, 0x5000
buffer_load_dwordx4 v249, s[52:55], s15 offen offset:0 nt lds
s_waitcnt vmcnt(13)
s_barrier
s_add_u32 m0, s10, 0x6000
s_mov_b32 s15, 0x6000
buffer_load_dwordx4 v249, s[52:55], s15 offen offset:0 nt lds
s_add_u32 m0, s10, 0x7000
s_mov_b32 s15, 0x7000
buffer_load_dwordx4 v249, s[52:55], s15 offen offset:0 nt lds
s_add_u32 m0, s11, 0x1c000
s_add_u32 s15, s79, 0x40000
buffer_load_dwordx4 v251, s[48:51], s15 offen offset:0 lds
s_add_u32 m0, s11, 0x1c800
s_add_u32 s15, s79, 0x48000
buffer_load_dwordx4 v251, s[48:51], s15 offen offset:0 lds
s_add_u32 m0, s11, 0x1e000
s_add_u32 s15, s79, 0x60000
buffer_load_dwordx4 v251, s[48:51], s15 offen offset:0 lds
s_add_u32 m0, s11, 0x1e800
s_add_u32 s15, s79, 0x68000
buffer_load_dwordx4 v251, s[48:51], s15 offen offset:0 lds
s_cmp_ge_u32 s80, 5
s_cselect_b32 s13, -5, 5
s_add_u32 s13, s13, s80
s_lshl_b32 s78, s13, 7
s_lshl_b32 s79, s13, 19
s_add_u32 m0, s10, 0x15000
s_add_u32 s15, s78, 0x0
buffer_load_dwordx4 v250, s[44:47], s15 offen offset:0 lds
s_waitcnt vmcnt(13)
s_barrier
s_add_u32 m0, s10, 0x16000
s_add_u32 s15, s78, 0xa000
buffer_load_dwordx4 v250, s[44:47], s15 offen offset:0 lds
s_add_u32 m0, s10, 0x17000
s_add_u32 s15, s78, 0x14000
buffer_load_dwordx4 v250, s[44:47], s15 offen offset:0 lds
s_add_u32 m0, s11, 0x20000
s_add_u32 s15, s79, 0x0
buffer_load_dwordx4 v251, s[48:51], s15 offen offset:0 lds
s_add_u32 m0, s11, 0x20800
s_add_u32 s15, s79, 0x8000
buffer_load_dwordx4 v251, s[48:51], s15 offen offset:0 lds
s_add_u32 m0, s11, 0x22000
s_add_u32 s15, s79, 0x20000
buffer_load_dwordx4 v251, s[48:51], s15 offen offset:0 lds
s_add_u32 m0, s11, 0x22800
s_add_u32 s15, s79, 0x28000
buffer_load_dwordx4 v251, s[48:51], s15 offen offset:0 lds
s_add_u32 m0, s11, 0x24000
s_add_u32 s15, s79, 0x40000
buffer_load_dwordx4 v251, s[48:51], s15 offen offset:0 lds
s_waitcnt vmcnt(8)
s_barrier
s_add_u32 m0, s11, 0x24800
s_add_u32 s15, s79, 0x48000
buffer_load_dwordx4 v251, s[48:51], s15 offen offset:0 lds
s_add_u32 m0, s11, 0x26000
s_add_u32 s15, s79, 0x60000
buffer_load_dwordx4 v251, s[48:51], s15 offen offset:0 lds
s_add_u32 m0, s11, 0x26800
s_add_u32 s15, s79, 0x68000
buffer_load_dwordx4 v251, s[48:51], s15 offen offset:0 lds
s_cmp_ge_u32 s80, 7
s_cselect_b32 s13, -7, 3
s_add_u32 s13, s13, s80
s_lshl_b32 s78, s13, 7
s_lshl_b32 s79, s13, 19
s_add_u32 m0, s10, 0xc000
s_add_u32 s15, s78, 0x0
buffer_load_dwordx4 v250, s[44:47], s15 offen offset:0 lds
s_add_u32 m0, s10, 0xd000
s_add_u32 s15, s78, 0xa000
buffer_load_dwordx4 v250, s[44:47], s15 offen offset:0 lds
s_add_u32 m0, s10, 0xe000
s_add_u32 s15, s78, 0x14000
buffer_load_dwordx4 v250, s[44:47], s15 offen offset:0 lds
s_add_u32 m0, s11, 0x18000
s_add_u32 s15, s79, 0x0
buffer_load_dwordx4 v251, s[48:51], s15 offen offset:0 lds
s_waitcnt vmcnt(8)
s_barrier
s_add_u32 m0, s11, 0x18800
s_add_u32 s15, s79, 0x8000
buffer_load_dwordx4 v251, s[48:51], s15 offen offset:0 lds
s_add_u32 m0, s11, 0x1a000
s_add_u32 s15, s79, 0x20000
buffer_load_dwordx4 v251, s[48:51], s15 offen offset:0 lds
s_add_u32 m0, s11, 0x1a800
s_add_u32 s15, s79, 0x28000
buffer_load_dwordx4 v251, s[48:51], s15 offen offset:0 lds
s_mov_b32 s15, 0x1e000
buffer_load_dword v246, v247, s[60:63], s15 offen
s_mov_b32 s15, 0x14000
buffer_load_dword v246, v247, s[60:63], s15 offen
s_add_u32 m0, s11, 0x1c000
s_add_u32 s15, s79, 0x40000
buffer_load_dwordx4 v251, s[48:51], s15 offen offset:0 lds
s_add_u32 m0, s11, 0x1c800
s_add_u32 s15, s79, 0x48000
buffer_load_dwordx4 v251, s[48:51], s15 offen offset:0 lds
s_waitcnt vmcnt(11)
s_barrier
s_add_u32 m0, s11, 0x1e000
s_add_u32 s15, s79, 0x60000
buffer_load_dwordx4 v251, s[48:51], s15 offen offset:0 lds
s_add_u32 m0, s11, 0x1e800
s_add_u32 s15, s79, 0x68000
buffer_load_dwordx4 v251, s[48:51], s15 offen offset:0 lds
s_cmp_ge_u32 s80, 6
s_cselect_b32 s13, -6, 4
s_add_u32 s13, s13, s80
s_lshl_b32 s78, s13, 7
s_lshl_b32 s79, s13, 19
s_add_u32 m0, s10, 0x12000
s_add_u32 s15, s78, 0x0
buffer_load_dwordx4 v250, s[44:47], s15 offen offset:0 lds
s_add_u32 m0, s10, 0x13000
s_add_u32 s15, s78, 0xa000
buffer_load_dwordx4 v250, s[44:47], s15 offen offset:0 lds
s_add_u32 m0, s10, 0x14000
s_add_u32 s15, s78, 0x14000
buffer_load_dwordx4 v250, s[44:47], s15 offen offset:0 lds
s_add_u32 m0, s11, 0x20000
s_add_u32 s15, s79, 0x0
buffer_load_dwordx4 v251, s[48:51], s15 offen offset:0 lds
s_add_u32 m0, s11, 0x20800
s_add_u32 s15, s79, 0x8000
buffer_load_dwordx4 v251, s[48:51], s15 offen offset:0 lds
s_waitcnt vmcnt(11)
s_barrier
s_add_u32 m0, s11, 0x22000
s_add_u32 s15, s79, 0x20000
buffer_load_dwordx4 v251, s[48:51], s15 offen offset:0 lds
s_add_u32 m0, s11, 0x22800
s_add_u32 s15, s79, 0x28000
buffer_load_dwordx4 v251, s[48:51], s15 offen offset:0 lds
s_add_u32 m0, s11, 0x24000
s_add_u32 s15, s79, 0x40000
buffer_load_dwordx4 v251, s[48:51], s15 offen offset:0 lds
s_add_u32 m0, s11, 0x24800
s_add_u32 s15, s79, 0x48000
buffer_load_dwordx4 v251, s[48:51], s15 offen offset:0 lds
s_add_u32 m0, s11, 0x26000
s_add_u32 s15, s79, 0x60000
buffer_load_dwordx4 v251, s[48:51], s15 offen offset:0 lds
s_add_u32 m0, s11, 0x26800
s_add_u32 s15, s79, 0x68000
buffer_load_dwordx4 v251, s[48:51], s15 offen offset:0 lds
s_add_u32 m0, s10, 0x8000
s_mov_b32 s15, 0x8000
buffer_load_dwordx4 v249, s[52:55], s15 offen offset:0 nt lds
s_waitcnt vmcnt(12)
s_barrier
s_add_u32 m0, s10, 0x9000
s_mov_b32 s15, 0x9000
buffer_load_dwordx4 v249, s[52:55], s15 offen offset:0 nt lds
s_add_u32 m0, s10, 0xa000
s_mov_b32 s15, 0xa000
buffer_load_dwordx4 v249, s[52:55], s15 offen offset:0 nt lds
s_add_u32 m0, s10, 0xb000
s_mov_b32 s15, 0xb000
buffer_load_dwordx4 v249, s[52:55], s15 offen offset:0 nt lds
s_cmp_ge_u32 s80, 4
s_cselect_b32 s13, -4, 6
s_add_u32 s13, s13, s80
s_lshl_b32 s78, s13, 7
s_lshl_b32 s79, s13, 19
s_add_u32 m0, s10, 0x15000
s_add_u32 s15, s78, 0x0
buffer_load_dwordx4 v250, s[44:47], s15 offen offset:0 lds
s_add_u32 m0, s10, 0x16000
s_add_u32 s15, s78, 0xa000
buffer_load_dwordx4 v250, s[44:47], s15 offen offset:0 lds
s_add_u32 m0, s10, 0x17000
s_add_u32 s15, s78, 0x14000
buffer_load_dwordx4 v250, s[44:47], s15 offen offset:0 lds
s_add_u32 m0, s11, 0x18000
s_add_u32 s15, s79, 0x0
buffer_load_dwordx4 v251, s[48:51], s15 offen offset:0 lds
s_waitcnt vmcnt(12)
s_barrier
s_add_u32 m0, s11, 0x18800
s_add_u32 s15, s79, 0x8000
buffer_load_dwordx4 v251, s[48:51], s15 offen offset:0 lds
s_add_u32 m0, s11, 0x1a000
s_add_u32 s15, s79, 0x20000
buffer_load_dwordx4 v251, s[48:51], s15 offen offset:0 lds
s_add_u32 m0, s11, 0x1a800
s_add_u32 s15, s79, 0x28000
buffer_load_dwordx4 v251, s[48:51], s15 offen offset:0 lds
s_add_u32 m0, s11, 0x1c000
s_add_u32 s15, s79, 0x40000
buffer_load_dwordx4 v251, s[48:51], s15 offen offset:0 lds
s_add_u32 m0, s11, 0x1c800
s_add_u32 s15, s79, 0x48000
buffer_load_dwordx4 v251, s[48:51], s15 offen offset:0 lds
s_add_u32 m0, s11, 0x1e000
s_add_u32 s15, s79, 0x60000
buffer_load_dwordx4 v251, s[48:51], s15 offen offset:0 lds
s_add_u32 m0, s11, 0x1e800
s_add_u32 s15, s79, 0x68000
buffer_load_dwordx4 v251, s[48:51], s15 offen offset:0 lds
s_waitcnt vmcnt(15)
s_barrier
s_cmp_ge_u32 s80, 3
s_cselect_b32 s13, -3, 7
s_add_u32 s13, s13, s80
s_lshl_b32 s78, s13, 7
s_lshl_b32 s79, s13, 19
s_add_u32 m0, s10, 0xf000
s_add_u32 s15, s78, 0x0
buffer_load_dwordx4 v250, s[44:47], s15 offen offset:0 lds
s_add_u32 m0, s10, 0x10000
s_add_u32 s15, s78, 0xa000
buffer_load_dwordx4 v250, s[44:47], s15 offen offset:0 lds
s_add_u32 m0, s10, 0x11000
s_add_u32 s15, s78, 0x14000
buffer_load_dwordx4 v250, s[44:47], s15 offen offset:0 lds
s_add_u32 m0, s11, 0x20000
s_add_u32 s15, s79, 0x0
buffer_load_dwordx4 v251, s[48:51], s15 offen offset:0 lds
s_add_u32 m0, s11, 0x20800
s_add_u32 s15, s79, 0x8000
buffer_load_dwordx4 v251, s[48:51], s15 offen offset:0 lds
s_add_u32 m0, s11, 0x22000
s_add_u32 s15, s79, 0x20000
buffer_load_dwordx4 v251, s[48:51], s15 offen offset:0 lds
s_add_u32 m0, s11, 0x22800
s_add_u32 s15, s79, 0x28000
buffer_load_dwordx4 v251, s[48:51], s15 offen offset:0 lds
s_waitcnt vmcnt(11)
s_barrier
s_add_u32 m0, s11, 0x24000
s_add_u32 s15, s79, 0x40000
buffer_load_dwordx4 v251, s[48:51], s15 offen offset:0 lds
s_add_u32 m0, s11, 0x24800
s_add_u32 s15, s79, 0x48000
buffer_load_dwordx4 v251, s[48:51], s15 offen offset:0 lds
s_add_u32 m0, s11, 0x26000
s_add_u32 s15, s79, 0x60000
buffer_load_dwordx4 v251, s[48:51], s15 offen offset:0 lds
s_add_u32 m0, s11, 0x26800
s_add_u32 s15, s79, 0x68000
buffer_load_dwordx4 v251, s[48:51], s15 offen offset:0 lds
s_cmp_ge_u32 s80, 2
s_cselect_b32 s13, -2, 8
s_add_u32 s13, s13, s80
s_lshl_b32 s78, s13, 7
s_lshl_b32 s79, s13, 19
s_add_u32 m0, s10, 0xc000
s_add_u32 s15, s78, 0x0
buffer_load_dwordx4 v250, s[44:47], s15 offen offset:0 lds
s_add_u32 m0, s10, 0xd000
s_add_u32 s15, s78, 0xa000
buffer_load_dwordx4 v250, s[44:47], s15 offen offset:0 lds
s_add_u32 m0, s10, 0xe000
s_add_u32 s15, s78, 0x14000
buffer_load_dwordx4 v250, s[44:47], s15 offen offset:0 lds
s_waitcnt vmcnt(14)
s_barrier
s_add_u32 m0, s11, 0x18000
s_add_u32 s15, s79, 0x0
buffer_load_dwordx4 v251, s[48:51], s15 offen offset:0 lds
s_add_u32 m0, s11, 0x18800
s_add_u32 s15, s79, 0x8000
buffer_load_dwordx4 v251, s[48:51], s15 offen offset:0 lds
s_add_u32 m0, s11, 0x1a000
s_add_u32 s15, s79, 0x20000
buffer_load_dwordx4 v251, s[48:51], s15 offen offset:0 lds
s_add_u32 m0, s11, 0x1a800
s_add_u32 s15, s79, 0x28000
buffer_load_dwordx4 v251, s[48:51], s15 offen offset:0 lds
s_add_u32 m0, s10, 0x12000
s_mov_b32 s15, 0x0
buffer_load_dwordx4 v248, s[56:59], s15 offen offset:0 nt lds
s_add_u32 m0, s10, 0x13000
s_mov_b32 s15, 0x2000
buffer_load_dwordx4 v248, s[56:59], s15 offen offset:0 nt lds
s_add_u32 m0, s10, 0x14000
s_mov_b32 s15, 0x4000
buffer_load_dwordx4 v248, s[56:59], s15 offen offset:0 nt lds
s_waitcnt vmcnt(14)
s_barrier
s_add_u32 m0, s10, 0x15000
s_mov_b32 s15, 0x6000
buffer_load_dwordx4 v248, s[56:59], s15 offen offset:0 nt lds
s_add_u32 m0, s10, 0x16000
s_mov_b32 s15, 0x8000
buffer_load_dwordx4 v248, s[56:59], s15 offen offset:0 nt lds
s_add_u32 m0, s10, 0x17000
s_mov_b32 s15, 0xa000
buffer_load_dwordx4 v248, s[56:59], s15 offen offset:0 nt lds
s_add_u32 m0, s11, 0x1c000
s_add_u32 s15, s79, 0x40000
buffer_load_dwordx4 v251, s[48:51], s15 offen offset:0 lds
s_add_u32 m0, s11, 0x1c800
s_add_u32 s15, s79, 0x48000
buffer_load_dwordx4 v251, s[48:51], s15 offen offset:0 lds
s_add_u32 m0, s11, 0x1e000
s_add_u32 s15, s79, 0x60000
buffer_load_dwordx4 v251, s[48:51], s15 offen offset:0 lds
s_add_u32 m0, s11, 0x1e800
s_add_u32 s15, s79, 0x68000
buffer_load_dwordx4 v251, s[48:51], s15 offen offset:0 lds
s_waitcnt vmcnt(17)
s_barrier
s_waitcnt vmcnt(10)
s_barrier
s_cmp_ge_u32 s80, 1
s_cselect_b32 s13, -1, 9
s_add_u32 s13, s13, s80
s_lshl_b32 s78, s13, 7
s_lshl_b32 s79, s13, 19
s_add_u32 m0, s10, 0xf000
s_add_u32 s15, s78, 0x0
buffer_load_dwordx4 v250, s[44:47], s15 offen offset:0 lds
s_add_u32 m0, s10, 0x10000
s_add_u32 s15, s78, 0xa000
buffer_load_dwordx4 v250, s[44:47], s15 offen offset:0 lds
s_add_u32 m0, s10, 0x11000
s_add_u32 s15, s78, 0x14000
buffer_load_dwordx4 v250, s[44:47], s15 offen offset:0 lds
s_add_u32 m0, s11, 0x20000
s_add_u32 s15, s79, 0x0
buffer_load_dwordx4 v251, s[48:51], s15 offen offset:0 lds
s_add_u32 m0, s11, 0x20800
s_add_u32 s15, s79, 0x8000
buffer_load_dwordx4 v251, s[48:51], s15 offen offset:0 lds
s_add_u32 m0, s11, 0x22000
s_add_u32 s15, s79, 0x20000
buffer_load_dwordx4 v251, s[48:51], s15 offen offset:0 lds
s_add_u32 m0, s11, 0x22800
s_add_u32 s15, s79, 0x28000
buffer_load_dwordx4 v251, s[48:51], s15 offen offset:0 lds
s_add_u32 m0, s11, 0x24000
s_add_u32 s15, s79, 0x40000
buffer_load_dwordx4 v251, s[48:51], s15 offen offset:0 lds
s_add_u32 m0, s11, 0x24800
s_add_u32 s15, s79, 0x48000
buffer_load_dwordx4 v251, s[48:51], s15 offen offset:0 lds
s_add_u32 m0, s11, 0x26000
s_add_u32 s15, s79, 0x60000
buffer_load_dwordx4 v251, s[48:51], s15 offen offset:0 lds
s_add_u32 m0, s11, 0x26800
s_add_u32 s15, s79, 0x68000
buffer_load_dwordx4 v251, s[48:51], s15 offen offset:0 lds
s_waitcnt vmcnt(11)
s_branch L_join
L_var4:
s_cmp_ge_u32 s80, 10
s_cselect_b32 s13, -10, 0
s_add_u32 s13, s13, s80
s_lshl_b32 s78, s13, 7
s_lshl_b32 s79, s13, 19
s_add_u32 m0, s10, 0xf000
s_add_u32 s15, s78, 0x0
buffer_load_dwordx4 v250, s[44:47], s15 offen offset:0 lds
s_add_u32 m0, s10, 0x10000
s_add_u32 s15, s78, 0xa000
buffer_load_dwordx4 v250, s[44:47], s15 offen offset:0 lds
s_add_u32 m0, s10, 0x11000
s_add_u32 s15, s78, 0x14000
buffer_load_dwordx4 v250, s[44:47], s15 offen offset:0 lds
s_waitcnt vmcnt(7)
s_barrier
s_add_u32 m0, s11, 0x20000
s_add_u32 s15, s79, 0x0
buffer_load_dwordx4 v251, s[48:51], s15 offen offset:0 lds
s_add_u32 m0, s11, 0x20800
s_add_u32 s15, s79, 0x8000
buffer_load_dwordx4 v251, s[48:51], s15 offen offset:0 lds
s_add_u32 m0, s11, 0x22000
s_add_u32 s15, s79, 0x20000
buffer_load_dwordx4 v251, s[48:51], s15 offen offset:0 lds
s_add_u32 m0, s11, 0x22800
s_add_u32 s15, s79, 0x28000
buffer_load_dwordx4 v251, s[48:51], s15 offen offset:0 lds
s_add_u32 m0, s11, 0x24000
s_add_u32 s15, s79, 0x40000
buffer_load_dwordx4 v251, s[48:51], s15 offen offset:0 lds
s_add_u32 m0, s11, 0x24800
s_add_u32 s15, s79, 0x48000
buffer_load_dwordx4 v251, s[48:51], s15 offen offset:0 lds
s_add_u32 m0, s11, 0x26000
s_add_u32 s15, s79, 0x60000
buffer_load_dwordx4 v251, s[48:51], s15 offen offset:0 lds
s_waitcnt vmcnt(10)
s_barrier
s_add_u32 m0, s11, 0x26800
s_add_u32 s15, s79, 0x68000
buffer_load_dwordx4 v251, s[48:51], s15 offen offset:0 lds
s_add_u32 m0, s10, 0x0
s_mov_b32 s15, 0x0
buffer_load_dwordx4 v249, s[52:55], s15 offen offset:0 nt lds
s_add_u32 m0, s10, 0x1000
s_mov_b32 s15, 0x1000
buffer_load_dwordx4 v249, s[52:55], s15 offen offset:0 nt lds
s_add_u32 m0, s10, 0x2000
s_mov_b32 s15, 0x2000
buffer_load_dwordx4 v249, s[52:55], s15 offen offset:0 nt lds
s_add_u32 m0, s10, 0x3000
s_mov_b32 s15, 0x3000
buffer_load_dwordx4 v249, s[52:55], s15 offen offset:0 nt lds
s_add_u32 m0, s10, 0x4000
s_mov_b32 s15, 0x4000
buffer_load_dwordx4 v249, s[52:55], s15 offen offset:0 nt lds
s_add_u32 m0, s10, 0x5000
s_mov_b32 s15, 0x5000
buffer_load_dwordx4 v249, s[52:55], s15 offen offset:0 nt lds
s_waitcnt vmcnt(10)
s_barrier
s_add_u32 m0, s10, 0x6000
s_mov_b32 s15, 0x6000
buffer_load_dwordx4 v249, s[52:55], s15 offen offset:0 nt lds
s_add_u32 m0, s10, 0x7000
s_mov_b32 s15, 0x7000
buffer_load_dwordx4 v249, s[52:55], s15 offen offset:0 nt lds
s_cmp_ge_u32 s80, 9
s_cselect_b32 s13, -9, 1
s_add_u32 s13, s13, s80
s_lshl_b32 s78, s13, 7
s_lshl_b32 s79, s13, 19
s_add_u32 m0, s10, 0x12000
s_add_u32 s15, s78, 0x0
buffer_load_dwordx4 v250, s[44:47], s15 offen offset:0 lds
s_add_u32 m0, s10, 0x13000
s_add_u32 s15, s78, 0xa000
buffer_load_dwordx4 v250, s[44:47], s15 offen offset:0 lds
s_add_u32 m0, s10, 0x14000
s_add_u32 s15, s78, 0x14000
buffer_load_dwordx4 v250, s[44:47], s15 offen offset:0 lds
s_add_u32 m0, s11, 0x18000
s_add_u32 s15, s79, 0x0
buffer_load_dwordx4 v251, s[48:51], s15 offen offset:0 lds
s_add_u32 m0, s11, 0x18800
s_add_u32 s15, s79, 0x8000
buffer_load_dwordx4 v251, s[48:51], s15 offen offset:0 lds
s_waitcnt vmcnt(13)
s_barrier
s_add_u32 m0, s11, 0x1a000
s_add_u32 s15, s79, 0x20000
buffer_load_dwordx4 v251, s[48:51], s15 offen offset:0 lds
s_add_u32 m0, s11, 0x1a800
s_add_u32 s15, s79, 0x28000
buffer_load_dwordx4 v251, s[48:51], s15 offen offset:0 lds
s_add_u32 m0, s11, 0x1c000
s_add_u32 s15, s79, 0x40000
buffer_load_dwordx4 v251, s[48:51], s15 offen offset:0 lds
s_add_u32 m0, s11, 0x1c800
s_add_u32 s15, s79, 0x48000
buffer_load_dwordx4 v251, s[48:51], s15 offen offset:0 lds
s_add_u32 m0, s11, 0x1e000
s_add_u32 s15, s79, 0x60000
buffer_load_dwordx4 v251, s[48:51], s15 offen offset:0 lds
s_add_u32 m0, s11, 0x1e800
s_add_u32 s15, s79, 0x68000
buffer_load_dwordx4 v251, s[48:51], s15 offen offset:0 lds
s_cmp_ge_u32 s80, 7
s_cselect_b32 s13, -7, 3
s_add_u32 s13, s13, s80
s_lshl_b32 s78, s13, 7
s_lshl_b32 s79, s13, 19
s_add_u32 m0, s10, 0x15000
s_add_u32 s15, s78, 0x0
buffer_load_dwordx4 v250, s[44:47], s15 offen offset:0 lds
s_waitcnt vmcnt(5)
s_barrier
s_add_u32 m0, s10, 0x16000
s_add_u32 s15, s78, 0xa000
buffer_load_dwordx4 v250, s[44:47], s15 offen offset:0 lds
s_add_u32 m0, s10, 0x17000
s_add_u32 s15, s78, 0x14000
buffer_load_dwordx4 v250, s[44:47], s15 offen offset:0 lds
s_add_u32 m0, s11, 0x20000
s_add_u32 s15, s79, 0x0
buffer_load_dwordx4 v251, s[48:51], s15 offen offset:0 lds
s_add_u32 m0, s11, 0x20800
s_add_u32 s15, s79, 0x8000
buffer_load_dwordx4 v251, s[48:51], s15 offen offset:0 lds
s_add_u32 m0, s11, 0x22000
s_add_u32 s15, s79, 0x20000
buffer_load_dwordx4 v251, s[48:51], s15 offen offset:0 lds
s_add_u32 m0, s11, 0x22800
s_add_u32 s15, s79, 0x28000
buffer_load_dwordx4 v251, s[48:51], s15 offen offset:0 lds
s_mov_b32 s15, 0x1e000
buffer_load_dword v246, v247, s[60:63], s15 offen
s_waitcnt vmcnt(8)
s_barrier
s_mov_b32 s15, 0x14000
buffer_load_dword v246, v247, s[60:63], s15 offen
s_add_u32 m0, s11, 0x24000
s_add_u32 s15, s79, 0x40000
buffer_load_dwordx4 v251, s[48:51], s15 offen offset:0 lds
s_add_u32 m0, s11, 0x24800
s_add_u32 s15, s79, 0x48000
buffer_load_dwordx4 v251, s[48:51], s15 offen offset:0 lds
s_add_u32 m0, s11, 0x26000
s_add_u32 s15, s79, 0x60000
buffer_load_dwordx4 v251, s[48:51], s15 offen offset:0 lds
s_add_u32 m0, s11, 0x26800
s_add_u32 s15, s79, 0x68000
buffer_load_dwordx4 v251, s[48:51], s15 offen offset:0 lds
s_cmp_ge_u32 s80, 4
s_cselect_b32 s13, -4, 6
s_add_u32 s13, s13, s80
s_lshl_b32 s78, s13, 7
s_lshl_b32 s79, s13, 19
s_add_u32 m0, s10, 0xc000
s_add_u32 s15, s78, 0x0
buffer_load_dwordx4 v250, s[44:47], s15 offen offset:0 lds
s_add_u32 m0, s10, 0xd000
s_add_u32 s15, s78, 0xa000
buffer_load_dwordx4 v250, s[44:47], s15 offen offset:0 lds
s_waitcnt vmcnt(8)
s_barrier
s_add_u32 m0, s10, 0xe000
s_add_u32 s15, s78, 0x14000
buffer_load_dwordx4 v250, s[44:47], s15 offen offset:0 lds
s_add_u32 m0, s11, 0x18000
s_add_u32 s15, s79, 0x0
buffer_load_dwordx4 v251, s[48:51], s15 offen offset:0 lds
s_add_u32 m0, s11, 0x18800
s_add_u32 s15, s79, 0x8000
buffer_load_dwordx4 v251, s[48:51], s15 offen offset:0 lds
s_add_u32 m0, s11, 0x1a000
s_add_u32 s15, s79, 0x20000
buffer_load_dwordx4 v251, s[48:51], s15 offen offset:0 lds
s_add_u32 m0, s11, 0x1a800
s_add_u32 s15, s79, 0x28000
buffer_load_dwordx4 v251, s[48:51], s15 offen offset:0 lds
s_add_u32 m0, s11, 0x1c000
s_add_u32 s15, s79, 0x40000
buffer_load_dwordx4 v251, s[48:51], s15 offen offset:0 lds
s_add_u32 m0, s11, 0x1c800
s_add_u32 s15, s79, 0x48000
buffer_load_dwordx4 v251, s[48:51], s15 offen offset:0 lds
s_waitcnt vmcnt(9)
s_barrier
s_add_u32 m0, s11, 0x1e000
s_add_u32 s15, s79, 0x60000
buffer_load_dwordx4 v251, s[48:51], s15 offen offset:0 lds
s_add_u32 m0, s11, 0x1e800
s_add_u32 s15, s79, 0x68000
buffer_load_dwordx4 v251, s[48:51], s15 offen offset:0 lds
s_cmp_ge_u32 s80, 6
s_cselect_b32 s13, -6, 4
s_add_u32 s13, s13, s80
s_lshl_b32 s78, s13, 7
s_lshl_b32 s79, s13, 19
s_add_u32 m0, s10, 0x12000
s_add_u32 s15, s78, 0x0
buffer_load_dwordx4 v250, s[44:47], s15 offen offset:0 lds
s_add_u32 m0, s10, 0x13000
s_add_u32 s15, s78, 0xa000
buffer_load_dwordx4 v250, s[44:47], s15 offen offset:0 lds
s_add_u32 m0, s10, 0x14000
s_add_u32 s15, s78, 0x14000
buffer_load_dwordx4 v250, s[44:47], s15 offen offset:0 lds
s_add_u32 m0, s11, 0x20000
s_add_u32 s15, s79, 0x0
buffer_load_dwordx4 v251, s[48:51], s15 offen offset:0 lds
s_add_u32 m0, s11, 0x20800
s_add_u32 s15, s79, 0x8000
buffer_load_dwordx4 v251, s[48:51], s15 offen offset:0 lds
s_waitcnt vmcnt(9)
s_barrier
s_add_u32 m0, s11, 0x22000
s_add_u32 s15, s79, 0x20000
buffer_load_dwordx4 v251, s[48:51], s15 offen offset:0 lds
s_add_u32 m0, s11, 0x22800
s_add_u32 s15, s79, 0x28000
buffer_load_dwordx4 v251, s[48:51], s15 offen offset:0 lds
s_add_u32 m0, s11, 0x24000
s_add_u32 s15, s79, 0x40000
buffer_load_dwordx4 v251, s[48:51], s15 offen offset:0 lds
s_add_u32 m0, s11, 0x24800
s_add_u32 s15, s79, 0x48000
buffer_load_dwordx4 v251, s[48:51], s15 offen offset:0 lds
s_add_u32 m0, s11, 0x26000
s_add_u32 s15, s79, 0x60000
buffer_load_dwordx4 v251, s[48:51], s15 offen offset:0 lds
s_add_u32 m0, s11, 0x26800
s_add_u32 s15, s79, 0x68000
buffer_load_dwordx4 v251, s[48:51], s15 offen offset:0 lds
s_add_u32 m0, s10, 0x8000
s_mov_b32 s15, 0x8000
buffer_load_dwordx4 v249, s[52:55], s15 offen offset:0 nt lds
s_waitcnt vmcnt(12)
s_barrier
s_add_u32 m0, s10, 0x9000
s_mov_b32 s15, 0x9000
buffer_load_dwordx4 v249, s[52:55], s15 offen offset:0 nt lds
s_add_u32 m0, s10, 0xa000
s_mov_b32 s15, 0xa000
buffer_load_dwordx4 v249, s[52:55], s15 offen offset:0 nt lds
s_add_u32 m0, s10, 0xb000
s_mov_b32 s15, 0xb000
buffer_load_dwordx4 v249, s[52:55], s15 offen offset:0 nt lds
s_cmp_ge_u32 s80, 5
s_cselect_b32 s13, -5, 5
s_add_u32 s13, s13, s80
s_lshl_b32 s78, s13, 7
s_lshl_b32 s79, s13, 19
s_add_u32 m0, s10, 0x15000
s_add_u32 s15, s78, 0x0
buffer_load_dwordx4 v250, s[44:47], s15 offen offset:0 lds
s_add_u32 m0, s10, 0x16000
s_add_u32 s15, s78, 0xa000
buffer_load_dwordx4 v250, s[44:47], s15 offen offset:0 lds
s_add_u32 m0, s10, 0x17000
s_add_u32 s15, s78, 0x14000
buffer_load_dwordx4 v250, s[44:47], s15 offen offset:0 lds
s_add_u32 m0, s11, 0x18000
s_add_u32 s15, s79, 0x0
buffer_load_dwordx4 v251, s[48:51], s15 offen offset:0 lds
s_waitcnt vmcnt(12)
s_barrier
s_add_u32 m0, s11, 0x18800
s_add_u32 s15, s79, 0x8000
buffer_load_dwordx4 v251, s[48:51], s15 offen offset:0 lds
s_add_u32 m0, s11, 0x1a000
s_add_u32 s15, s79, 0x20000
buffer_load_dwordx4 v251, s[48:51], s15 offen offset:0 lds
s_add_u32 m0, s11, 0x1a800
s_add_u32 s15, s79, 0x28000
buffer_load_dwordx4 v251, s[48:51], s15 offen offset:0 lds
s_add_u32 m0, s11, 0x1c000
s_add_u32 s15, s79, 0x40000
buffer_load_dwordx4 v251, s[48:51], s15 offen offset:0 lds
s_add_u32 m0, s11, 0x1c800
s_add_u32 s15, s79, 0x48000
buffer_load_dwordx4 v251, s[48:51], s15 offen offset:0 lds
s_add_u32 m0, s11, 0x1e000
s_add_u32 s15, s79, 0x60000
buffer_load_dwordx4 v251, s[48:51], s15 offen offset:0 lds
s_add_u32 m0, s11, 0x1e800
s_add_u32 s15, s79, 0x68000
buffer_load_dwordx4 v251, s[48:51], s15 offen offset:0 lds
s_waitcnt vmcnt(15)
s_barrier
s_cmp_ge_u32 s80, 3
s_cselect_b32 s13, -3, 7
s_add_u32 s13, s13, s80
s_lshl_b32 s78, s13, 7
s_lshl_b32 s79, s13, 19
s_add_u32 m0, s10, 0xf000
s_add_u32 s15, s78, 0x0
buffer_load_dwordx4 v250, s[44:47], s15 offen offset:0 lds
s_add_u32 m0, s10, 0x10000
s_add_u32 s15, s78, 0xa000
buffer_load_dwordx4 v250, s[44:47], s15 offen offset:0 lds
s_add_u32 m0, s10, 0x11000
s_add_u32 s15, s78, 0x14000
buffer_load_dwordx4 v250, s[44:47], s15 offen offset:0 lds
s_add_u32 m0, s11, 0x20000
s_add_u32 s15, s79, 0x0
buffer_load_dwordx4 v251, s[48:51], s15 offen offset:0 lds
s_add_u32 m0, s11, 0x20800
s_add_u32 s15, s79, 0x8000
buffer_load_dwordx4 v251, s[48:51], s15 offen offset:0 lds
s_add_u32 m0, s11, 0x22000
s_add_u32 s15, s79, 0x20000
buffer_load_dwordx4 v251, s[48:51], s15 offen offset:0 lds
s_add_u32 m0, s11, 0x22800
s_add_u32 s15, s79, 0x28000
buffer_load_dwordx4 v251, s[48:51], s15 offen offset:0 lds
s_waitcnt vmcnt(11)
s_barrier
s_add_u32 m0, s11, 0x24000
s_add_u32 s15, s79, 0x40000
buffer_load_dwordx4 v251, s[48:51], s15 offen offset:0 lds
s_add_u32 m0, s11, 0x24800
s_add_u32 s15, s79, 0x48000
buffer_load_dwordx4 v251, s[48:51], s15 offen offset:0 lds
s_add_u32 m0, s11, 0x26000
s_add_u32 s15, s79, 0x60000
buffer_load_dwordx4 v251, s[48:51], s15 offen offset:0 lds
s_add_u32 m0, s11, 0x26800
s_add_u32 s15, s79, 0x68000
buffer_load_dwordx4 v251, s[48:51], s15 offen offset:0 lds
s_cmp_ge_u32 s80, 2
s_cselect_b32 s13, -2, 8
s_add_u32 s13, s13, s80
s_lshl_b32 s78, s13, 7
s_lshl_b32 s79, s13, 19
s_add_u32 m0, s10, 0xc000
s_add_u32 s15, s78, 0x0
buffer_load_dwordx4 v250, s[44:47], s15 offen offset:0 lds
s_add_u32 m0, s10, 0xd000
s_add_u32 s15, s78, 0xa000
buffer_load_dwordx4 v250, s[44:47], s15 offen offset:0 lds
s_add_u32 m0, s10, 0xe000
s_add_u32 s15, s78, 0x14000
buffer_load_dwordx4 v250, s[44:47], s15 offen offset:0 lds
s_waitcnt vmcnt(14)
s_barrier
s_add_u32 m0, s11, 0x18000
s_add_u32 s15, s79, 0x0
buffer_load_dwordx4 v251, s[48:51], s15 offen offset:0 lds
s_add_u32 m0, s11, 0x18800
s_add_u32 s15, s79, 0x8000
buffer_load_dwordx4 v251, s[48:51], s15 offen offset:0 lds
s_add_u32 m0, s11, 0x1a000
s_add_u32 s15, s79, 0x20000
buffer_load_dwordx4 v251, s[48:51], s15 offen offset:0 lds
s_add_u32 m0, s11, 0x1a800
s_add_u32 s15, s79, 0x28000
buffer_load_dwordx4 v251, s[48:51], s15 offen offset:0 lds
s_waitcnt vmcnt(11)
s_barrier
s_add_u32 m0, s11, 0x1c000
s_add_u32 s15, s79, 0x40000
buffer_load_dwordx4 v251, s[48:51], s15 offen offset:0 lds
s_add_u32 m0, s11, 0x1c800
s_add_u32 s15, s79, 0x48000
buffer_load_dwordx4 v251, s[48:51], s15 offen offset:0 lds
s_add_u32 m0, s11, 0x1e000
s_add_u32 s15, s79, 0x60000
buffer_load_dwordx4 v251, s[48:51], s15 offen offset:0 lds
s_add_u32 m0, s11, 0x1e800
s_add_u32 s15, s79, 0x68000
buffer_load_dwordx4 v251, s[48:51], s15 offen offset:0 lds
s_add_u32 m0, s10, 0x12000
s_mov_b32 s15, 0x0
buffer_load_dwordx4 v248, s[56:59], s15 offen offset:0 nt lds
s_add_u32 m0, s10, 0x13000
s_mov_b32 s15, 0x2000
buffer_load_dwordx4 v248, s[56:59], s15 offen offset:0 nt lds
s_add_u32 m0, s10, 0x14000
s_mov_b32 s15, 0x4000
buffer_load_dwordx4 v248, s[56:59], s15 offen offset:0 nt lds
s_waitcnt vmcnt(14)
s_barrier
s_add_u32 m0, s10, 0x15000
s_mov_b32 s15, 0x6000
buffer_load_dwordx4 v248, s[56:59], s15 offen offset:0 nt lds
s_add_u32 m0, s10, 0x16000
s_mov_b32 s15, 0x8000
buffer_load_dwordx4 v248, s[56:59], s15 offen offset:0 nt lds
s_add_u32 m0, s10, 0x17000
s_mov_b32 s15, 0xa000
buffer_load_dwordx4 v248, s[56:59], s15 offen offset:0 nt lds
s_waitcnt vmcnt(10)
s_barrier
s_cmp_ge_u32 s80, 1
s_cselect_b32 s13, -1, 9
s_add_u32 s13, s13, s80
s_lshl_b32 s78, s13, 7
s_lshl_b32 s79, s13, 19
s_add_u32 m0, s10, 0xf000
s_add_u32 s15, s78, 0x0
buffer_load_dwordx4 v250, s[44:47], s15 offen offset:0 lds
s_add_u32 m0, s10, 0x10000
s_add_u32 s15, s78, 0xa000
buffer_load_dwordx4 v250, s[44:47], s15 offen offset:0 lds
s_add_u32 m0, s10, 0x11000
s_add_u32 s15, s78, 0x14000
buffer_load_dwordx4 v250, s[44:47], s15 offen offset:0 lds
s_add_u32 m0, s11, 0x20000
s_add_u32 s15, s79, 0x0
buffer_load_dwordx4 v251, s[48:51], s15 offen offset:0 lds
s_add_u32 m0, s11, 0x20800
s_add_u32 s15, s79, 0x8000
buffer_load_dwordx4 v251, s[48:51], s15 offen offset:0 lds
s_add_u32 m0, s11, 0x22000
s_add_u32 s15, s79, 0x20000
buffer_load_dwordx4 v251, s[48:51], s15 offen offset:0 lds
s_add_u32 m0, s11, 0x22800
s_add_u32 s15, s79, 0x28000
buffer_load_dwordx4 v251, s[48:51], s15 offen offset:0 lds
s_add_u32 m0, s11, 0x24000
s_add_u32 s15, s79, 0x40000
buffer_load_dwordx4 v251, s[48:51], s15 offen offset:0 lds
s_add_u32 m0, s11, 0x24800
s_add_u32 s15, s79, 0x48000
buffer_load_dwordx4 v251, s[48:51], s15 offen offset:0 lds
s_add_u32 m0, s11, 0x26000
s_add_u32 s15, s79, 0x60000
buffer_load_dwordx4 v251, s[48:51], s15 offen offset:0 lds
s_add_u32 m0, s11, 0x26800
s_add_u32 s15, s79, 0x68000
buffer_load_dwordx4 v251, s[48:51], s15 offen offset:0 lds
s_waitcnt vmcnt(17)
s_branch L_join
L_var5:
s_cmp_ge_u32 s80, 9
s_cselect_b32 s13, -9, 1
s_add_u32 s13, s13, s80
s_lshl_b32 s78, s13, 7
s_lshl_b32 s79, s13, 19
s_add_u32 m0, s10, 0xf000
s_add_u32 s15, s78, 0x0
buffer_load_dwordx4 v250, s[44:47], s15 offen offset:0 lds
s_add_u32 m0, s10, 0x10000
s_add_u32 s15, s78, 0xa000
buffer_load_dwordx4 v250, s[44:47], s15 offen offset:0 lds
s_add_u32 m0, s10, 0x11000
s_add_u32 s15, s78, 0x14000
buffer_load_dwordx4 v250, s[44:47], s15 offen offset:0 lds
s_waitcnt vmcnt(7)
s_barrier
s_add_u32 m0, s11, 0x20000
s_add_u32 s15, s79, 0x0
buffer_load_dwordx4 v251, s[48:51], s15 offen offset:0 lds
s_add_u32 m0, s11, 0x20800
s_add_u32 s15, s79, 0x8000
buffer_load_dwordx4 v251, s[48:51], s15 offen offset:0 lds
s_add_u32 m0, s11, 0x22000
s_add_u32 s15, s79, 0x20000
buffer_load_dwordx4 v251, s[48:51], s15 offen offset:0 lds
s_add_u32 m0, s11, 0x22800
s_add_u32 s15, s79, 0x28000
buffer_load_dwordx4 v251, s[48:51], s15 offen offset:0 lds
s_add_u32 m0, s10, 0x0
s_mov_b32 s15, 0x0
buffer_load_dwordx4 v249, s[52:55], s15 offen offset:0 nt lds
s_add_u32 m0, s10, 0x1000
s_mov_b32 s15, 0x1000
buffer_load_dwordx4 v249, s[52:55], s15 offen offset:0 nt lds
s_add_u32 m0, s10, 0x2000
s_mov_b32 s15, 0x2000
buffer_load_dwordx4 v249, s[52:55], s15 offen offset:0 nt lds
s_waitcnt vmcnt(10)
s_barrier
s_add_u32 m0, s10, 0x3000
s_mov_b32 s15, 0x3000
buffer_load_dwordx4 v249, s[52:55], s15 offen offset:0 nt lds
s_add_u32 m0, s10, 0x4000
s_mov_b32 s15, 0x4000
buffer_load_dwordx4 v249, s[52:55], s15 offen offset:0 nt lds
s_add_u32 m0, s10, 0x5000
s_mov_b32 s15, 0x5000
buffer_load_dwordx4 v249, s[52:55], s15 offen offset:0 nt lds
s_add_u32 m0, s10, 0x6000
s_mov_b32 s15, 0x6000
buffer_load_dwordx4 v249, s[52:55], s15 offen offset:0 nt lds
s_add_u32 m0, s10, 0x7000
s_mov_b32 s15, 0x7000
buffer_load_dwordx4 v249, s[52:55], s15 offen offset:0 nt lds
s_add_u32 m0, s11, 0x24000
s_add_u32 s15, s79, 0x40000
buffer_load_dwordx4 v251, s[48:51], s15 offen offset:0 lds
s_add_u32 m0, s11, 0x24800
s_add_u32 s15, s79, 0x48000
buffer_load_dwordx4 v251, s[48:51], s15 offen offset:0 lds
s_waitcnt vmcnt(10)
s_barrier
s_add_u32 m0, s11, 0x26000
s_add_u32 s15, s79, 0x60000
buffer_load_dwordx4 v251, s[48:51], s15 offen offset:0 lds
s_add_u32 m0, s11, 0x26800
s_add_u32 s15, s79, 0x68000
buffer_load_dwordx4 v251, s[48:51], s15 offen offset:0 lds
s_cmp_ge_u32 s80, 8
s_cselect_b32 s13, -8, 2
s_add_u32 s13, s13, s80
s_lshl_b32 s78, s13, 7
s_lshl_b32 s79, s13, 19
s_add_u32 m0, s10, 0x12000
s_add_u32 s15, s78, 0x0
buffer_load_dwordx4 v250, s[44:47], s15 offen offset:0 lds
s_add_u32 m0, s10, 0x13000
s_add_u32 s15, s78, 0xa000
buffer_load_dwordx4 v250, s[44:47], s15 offen offset:0 lds
s_add_u32 m0, s10, 0x14000
s_add_u32 s15, s78, 0x14000
buffer_load_dwordx4 v250, s[44:47], s15 offen offset:0 lds
s_add_u32 m0, s11, 0x18000
s_add_u32 s15, s79, 0x0
buffer_load_dwordx4 v251, s[48:51], s15 offen offset:0 lds
s_add_u32 m0, s11, 0x18800
s_add_u32 s15, s79, 0x8000
buffer_load_dwordx4 v251, s[48:51], s15 offen offset:0 lds
s_waitcnt vmcnt(5)
s_barrier
s_add_u32 m0, s11, 0x1a000
s_add_u32 s15, s79, 0x20000
buffer_load_dwordx4 v251, s[48:51], s15 offen offset:0 lds
s_add_u32 m0, s11, 0x1a800
s_add_u32 s15, s79, 0x28000
buffer_load_dwordx4 v251, s[48:51], s15 offen offset:0 lds
s_add_u32 m0, s11, 0x1c000
s_add_u32 s15, s79, 0x40000
buffer_load_dwordx4 v251, s[48:51], s15 offen offset:0 lds
s_add_u32 m0, s11, 0x1c800
s_add_u32 s15, s79, 0x48000
buffer_load_dwordx4 v251, s[48:51], s15 offen offset:0 lds
s_add_u32 m0, s11, 0x1e000
s_add_u32 s15, s79, 0x60000
buffer_load_dwordx4 v251, s[48:51], s15 offen offset:0 lds
s_add_u32 m0, s11, 0x1e800
s_add_u32 s15, s79, 0x68000
buffer_load_dwordx4 v251, s[48:51], s15 offen offset:0 lds
s_mov_b32 s15, 0x1e000
buffer_load_dword v246, v247, s[60:63], s15 offen
s_waitcnt vmcnt(5)
s_barrier
s_mov_b32 s15, 0x14000
buffer_load_dword v246, v247, s[60:63], s15 offen
s_cmp_ge_u32 s80, 7
s_cselect_b32 s13, -7, 3
s_add_u32 s13, s13, s80
s_lshl_b32 s78, s13, 7
s_lshl_b32 s79, s13, 19
s_add_u32 m0, s10, 0x15000
s_add_u32 s15, s78, 0x0
buffer_load_dwordx4 v250, s[44:47], s15 offen offset:0 lds
s_add_u32 m0, s10, 0x16000
s_add_u32 s15, s78, 0xa000
buffer_load_dwordx4 v250, s[44:47], s15 offen offset:0 lds
s_add_u32 m0, s10, 0x17000
s_add_u32 s15, s78, 0x14000
buffer_load_dwordx4 v250, s[44:47], s15 offen offset:0 lds
s_add_u32 m0, s11, 0x20000
s_add_u32 s15, s79, 0x0
buffer_load_dwordx4 v251, s[48:51], s15 offen offset:0 lds
s_add_u32 m0, s11, 0x20800
s_add_u32 s15, s79, 0x8000
buffer_load_dwordx4 v251, s[48:51], s15 offen offset:0 lds
s_add_u32 m0, s11, 0x22000
s_add_u32 s15, s79, 0x20000
buffer_load_dwordx4 v251, s[48:51], s15 offen offset:0 lds
s_waitcnt vmcnt(8)
s_barrier
s_add_u32 m0, s11, 0x22800
s_add_u32 s15, s79, 0x28000
buffer_load_dwordx4 v251, s[48:51], s15 offen offset:0 lds
s_add_u32 m0, s11, 0x24000
s_add_u32 s15, s79, 0x40000
buffer_load_dwordx4 v251, s[48:51], s15 offen offset:0 lds
s_add_u32 m0, s11, 0x24800
s_add_u32 s15, s79, 0x48000
buffer_load_dwordx4 v251, s[48:51], s15 offen offset:0 lds
s_add_u32 m0, s11, 0x26000
s_add_u32 s15, s79, 0x60000
buffer_load_dwordx4 v251, s[48:51], s15 offen offset:0 lds
s_add_u32 m0, s11, 0x26800
s_add_u32 s15, s79, 0x68000
buffer_load_dwordx4 v251, s[48:51], s15 offen offset:0 lds
s_cmp_ge_u32 s80, 6
s_cselect_b32 s13, -6, 4
s_add_u32 s13, s13, s80
s_lshl_b32 s78, s13, 7
s_lshl_b32 s79, s13, 19
s_add_u32 m0, s10, 0xc000
s_add_u32 s15, s78, 0x0
buffer_load_dwordx4 v250, s[44:47], s15 offen offset:0 lds
s_add_u32 m0, s10, 0xd000
s_add_u32 s15, s78, 0xa000
buffer_load_dwordx4 v250, s[44:47], s15 offen offset:0 lds
s_waitcnt vmcnt(6)
s_barrier
s_add_u32 m0, s10, 0xe000
s_add_u32 s15, s78, 0x14000
buffer_load_dwordx4 v250, s[44:47], s15 offen offset:0 lds
s_add_u32 m0, s11, 0x18000
s_add_u32 s15, s79, 0x0
buffer_load_dwordx4 v251, s[48:51], s15 offen offset:0 lds
s_add_u32 m0, s11, 0x18800
s_add_u32 s15, s79, 0x8000
buffer_load_dwordx4 v251, s[48:51], s15 offen offset:0 lds
s_add_u32 m0, s11, 0x1a000
s_add_u32 s15, s79, 0x20000
buffer_load_dwordx4 v251, s[48:51], s15 offen offset:0 lds
s_add_u32 m0, s11, 0x1a800
s_add_u32 s15, s79, 0x28000
buffer_load_dwordx4 v251, s[48:51], s15 offen offset:0 lds
s_add_u32 m0, s10, 0x8000
s_mov_b32 s15, 0x8000
buffer_load_dwordx4 v249, s[52:55], s15 offen offset:0 nt lds
s_add_u32 m0, s10, 0x9000
s_mov_b32 s15, 0x9000
buffer_load_dwordx4 v249, s[52:55], s15 offen offset:0 nt lds
s_waitcnt vmcnt(9)
s_barrier
s_add_u32 m0, s10, 0xa000
s_mov_b32 s15, 0xa000
buffer_load_dwordx4 v249, s[52:55], s15 offen offset:0 nt lds
s_add_u32 m0, s10, 0xb000
s_mov_b32 s15, 0xb000
buffer_load_dwordx4 v249, s[52:55], s15 offen offset:0 nt lds
s_add_u32 m0, s11, 0x1c000
s_add_u32 s15, s79, 0x40000
buffer_load_dwordx4 v251, s[48:51], s15 offen offset:0 lds
s_add_u32 m0, s11, 0x1c800
s_add_u32 s15, s79, 0x48000
buffer_load_dwordx4 v251, s[48:51], s15 offen offset:0 lds
s_add_u32 m0, s11, 0x1e000
s_add_u32 s15, s79, 0x60000
buffer_load_dwordx4 v251, s[48:51], s15 offen offset:0 lds
s_add_u32 m0, s11, 0x1e800
s_add_u32 s15, s79, 0x68000
buffer_load_dwordx4 v251, s[48:51], s15 offen offset:0 lds
s_cmp_ge_u32 s80, 3
s_cselect_b32 s13, -3, 7
s_add_u32 s13, s13, s80
s_lshl_b32 s78, s13, 7
s_lshl_b32 s79, s13, 19
s_add_u32 m0, s10, 0x12000
s_add_u32 s15, s78, 0x0
buffer_load_dwordx4 v250, s[44:47], s15 offen offset:0 lds
s_waitcnt vmcnt(9)
s_barrier
s_add_u32 m0, s10, 0x13000
s_add_u32 s15, s78, 0xa000
buffer_load_dwordx4 v250, s[44:47], s15 offen offset:0 lds
s_add_u32 m0, s10, 0x14000
s_add_u32 s15, s78, 0x14000
buffer_load_dwordx4 v250, s[44:47], s15 offen offset:0 lds
s_add_u32 m0, s11, 0x20000
s_add_u32 s15, s79, 0x0
buffer_load_dwordx4 v251, s[48:51], s15 offen offset:0 lds
s_add_u32 m0, s11, 0x20800
s_add_u32 s15, s79, 0x8000
buffer_load_dwordx4 v251, s[48:51], s15 offen offset:0 lds
s_add_u32 m0, s11, 0x22000
s_add_u32 s15, s79, 0x20000
buffer_load_dwordx4 v251, s[48:51], s15 offen offset:0 lds
s_add_u32 m0, s11, 0x22800
s_add_u32 s15, s79, 0x28000
buffer_load_dwordx4 v251, s[48:51], s15 offen offset:0 lds
s_add_u32 m0, s11, 0x24000
s_add_u32 s15, s79, 0x40000
buffer_load_dwordx4 v251, s[48:51], s15 offen offset:0 lds
s_waitcnt vmcnt(8)
s_barrier
s_add_u32 m0, s11, 0x24800
s_add_u32 s15, s79, 0x48000
buffer_load_dwordx4 v251, s[48:51], s15 offen offset:0 lds
s_add_u32 m0, s11, 0x26000
s_add_u32 s15, s79, 0x60000
buffer_load_dwordx4 v251, s[48:51], s15 offen offset:0 lds
s_add_u32 m0, s11, 0x26800
s_add_u32 s15, s79, 0x68000
buffer_load_dwordx4 v251, s[48:51], s15 offen offset:0 lds
s_cmp_ge_u32 s80, 5
s_cselect_b32 s13, -5, 5
s_add_u32 s13, s13, s80
s_lshl_b32 s78, s13, 7
s_lshl_b32 s79, s13, 19
s_add_u32 m0, s10, 0x15000
s_add_u32 s15, s78, 0x0
buffer_load_dwordx4 v250, s[44:47], s15 offen offset:0 lds
s_add_u32 m0, s10, 0x16000
s_add_u32 s15, s78, 0xa000
buffer_load_dwordx4 v250, s[44:47], s15 offen offset:0 lds
s_add_u32 m0, s10, 0x17000
s_add_u32 s15, s78, 0x14000
buffer_load_dwordx4 v250, s[44:47], s15 offen offset:0 lds
s_add_u32 m0, s11, 0x18000
s_add_u32 s15, s79, 0x0
buffer_load_dwordx4 v251, s[48:51], s15 offen offset:0 lds
s_waitcnt vmcnt(8)
s_barrier
s_add_u32 m0, s11, 0x18800
s_add_u32 s15, s79, 0x8000
buffer_load_dwordx4 v251, s[48:51], s15 offen offset:0 lds
s_add_u32 m0, s11, 0x1a000
s_add_u32 s15, s79, 0x20000
buffer_load_dwordx4 v251, s[48:51], s15 offen offset:0 lds
s_add_u32 m0, s11, 0x1a800
s_add_u32 s15, s79, 0x28000
buffer_load_dwordx4 v251, s[48:51], s15 offen offset:0 lds
s_add_u32 m0, s11, 0x1c000
s_add_u32 s15, s79, 0x40000
buffer_load_dwordx4 v251, s[48:51], s15 offen offset:0 lds
s_add_u32 m0, s11, 0x1c800
s_add_u32 s15, s79, 0x48000
buffer_load_dwordx4 v251, s[48:51], s15 offen offset:0 lds
s_add_u32 m0, s11, 0x1e000
s_add_u32 s15, s79, 0x60000
buffer_load_dwordx4 v251, s[48:51], s15 offen offset:0 lds
s_add_u32 m0, s11, 0x1e800
s_add_u32 s15, s79, 0x68000
buffer_load_dwordx4 v251, s[48:51], s15 offen offset:0 lds
s_waitcnt vmcnt(11)
s_barrier
s_cmp_ge_u32 s80, 4
s_cselect_b32 s13, -4, 6
s_add_u32 s13, s13, s80
s_lshl_b32 s78, s13, 7
s_lshl_b32 s79, s13, 19
s_add_u32 m0, s10, 0xf000
s_add_u32 s15, s78, 0x0
buffer_load_dwordx4 v250, s[44:47], s15 offen offset:0 lds
s_add_u32 m0, s10, 0x10000
s_add_u32 s15, s78, 0xa000
buffer_load_dwordx4 v250, s[44:47], s15 offen offset:0 lds
s_add_u32 m0, s10, 0x11000
s_add_u32 s15, s78, 0x14000
buffer_load_dwordx4 v250, s[44:47], s15 offen offset:0 lds
s_add_u32 m0, s11, 0x20000
s_add_u32 s15, s79, 0x0
buffer_load_dwordx4 v251, s[48:51], s15 offen offset:0 lds
s_add_u32 m0, s11, 0x20800
s_add_u32 s15, s79, 0x8000
buffer_load_dwordx4 v251, s[48:51], s15 offen offset:0 lds
s_add_u32 m0, s11, 0x22000
s_add_u32 s15, s79, 0x20000
buffer_load_dwordx4 v251, s[48:51], s15 offen offset:0 lds
s_add_u32 m0, s11, 0x22800
s_add_u32 s15, s79, 0x28000
buffer_load_dwordx4 v251, s[48:51], s15 offen offset:0 lds
s_waitcnt vmcnt(11)
s_barrier
s_add_u32 m0, s11, 0x24000
s_add_u32 s15, s79, 0x40000
buffer_load_dwordx4 v251, s[48:51], s15 offen offset:0 lds
s_add_u32 m0, s11, 0x24800
s_add_u32 s15, s79, 0x48000
buffer_load_dwordx4 v251, s[48:51], s15 offen offset:0 lds
s_add_u32 m0, s11, 0x26000
s_add_u32 s15, s79, 0x60000
buffer_load_dwordx4 v251, s[48:51], s15 offen offset:0 lds
s_add_u32 m0, s11, 0x26800
s_add_u32 s15, s79, 0x68000
buffer_load_dwordx4 v251, s[48:51], s15 offen offset:0 lds
s_cmp_ge_u32 s80, 2
s_cselect_b32 s13, -2, 8
s_add_u32 s13, s13, s80
s_lshl_b32 s78, s13, 7
s_lshl_b32 s79, s13, 19
s_add_u32 m0, s10, 0xc000
s_add_u32 s15, s78, 0x0
buffer_load_dwordx4 v250, s[44:47], s15 offen offset:0 lds
s_add_u32 m0, s10, 0xd000
s_add_u32 s15, s78, 0xa000
buffer_load_dwordx4 v250, s[44:47], s15 offen offset:0 lds
s_add_u32 m0, s10, 0xe000
s_add_u32 s15, s78, 0x14000
buffer_load_dwordx4 v250, s[44:47], s15 offen offset:0 lds
s_waitcnt vmcnt(14)
s_barrier
s_add_u32 m0, s11, 0x18000
s_add_u32 s15, s79, 0x0
buffer_load_dwordx4 v251, s[48:51], s15 offen offset:0 lds
s_add_u32 m0, s11, 0x18800
s_add_u32 s15, s79, 0x8000
buffer_load_dwordx4 v251, s[48:51], s15 offen offset:0 lds
s_add_u32 m0, s11, 0x1a000
s_add_u32 s15, s79, 0x20000
buffer_load_dwordx4 v251, s[48:51], s15 offen offset:0 lds
s_add_u32 m0, s11, 0x1a800
s_add_u32 s15, s79, 0x28000
buffer_load_dwordx4 v251, s[48:51], s15 offen offset:0 lds
s_add_u32 m0, s10, 0x12000
s_mov_b32 s15, 0x0
buffer_load_dwordx4 v248, s[56:59], s15 offen offset:0 nt lds
s_add_u32 m0, s10, 0x13000
s_mov_b32 s15, 0x2000
buffer_load_dwordx4 v248, s[56:59], s15 offen offset:0 nt lds
s_add_u32 m0, s10, 0x14000
s_mov_b32 s15, 0x4000
buffer_load_dwordx4 v248, s[56:59], s15 offen offset:0 nt lds
s_waitcnt vmcnt(14)
s_barrier
s_add_u32 m0, s10, 0x15000
s_mov_b32 s15, 0x6000
buffer_load_dwordx4 v248, s[56:59], s15 offen offset:0 nt lds
s_add_u32 m0, s10, 0x16000
s_mov_b32 s15, 0x8000
buffer_load_dwordx4 v248, s[56:59], s15 offen offset:0 nt lds
s_add_u32 m0, s10, 0x17000
s_mov_b32 s15, 0xa000
buffer_load_dwordx4 v248, s[56:59], s15 offen offset:0 nt lds
s_add_u32 m0, s11, 0x1c000
s_add_u32 s15, s79, 0x40000
buffer_load_dwordx4 v251, s[48:51], s15 offen offset:0 lds
s_add_u32 m0, s11, 0x1c800
s_add_u32 s15, s79, 0x48000
buffer_load_dwordx4 v251, s[48:51], s15 offen offset:0 lds
s_add_u32 m0, s11, 0x1e000
s_add_u32 s15, s79, 0x60000
buffer_load_dwordx4 v251, s[48:51], s15 offen offset:0 lds
s_add_u32 m0, s11, 0x1e800
s_add_u32 s15, s79, 0x68000
buffer_load_dwordx4 v251, s[48:51], s15 offen offset:0 lds
s_waitcnt vmcnt(17)
s_barrier
s_waitcnt vmcnt(10)
s_barrier
s_cmp_ge_u32 s80, 1
s_cselect_b32 s13, -1, 9
s_add_u32 s13, s13, s80
s_lshl_b32 s78, s13, 7
s_lshl_b32 s79, s13, 19
s_add_u32 m0, s10, 0xf000
s_add_u32 s15, s78, 0x0
buffer_load_dwordx4 v250, s[44:47], s15 offen offset:0 lds
s_add_u32 m0, s10, 0x10000
s_add_u32 s15, s78, 0xa000
buffer_load_dwordx4 v250, s[44:47], s15 offen offset:0 lds
s_add_u32 m0, s10, 0x11000
s_add_u32 s15, s78, 0x14000
buffer_load_dwordx4 v250, s[44:47], s15 offen offset:0 lds
s_add_u32 m0, s11, 0x20000
s_add_u32 s15, s79, 0x0
buffer_load_dwordx4 v251, s[48:51], s15 offen offset:0 lds
s_add_u32 m0, s11, 0x20800
s_add_u32 s15, s79, 0x8000
buffer_load_dwordx4 v251, s[48:51], s15 offen offset:0 lds
s_add_u32 m0, s11, 0x22000
s_add_u32 s15, s79, 0x20000
buffer_load_dwordx4 v251, s[48:51], s15 offen offset:0 lds
s_add_u32 m0, s11, 0x22800
s_add_u32 s15, s79, 0x28000
buffer_load_dwordx4 v251, s[48:51], s15 offen offset:0 lds
s_add_u32 m0, s11, 0x24000
s_add_u32 s15, s79, 0x40000
buffer_load_dwordx4 v251, s[48:51], s15 offen offset:0 lds
s_add_u32 m0, s11, 0x24800
s_add_u32 s15, s79, 0x48000
buffer_load_dwordx4 v251, s[48:51], s15 offen offset:0 lds
s_add_u32 m0, s11, 0x26000
s_add_u32 s15, s79, 0x60000
buffer_load_dwordx4 v251, s[48:51], s15 offen offset:0 lds
s_add_u32 m0, s11, 0x26800
s_add_u32 s15, s79, 0x68000
buffer_load_dwordx4 v251, s[48:51], s15 offen offset:0 lds
s_waitcnt vmcnt(11)
s_branch L_join
L_var6:
s_cmp_ge_u32 s80, 9
s_cselect_b32 s13, -9, 1
s_add_u32 s13, s13, s80
s_lshl_b32 s78, s13, 7
s_lshl_b32 s79, s13, 19
s_add_u32 m0, s10, 0xf000
s_add_u32 s15, s78, 0x0
buffer_load_dwordx4 v250, s[44:47], s15 offen offset:0 lds
s_add_u32 m0, s10, 0x10000
s_add_u32 s15, s78, 0xa000
buffer_load_dwordx4 v250, s[44:47], s15 offen offset:0 lds
s_add_u32 m0, s10, 0x11000
s_add_u32 s15, s78, 0x14000
buffer_load_dwordx4 v250, s[44:47], s15 offen offset:0 lds
s_waitcnt vmcnt(7)
s_barrier
s_add_u32 m0, s11, 0x20000
s_add_u32 s15, s79, 0x0
buffer_load_dwordx4 v251, s[48:51], s15 offen offset:0 lds
s_add_u32 m0, s11, 0x20800
s_add_u32 s15, s79, 0x8000
buffer_load_dwordx4 v251, s[48:51], s15 offen offset:0 lds
s_add_u32 m0, s11, 0x22000
s_add_u32 s15, s79, 0x20000
buffer_load_dwordx4 v251, s[48:51], s15 offen offset:0 lds
s_add_u32 m0, s11, 0x22800
s_add_u32 s15, s79, 0x28000
buffer_load_dwordx4 v251, s[48:51], s15 offen offset:0 lds
s_add_u32 m0, s11, 0x24000
s_add_u32 s15, s79, 0x40000
buffer_load_dwordx4 v251, s[48:51], s15 offen offset:0 lds
s_add_u32 m0, s11, 0x24800
s_add_u32 s15, s79, 0x48000
buffer_load_dwordx4 v251, s[48:51], s15 offen offset:0 lds
s_add_u32 m0, s11, 0x26000
s_add_u32 s15, s79, 0x60000
buffer_load_dwordx4 v251, s[48:51], s15 offen offset:0 lds
s_waitcnt vmcnt(10)
s_barrier
s_add_u32 m0, s11, 0x26800
s_add_u32 s15, s79, 0x68000
buffer_load_dwordx4 v251, s[48:51], s15 offen offset:0 lds
s_cmp_ge_u32 s80, 8
s_cselect_b32 s13, -8, 2
s_add_u32 s13, s13, s80
s_lshl_b32 s78, s13, 7
s_lshl_b32 s79, s13, 19
s_add_u32 m0, s10, 0x12000
s_add_u32 s15, s78, 0x0
buffer_load_dwordx4 v250, s[44:47], s15 offen offset:0 lds
s_add_u32 m0, s10, 0x13000
s_add_u32 s15, s78, 0xa000
buffer_load_dwordx4 v250, s[44:47], s15 offen offset:0 lds
s_add_u32 m0, s10, 0x14000
s_add_u32 s15, s78, 0x14000
buffer_load_dwordx4 v250, s[44:47], s15 offen offset:0 lds
s_add_u32 m0, s11, 0x18000
s_add_u32 s15, s79, 0x0
buffer_load_dwordx4 v251, s[48:51], s15 offen offset:0 lds
s_add_u32 m0, s11, 0x18800
s_add_u32 s15, s79, 0x8000
buffer_load_dwordx4 v251, s[48:51], s15 offen offset:0 lds
s_add_u32 m0, s11, 0x1a000
s_add_u32 s15, s79, 0x20000
buffer_load_dwordx4 v251, s[48:51], s15 offen offset:0 lds
s_waitcnt vmcnt(10)
s_barrier
s_add_u32 m0, s11, 0x1a800
s_add_u32 s15, s79, 0x28000
buffer_load_dwordx4 v251, s[48:51], s15 offen offset:0 lds
s_add_u32 m0, s10, 0x0
s_mov_b32 s15, 0x0
buffer_load_dwordx4 v249, s[52:55], s15 offen offset:0 nt lds
s_add_u32 m0, s10, 0x1000
s_mov_b32 s15, 0x1000
buffer_load_dwordx4 v249, s[52:55], s15 offen offset:0 nt lds
s_add_u32 m0, s10, 0x2000
s_mov_b32 s15, 0x2000
buffer_load_dwordx4 v249, s[52:55], s15 offen offset:0 nt lds
s_add_u32 m0, s10, 0x3000
s_mov_b32 s15, 0x3000
buffer_load_dwordx4 v249, s[52:55], s15 offen offset:0 nt lds
s_add_u32 m0, s10, 0x4000
s_mov_b32 s15, 0x4000
buffer_load_dwordx4 v249, s[52:55], s15 offen offset:0 nt lds
s_add_u32 m0, s10, 0x5000
s_mov_b32 s15, 0x5000
buffer_load_dwordx4 v249, s[52:55], s15 offen offset:0 nt lds
s_waitcnt vmcnt(13)
s_barrier
s_add_u32 m0, s10, 0x6000
s_mov_b32 s15, 0x6000
buffer_load_dwordx4 v249, s[52:55], s15 offen offset:0 nt lds
s_add_u32 m0, s10, 0x7000
s_mov_b32 s15, 0x7000
buffer_load_dwordx4 v249, s[52:55], s15 offen offset:0 nt lds
s_add_u32 m0, s11, 0x1c000
s_add_u32 s15, s79, 0x40000
buffer_load_dwordx4 v251, s[48:51], s15 offen offset:0 lds
s_add_u32 m0, s11, 0x1c800
s_add_u32 s15, s79, 0x48000
buffer_load_dwordx4 v251, s[48:51], s15 offen offset:0 lds
s_add_u32 m0, s11, 0x1e000
s_add_u32 s15, s79, 0x60000
buffer_load_dwordx4 v251, s[48:51], s15 offen offset:0 lds
s_add_u32 m0, s11, 0x1e800
s_add_u32 s15, s79, 0x68000
buffer_load_dwordx4 v251, s[48:51], s15 offen offset:0 lds
s_cmp_ge_u32 s80, 7
s_cselect_b32 s13, -7, 3
s_add_u32 s13, s13, s80
s_lshl_b32 s78, s13, 7
s_lshl_b32 s79, s13, 19
s_add_u32 m0, s10, 0x15000
s_add_u32 s15, s78, 0x0
buffer_load_dwordx4 v250, s[44:47], s15 offen offset:0 lds
s_waitcnt vmcnt(13)
s_barrier
s_add_u32 m0, s10, 0x16000
s_add_u32 s15, s78, 0xa000
buffer_load_dwordx4 v250, s[44:47], s15 offen offset:0 lds
s_add_u32 m0, s10, 0x17000
s_add_u32 s15, s78, 0x14000
buffer_load_dwordx4 v250, s[44:47], s15 offen offset:0 lds
s_add_u32 m0, s11, 0x20000
s_add_u32 s15, s79, 0x0
buffer_load_dwordx4 v251, s[48:51], s15 offen offset:0 lds
s_add_u32 m0, s11, 0x20800
s_add_u32 s15, s79, 0x8000
buffer_load_dwordx4 v251, s[48:51], s15 offen offset:0 lds
s_add_u32 m0, s11, 0x22000
s_add_u32 s15, s79, 0x20000
buffer_load_dwordx4 v251, s[48:51], s15 offen offset:0 lds
s_add_u32 m0, s11, 0x22800
s_add_u32 s15, s79, 0x28000
buffer_load_dwordx4 v251, s[48:51], s15 offen offset:0 lds
s_add_u32 m0, s11, 0x24000
s_add_u32 s15, s79, 0x40000
buffer_load_dwordx4 v251, s[48:51], s15 offen offset:0 lds
s_waitcnt vmcnt(8)
s_barrier
s_add_u32 m0, s11, 0x24800
s_add_u32 s15, s79, 0x48000
buffer_load_dwordx4 v251, s[48:51], s15 offen offset:0 lds
s_add_u32 m0, s11, 0x26000
s_add_u32 s15, s79, 0x60000
buffer_load_dwordx4 v251, s[48:51], s15 offen offset:0 lds
s_add_u32 m0, s11, 0x26800
s_add_u32 s15, s79, 0x68000
buffer_load_dwordx4 v251, s[48:51], s15 offen offset:0 lds
s_mov_b32 s15, 0x1e000
buffer_load_dword v246, v247, s[60:63], s15 offen
s_mov_b32 s15, 0x14000
buffer_load_dword v246, v247, s[60:63], s15 offen
s_cmp_ge_u32 s80, 6
s_cselect_b32 s13, -6, 4
s_add_u32 s13, s13, s80
s_lshl_b32 s78, s13, 7
s_lshl_b32 s79, s13, 19
s_add_u32 m0, s10, 0xc000
s_add_u32 s15, s78, 0x0
buffer_load_dwordx4 v250, s[44:47], s15 offen offset:0 lds
s_add_u32 m0, s10, 0xd000
s_add_u32 s15, s78, 0xa000
buffer_load_dwordx4 v250, s[44:47], s15 offen offset:0 lds
s_waitcnt vmcnt(8)
s_barrier
s_add_u32 m0, s10, 0xe000
s_add_u32 s15, s78, 0x14000
buffer_load_dwordx4 v250, s[44:47], s15 offen offset:0 lds
s_add_u32 m0, s11, 0x18000
s_add_u32 s15, s79, 0x0
buffer_load_dwordx4 v251, s[48:51], s15 offen offset:0 lds
s_add_u32 m0, s11, 0x18800
s_add_u32 s15, s79, 0x8000
buffer_load_dwordx4 v251, s[48:51], s15 offen offset:0 lds
s_add_u32 m0, s11, 0x1a000
s_add_u32 s15, s79, 0x20000
buffer_load_dwordx4 v251, s[48:51], s15 offen offset:0 lds
s_add_u32 m0, s11, 0x1a800
s_add_u32 s15, s79, 0x28000
buffer_load_dwordx4 v251, s[48:51], s15 offen offset:0 lds
s_add_u32 m0, s11, 0x1c000
s_add_u32 s15, s79, 0x40000
buffer_load_dwordx4 v251, s[48:51], s15 offen offset:0 lds
s_add_u32 m0, s11, 0x1c800
s_add_u32 s15, s79, 0x48000
buffer_load_dwordx4 v251, s[48:51], s15 offen offset:0 lds
s_waitcnt vmcnt(11)
s_barrier
s_add_u32 m0, s11, 0x1e000
s_add_u32 s15, s79, 0x60000
buffer_load_dwordx4 v251, s[48:51], s15 offen offset:0 lds
s_add_u32 m0, s11, 0x1e800
s_add_u32 s15, s79, 0x68000
buffer_load_dwordx4 v251, s[48:51], s15 offen offset:0 lds
s_cmp_ge_u32 s80, 5
s_cselect_b32 s13, -5, 5
s_add_u32 s13, s13, s80
s_lshl_b32 s78, s13, 7
s_lshl_b32 s79, s13, 19
s_add_u32 m0, s10, 0x12000
s_add_u32 s15, s78, 0x0
buffer_load_dwordx4 v250, s[44:47], s15 offen offset:0 lds
s_add_u32 m0, s10, 0x13000
s_add_u32 s15, s78, 0xa000
buffer_load_dwordx4 v250, s[44:47], s15 offen offset:0 lds
s_add_u32 m0, s10, 0x14000
s_add_u32 s15, s78, 0x14000
buffer_load_dwordx4 v250, s[44:47], s15 offen offset:0 lds
s_add_u32 m0, s11, 0x20000
s_add_u32 s15, s79, 0x0
buffer_load_dwordx4 v251, s[48:51], s15 offen offset:0 lds
s_add_u32 m0, s11, 0x20800
s_add_u32 s15, s79, 0x8000
buffer_load_dwordx4 v251, s[48:51], s15 offen offset:0 lds
s_waitcnt vmcnt(9)
s_barrier
s_add_u32 m0, s11, 0x22000
s_add_u32 s15, s79, 0x20000
buffer_load_dwordx4 v251, s[48:51], s15 offen offset:0 lds
s_add_u32 m0, s11, 0x22800
s_add_u32 s15, s79, 0x28000
buffer_load_dwordx4 v251, s[48:51], s15 offen offset:0 lds
s_add_u32 m0, s10, 0x8000
s_mov_b32 s15, 0x8000
buffer_load_dwordx4 v249, s[52:55], s15 offen offset:0 nt lds
s_add_u32 m0, s10, 0x9000
s_mov_b32 s15, 0x9000
buffer_load_dwordx4 v249, s[52:55], s15 offen offset:0 nt lds
s_add_u32 m0, s10, 0xa000
s_mov_b32 s15, 0xa000
buffer_load_dwordx4 v249, s[52:55], s15 offen offset:0 nt lds
s_add_u32 m0, s10, 0xb000
s_mov_b32 s15, 0xb000
buffer_load_dwordx4 v249, s[52:55], s15 offen offset:0 nt lds
s_add_u32 m0, s11, 0x24000
s_add_u32 s15, s79, 0x40000
buffer_load_dwordx4 v251, s[48:51], s15 offen offset:0 lds
s_waitcnt vmcnt(12)
s_barrier
s_add_u32 m0, s11, 0x24800
s_add_u32 s15, s79, 0x48000
buffer_load_dwordx4 v251, s[48:51], s15 offen offset:0 lds
s_add_u32 m0, s11, 0x26000
s_add_u32 s15, s79, 0x60000
buffer_load_dwordx4 v251, s[48:51], s15 offen offset:0 lds
s_add_u32 m0, s11, 0x26800
s_add_u32 s15, s79, 0x68000
buffer_load_dwordx4 v251, s[48:51], s15 offen offset:0 lds
s_cmp_ge_u32 s80, 2
s_cselect_b32 s13, -2, 8
s_add_u32 s13, s13, s80
s_lshl_b32 s78, s13, 7
s_lshl_b32 s79, s13, 19
s_add_u32 m0, s10, 0x15000
s_add_u32 s15, s78, 0x0
buffer_load_dwordx4 v250, s[44:47], s15 offen offset:0 lds
s_add_u32 m0, s10, 0x16000
s_add_u32 s15, s78, 0xa000
buffer_load_dwordx4 v250, s[44:47], s15 offen offset:0 lds
s_add_u32 m0, s10, 0x17000
s_add_u32 s15, s78, 0x14000
buffer_load_dwordx4 v250, s[44:47], s15 offen offset:0 lds
s_add_u32 m0, s11, 0x18000
s_add_u32 s15, s79, 0x0
buffer_load_dwordx4 v251, s[48:51], s15 offen offset:0 lds
s_waitcnt vmcnt(12)
s_barrier
s_add_u32 m0, s11, 0x18800
s_add_u32 s15, s79, 0x8000
buffer_load_dwordx4 v251, s[48:51], s15 offen offset:0 lds
s_add_u32 m0, s11, 0x1a000
s_add_u32 s15, s79, 0x20000
buffer_load_dwordx4 v251, s[48:51], s15 offen offset:0 lds
s_add_u32 m0, s11, 0x1a800
s_add_u32 s15, s79, 0x28000
buffer_load_dwordx4 v251, s[48:51], s15 offen offset:0 lds
s_add_u32 m0, s11, 0x1c000
s_add_u32 s15, s79, 0x40000
buffer_load_dwordx4 v251, s[48:51], s15 offen offset:0 lds
s_add_u32 m0, s11, 0x1c800
s_add_u32 s15, s79, 0x48000
buffer_load_dwordx4 v251, s[48:51], s15 offen offset:0 lds
s_add_u32 m0, s11, 0x1e000
s_add_u32 s15, s79, 0x60000
buffer_load_dwordx4 v251, s[48:51], s15 offen offset:0 lds
s_add_u32 m0, s11, 0x1e800
s_add_u32 s15, s79, 0x68000
buffer_load_dwordx4 v251, s[48:51], s15 offen offset:0 lds
s_waitcnt vmcnt(11)
s_barrier
s_cmp_ge_u32 s80, 4
s_cselect_b32 s13, -4, 6
s_add_u32 s13, s13, s80
s_lshl_b32 s78, s13, 7
s_lshl_b32 s79, s13, 19
s_add_u32 m0, s10, 0xf000
s_add_u32 s15, s78, 0x0
buffer_load_dwordx4 v250, s[44:47], s15 offen offset:0 lds
s_add_u32 m0, s10, 0x10000
s_add_u32 s15, s78, 0xa000
buffer_load_dwordx4 v250, s[44:47], s15 offen offset:0 lds
s_add_u32 m0, s10, 0x11000
s_add_u32 s15, s78, 0x14000
buffer_load_dwordx4 v250, s[44:47], s15 offen offset:0 lds
s_add_u32 m0, s11, 0x20000
s_add_u32 s15, s79, 0x0
buffer_load_dwordx4 v251, s[48:51], s15 offen offset:0 lds
s_add_u32 m0, s11, 0x20800
s_add_u32 s15, s79, 0x8000
buffer_load_dwordx4 v251, s[48:51], s15 offen offset:0 lds
s_add_u32 m0, s11, 0x22000
s_add_u32 s15, s79, 0x20000
buffer_load_dwordx4 v251, s[48:51], s15 offen offset:0 lds
s_add_u32 m0, s11, 0x22800
s_add_u32 s15, s79, 0x28000
buffer_load_dwordx4 v251, s[48:51], s15 offen offset:0 lds
s_waitcnt vmcnt(11)
s_barrier
s_add_u32 m0, s11, 0x24000
s_add_u32 s15, s79, 0x40000
buffer_load_dwordx4 v251, s[48:51], s15 offen offset:0 lds
s_add_u32 m0, s11, 0x24800
s_add_u32 s15, s79, 0x48000
buffer_load_dwordx4 v251, s[48:51], s15 offen offset:0 lds
s_add_u32 m0, s11, 0x26000
s_add_u32 s15, s79, 0x60000
buffer_load_dwordx4 v251, s[48:51], s15 offen offset:0 lds
s_add_u32 m0, s11, 0x26800
s_add_u32 s15, s79, 0x68000
buffer_load_dwordx4 v251, s[48:51], s15 offen offset:0 lds
s_cmp_ge_u32 s80, 3
s_cselect_b32 s13, -3, 7
s_add_u32 s13, s13, s80
s_lshl_b32 s78, s13, 7
s_lshl_b32 s79, s13, 19
s_add_u32 m0, s10, 0xc000
s_add_u32 s15, s78, 0x0
buffer_load_dwordx4 v250, s[44:47], s15 offen offset:0 lds
s_add_u32 m0, s10, 0xd000
s_add_u32 s15, s78, 0xa000
buffer_load_dwordx4 v250, s[44:47], s15 offen offset:0 lds
s_add_u32 m0, s10, 0xe000
s_add_u32 s15, s78, 0x14000
buffer_load_dwordx4 v250, s[44:47], s15 offen offset:0 lds
s_waitcnt vmcnt(14)
s_barrier
s_add_u32 m0, s11, 0x18000
s_add_u32 s15, s79, 0x0
buffer_load_dwordx4 v251, s[48:51], s15 offen offset:0 lds
s_add_u32 m0, s11, 0x18800
s_add_u32 s15, s79, 0x8000
buffer_load_dwordx4 v251, s[48:51], s15 offen offset:0 lds
s_add_u32 m0, s11, 0x1a000
s_add_u32 s15, s79, 0x20000
buffer_load_dwordx4 v251, s[48:51], s15 offen offset:0 lds
s_add_u32 m0, s11, 0x1a800
s_add_u32 s15, s79, 0x28000
buffer_load_dwordx4 v251, s[48:51], s15 offen offset:0 lds
s_waitcnt vmcnt(11)
s_barrier
s_add_u32 m0, s11, 0x1c000
s_add_u32 s15, s79, 0x40000
buffer_load_dwordx4 v251, s[48:51], s15 offen offset:0 lds
s_add_u32 m0, s11, 0x1c800
s_add_u32 s15, s79, 0x48000
buffer_load_dwordx4 v251, s[48:51], s15 offen offset:0 lds
s_add_u32 m0, s11, 0x1e000
s_add_u32 s15, s79, 0x60000
buffer_load_dwordx4 v251, s[48:51], s15 offen offset:0 lds
s_add_u32 m0, s11, 0x1e800
s_add_u32 s15, s79, 0x68000
buffer_load_dwordx4 v251, s[48:51], s15 offen offset:0 lds
s_add_u32 m0, s10, 0x12000
s_mov_b32 s15, 0x0
buffer_load_dwordx4 v248, s[56:59], s15 offen offset:0 nt lds
s_add_u32 m0, s10, 0x13000
s_mov_b32 s15, 0x2000
buffer_load_dwordx4 v248, s[56:59], s15 offen offset:0 nt lds
s_add_u32 m0, s10, 0x14000
s_mov_b32 s15, 0x4000
buffer_load_dwordx4 v248, s[56:59], s15 offen offset:0 nt lds
s_waitcnt vmcnt(14)
s_barrier
s_add_u32 m0, s10, 0x15000
s_mov_b32 s15, 0x6000
buffer_load_dwordx4 v248, s[56:59], s15 offen offset:0 nt lds
s_add_u32 m0, s10, 0x16000
s_mov_b32 s15, 0x8000
buffer_load_dwordx4 v248, s[56:59], s15 offen offset:0 nt lds
s_add_u32 m0, s10, 0x17000
s_mov_b32 s15, 0xa000
buffer_load_dwordx4 v248, s[56:59], s15 offen offset:0 nt lds
s_waitcnt vmcnt(10)
s_barrier
s_cmp_ge_u32 s80, 1
s_cselect_b32 s13, -1, 9
s_add_u32 s13, s13, s80
s_lshl_b32 s78, s13, 7
s_lshl_b32 s79, s13, 19
s_add_u32 m0, s10, 0xf000
s_add_u32 s15, s78, 0x0
buffer_load_dwordx4 v250, s[44:47], s15 offen offset:0 lds
s_add_u32 m0, s10, 0x10000
s_add_u32 s15, s78, 0xa000
buffer_load_dwordx4 v250, s[44:47], s15 offen offset:0 lds
s_add_u32 m0, s10, 0x11000
s_add_u32 s15, s78, 0x14000
buffer_load_dwordx4 v250, s[44:47], s15 offen offset:0 lds
s_add_u32 m0, s11, 0x20000
s_add_u32 s15, s79, 0x0
buffer_load_dwordx4 v251, s[48:51], s15 offen offset:0 lds
s_add_u32 m0, s11, 0x20800
s_add_u32 s15, s79, 0x8000
buffer_load_dwordx4 v251, s[48:51], s15 offen offset:0 lds
s_add_u32 m0, s11, 0x22000
s_add_u32 s15, s79, 0x20000
buffer_load_dwordx4 v251, s[48:51], s15 offen offset:0 lds
s_add_u32 m0, s11, 0x22800
s_add_u32 s15, s79, 0x28000
buffer_load_dwordx4 v251, s[48:51], s15 offen offset:0 lds
s_add_u32 m0, s11, 0x24000
s_add_u32 s15, s79, 0x40000
buffer_load_dwordx4 v251, s[48:51], s15 offen offset:0 lds
s_add_u32 m0, s11, 0x24800
s_add_u32 s15, s79, 0x48000
buffer_load_dwordx4 v251, s[48:51], s15 offen offset:0 lds
s_add_u32 m0, s11, 0x26000
s_add_u32 s15, s79, 0x60000
buffer_load_dwordx4 v251, s[48:51], s15 offen offset:0 lds
s_add_u32 m0, s11, 0x26800
s_add_u32 s15, s79, 0x68000
buffer_load_dwordx4 v251, s[48:51], s15 offen offset:0 lds
s_waitcnt vmcnt(17)
s_branch L_join
L_var7:
s_cmp_ge_u32 s80, 10
s_cselect_b32 s13, -10, 0
s_add_u32 s13, s13, s80
s_lshl_b32 s78, s13, 7
s_lshl_b32 s79, s13, 19
s_add_u32 m0, s10, 0xf000
s_add_u32 s15, s78, 0x0
buffer_load_dwordx4 v250, s[44:47], s15 offen offset:0 lds
s_add_u32 m0, s10, 0x10000
s_add_u32 s15, s78, 0xa000
buffer_load_dwordx4 v250, s[44:47], s15 offen offset:0 lds
s_add_u32 m0, s10, 0x11000
s_add_u32 s15, s78, 0x14000
buffer_load_dwordx4 v250, s[44:47], s15 offen offset:0 lds
s_waitcnt vmcnt(7)
s_barrier
s_add_u32 m0, s11, 0x20000
s_add_u32 s15, s79, 0x0
buffer_load_dwordx4 v251, s[48:51], s15 offen offset:0 lds
s_add_u32 m0, s11, 0x20800
s_add_u32 s15, s79, 0x8000
buffer_load_dwordx4 v251, s[48:51], s15 offen offset:0 lds
s_add_u32 m0, s11, 0x22000
s_add_u32 s15, s79, 0x20000
buffer_load_dwordx4 v251, s[48:51], s15 offen offset:0 lds
s_add_u32 m0, s11, 0x22800
s_add_u32 s15, s79, 0x28000
buffer_load_dwordx4 v251, s[48:51], s15 offen offset:0 lds
s_add_u32 m0, s11, 0x24000
s_add_u32 s15, s79, 0x40000
buffer_load_dwordx4 v251, s[48:51], s15 offen offset:0 lds
s_add_u32 m0, s11, 0x24800
s_add_u32 s15, s79, 0x48000
buffer_load_dwordx4 v251, s[48:51], s15 offen offset:0 lds
s_add_u32 m0, s11, 0x26000
s_add_u32 s15, s79, 0x60000
buffer_load_dwordx4 v251, s[48:51], s15 offen offset:0 lds
s_waitcnt vmcnt(10)
s_barrier
s_add_u32 m0, s11, 0x26800
s_add_u32 s15, s79, 0x68000
buffer_load_dwordx4 v251, s[48:51], s15 offen offset:0 lds
s_add_u32 m0, s10, 0x0
s_mov_b32 s15, 0x0
buffer_load_dwordx4 v249, s[52:55], s15 offen offset:0 nt lds
s_add_u32 m0, s10, 0x1000
s_mov_b32 s15, 0x1000
buffer_load_dwordx4 v249, s[52:55], s15 offen offset:0 nt lds
s_add_u32 m0, s10, 0x2000
s_mov_b32 s15, 0x2000
buffer_load_dwordx4 v249, s[52:55], s15 offen offset:0 nt lds
s_add_u32 m0, s10, 0x3000
s_mov_b32 s15, 0x3000
buffer_load_dwordx4 v249, s[52:55], s15 offen offset:0 nt lds
s_add_u32 m0, s10, 0x4000
s_mov_b32 s15, 0x4000
buffer_load_dwordx4 v249, s[52:55], s15 offen offset:0 nt lds
s_add_u32 m0, s10, 0x5000
s_mov_b32 s15, 0x5000
buffer_load_dwordx4 v249, s[52:55], s15 offen offset:0 nt lds
s_waitcnt vmcnt(10)
s_barrier
s_add_u32 m0, s10, 0x6000
s_mov_b32 s15, 0x6000
buffer_load_dwordx4 v249, s[52:55], s15 offen offset:0 nt lds
s_add_u32 m0, s10, 0x7000
s_mov_b32 s15, 0x7000
buffer_load_dwordx4 v249, s[52:55], s15 offen offset:0 nt lds
s_cmp_ge_u32 s80, 8
s_cselect_b32 s13, -8, 2
s_add_u32 s13, s13, s80
s_lshl_b32 s78, s13, 7
s_lshl_b32 s79, s13, 19
s_add_u32 m0, s10, 0x12000
s_add_u32 s15, s78, 0x0
buffer_load_dwordx4 v250, s[44:47], s15 offen offset:0 lds
s_add_u32 m0, s10, 0x13000
s_add_u32 s15, s78, 0xa000
buffer_load_dwordx4 v250, s[44:47], s15 offen offset:0 lds
s_add_u32 m0, s10, 0x14000
s_add_u32 s15, s78, 0x14000
buffer_load_dwordx4 v250, s[44:47], s15 offen offset:0 lds
s_add_u32 m0, s11, 0x18000
s_add_u32 s15, s79, 0x0
buffer_load_dwordx4 v251, s[48:51], s15 offen offset:0 lds
s_add_u32 m0, s11, 0x18800
s_add_u32 s15, s79, 0x8000
buffer_load_dwordx4 v251, s[48:51], s15 offen offset:0 lds
s_waitcnt vmcnt(13)
s_barrier
s_add_u32 m0, s11, 0x1a000
s_add_u32 s15, s79, 0x20000
buffer_load_dwordx4 v251, s[48:51], s15 offen offset:0 lds
s_add_u32 m0, s11, 0x1a800
s_add_u32 s15, s79, 0x28000
buffer_load_dwordx4 v251, s[48:51], s15 offen offset:0 lds
s_add_u32 m0, s11, 0x1c000
s_add_u32 s15, s79, 0x40000
buffer_load_dwordx4 v251, s[48:51], s15 offen offset:0 lds
s_add_u32 m0, s11, 0x1c800
s_add_u32 s15, s79, 0x48000
buffer_load_dwordx4 v251, s[48:51], s15 offen offset:0 lds
s_add_u32 m0, s11, 0x1e000
s_add_u32 s15, s79, 0x60000
buffer_load_dwordx4 v251, s[48:51], s15 offen offset:0 lds
s_add_u32 m0, s11, 0x1e800
s_add_u32 s15, s79, 0x68000
buffer_load_dwordx4 v251, s[48:51], s15 offen offset:0 lds
s_cmp_ge_u32 s80, 7
s_cselect_b32 s13, -7, 3
s_add_u32 s13, s13, s80
s_lshl_b32 s78, s13, 7
s_lshl_b32 s79, s13, 19
s_add_u32 m0, s10, 0x15000
s_add_u32 s15, s78, 0x0
buffer_load_dwordx4 v250, s[44:47], s15 offen offset:0 lds
s_waitcnt vmcnt(5)
s_barrier
s_add_u32 m0, s10, 0x16000
s_add_u32 s15, s78, 0xa000
buffer_load_dwordx4 v250, s[44:47], s15 offen offset:0 lds
s_add_u32 m0, s10, 0x17000
s_add_u32 s15, s78, 0x14000
buffer_load_dwordx4 v250, s[44:47], s15 offen offset:0 lds
s_add_u32 m0, s11, 0x20000
s_add_u32 s15, s79, 0x0
buffer_load_dwordx4 v251, s[48:51], s15 offen offset:0 lds
s_add_u32 m0, s11, 0x20800
s_add_u32 s15, s79, 0x8000
buffer_load_dwordx4 v251, s[48:51], s15 offen offset:0 lds
s_add_u32 m0, s11, 0x22000
s_add_u32 s15, s79, 0x20000
buffer_load_dwordx4 v251, s[48:51], s15 offen offset:0 lds
s_add_u32 m0, s11, 0x22800
s_add_u32 s15, s79, 0x28000
buffer_load_dwordx4 v251, s[48:51], s15 offen offset:0 lds
s_mov_b32 s15, 0x1e000
buffer_load_dword v246, v247, s[60:63], s15 offen
s_waitcnt vmcnt(8)
s_barrier
s_mov_b32 s15, 0x14000
buffer_load_dword v246, v247, s[60:63], s15 offen
s_add_u32 m0, s11, 0x24000
s_add_u32 s15, s79, 0x40000
buffer_load_dwordx4 v251, s[48:51], s15 offen offset:0 lds
s_add_u32 m0, s11, 0x24800
s_add_u32 s15, s79, 0x48000
buffer_load_dwordx4 v251, s[48:51], s15 offen offset:0 lds
s_add_u32 m0, s11, 0x26000
s_add_u32 s15, s79, 0x60000
buffer_load_dwordx4 v251, s[48:51], s15 offen offset:0 lds
s_add_u32 m0, s11, 0x26800
s_add_u32 s15, s79, 0x68000
buffer_load_dwordx4 v251, s[48:51], s15 offen offset:0 lds
s_cmp_ge_u32 s80, 6
s_cselect_b32 s13, -6, 4
s_add_u32 s13, s13, s80
s_lshl_b32 s78, s13, 7
s_lshl_b32 s79, s13, 19
s_add_u32 m0, s10, 0xc000
s_add_u32 s15, s78, 0x0
buffer_load_dwordx4 v250, s[44:47], s15 offen offset:0 lds
s_add_u32 m0, s10, 0xd000
s_add_u32 s15, s78, 0xa000
buffer_load_dwordx4 v250, s[44:47], s15 offen offset:0 lds
s_waitcnt vmcnt(8)
s_barrier
s_add_u32 m0, s10, 0xe000
s_add_u32 s15, s78, 0x14000
buffer_load_dwordx4 v250, s[44:47], s15 offen offset:0 lds
s_add_u32 m0, s11, 0x18000
s_add_u32 s15, s79, 0x0
buffer_load_dwordx4 v251, s[48:51], s15 offen offset:0 lds
s_add_u32 m0, s11, 0x18800
s_add_u32 s15, s79, 0x8000
buffer_load_dwordx4 v251, s[48:51], s15 offen offset:0 lds
s_add_u32 m0, s11, 0x1a000
s_add_u32 s15, s79, 0x20000
buffer_load_dwordx4 v251, s[48:51], s15 offen offset:0 lds
s_add_u32 m0, s11, 0x1a800
s_add_u32 s15, s79, 0x28000
buffer_load_dwordx4 v251, s[48:51], s15 offen offset:0 lds
s_add_u32 m0, s11, 0x1c000
s_add_u32 s15, s79, 0x40000
buffer_load_dwordx4 v251, s[48:51], s15 offen offset:0 lds
s_add_u32 m0, s11, 0x1c800
s_add_u32 s15, s79, 0x48000
buffer_load_dwordx4 v251, s[48:51], s15 offen offset:0 lds
s_waitcnt vmcnt(9)
s_barrier
s_add_u32 m0, s11, 0x1e000
s_add_u32 s15, s79, 0x60000
buffer_load_dwordx4 v251, s[48:51], s15 offen offset:0 lds
s_add_u32 m0, s11, 0x1e800
s_add_u32 s15, s79, 0x68000
buffer_load_dwordx4 v251, s[48:51], s15 offen offset:0 lds
s_add_u32 m0, s10, 0x8000
s_mov_b32 s15, 0x8000
buffer_load_dwordx4 v249, s[52:55], s15 offen offset:0 nt lds
s_add_u32 m0, s10, 0x9000
s_mov_b32 s15, 0x9000
buffer_load_dwordx4 v249, s[52:55], s15 offen offset:0 nt lds
s_add_u32 m0, s10, 0xa000
s_mov_b32 s15, 0xa000
buffer_load_dwordx4 v249, s[52:55], s15 offen offset:0 nt lds
s_add_u32 m0, s10, 0xb000
s_mov_b32 s15, 0xb000
buffer_load_dwordx4 v249, s[52:55], s15 offen offset:0 nt lds
s_cmp_ge_u32 s80, 5
s_cselect_b32 s13, -5, 5
s_add_u32 s13, s13, s80
s_lshl_b32 s78, s13, 7
s_lshl_b32 s79, s13, 19
s_add_u32 m0, s10, 0x12000
s_add_u32 s15, s78, 0x0
buffer_load_dwordx4 v250, s[44:47], s15 offen offset:0 lds
s_waitcnt vmcnt(9)
s_barrier
s_add_u32 m0, s10, 0x13000
s_add_u32 s15, s78, 0xa000
buffer_load_dwordx4 v250, s[44:47], s15 offen offset:0 lds
s_add_u32 m0, s10, 0x14000
s_add_u32 s15, s78, 0x14000
buffer_load_dwordx4 v250, s[44:47], s15 offen offset:0 lds
s_add_u32 m0, s11, 0x20000
s_add_u32 s15, s79, 0x0
buffer_load_dwordx4 v251, s[48:51], s15 offen offset:0 lds
s_add_u32 m0, s11, 0x20800
s_add_u32 s15, s79, 0x8000
buffer_load_dwordx4 v251, s[48:51], s15 offen offset:0 lds
s_add_u32 m0, s11, 0x22000
s_add_u32 s15, s79, 0x20000
buffer_load_dwordx4 v251, s[48:51], s15 offen offset:0 lds
s_add_u32 m0, s11, 0x22800
s_add_u32 s15, s79, 0x28000
buffer_load_dwordx4 v251, s[48:51], s15 offen offset:0 lds
s_add_u32 m0, s11, 0x24000
s_add_u32 s15, s79, 0x40000
buffer_load_dwordx4 v251, s[48:51], s15 offen offset:0 lds
s_waitcnt vmcnt(12)
s_barrier
s_add_u32 m0, s11, 0x24800
s_add_u32 s15, s79, 0x48000
buffer_load_dwordx4 v251, s[48:51], s15 offen offset:0 lds
s_add_u32 m0, s11, 0x26000
s_add_u32 s15, s79, 0x60000
buffer_load_dwordx4 v251, s[48:51], s15 offen offset:0 lds
s_add_u32 m0, s11, 0x26800
s_add_u32 s15, s79, 0x68000
buffer_load_dwordx4 v251, s[48:51], s15 offen offset:0 lds
s_cmp_ge_u32 s80, 4
s_cselect_b32 s13, -4, 6
s_add_u32 s13, s13, s80
s_lshl_b32 s78, s13, 7
s_lshl_b32 s79, s13, 19
s_add_u32 m0, s10, 0x15000
s_add_u32 s15, s78, 0x0
buffer_load_dwordx4 v250, s[44:47], s15 offen offset:0 lds
s_add_u32 m0, s10, 0x16000
s_add_u32 s15, s78, 0xa000
buffer_load_dwordx4 v250, s[44:47], s15 offen offset:0 lds
s_add_u32 m0, s10, 0x17000
s_add_u32 s15, s78, 0x14000
buffer_load_dwordx4 v250, s[44:47], s15 offen offset:0 lds
s_add_u32 m0, s11, 0x18000
s_add_u32 s15, s79, 0x0
buffer_load_dwordx4 v251, s[48:51], s15 offen offset:0 lds
s_waitcnt vmcnt(8)
s_barrier
s_add_u32 m0, s11, 0x18800
s_add_u32 s15, s79, 0x8000
buffer_load_dwordx4 v251, s[48:51], s15 offen offset:0 lds
s_add_u32 m0, s11, 0x1a000
s_add_u32 s15, s79, 0x20000
buffer_load_dwordx4 v251, s[48:51], s15 offen offset:0 lds
s_add_u32 m0, s11, 0x1a800
s_add_u32 s15, s79, 0x28000
buffer_load_dwordx4 v251, s[48:51], s15 offen offset:0 lds
s_add_u32 m0, s11, 0x1c000
s_add_u32 s15, s79, 0x40000
buffer_load_dwordx4 v251, s[48:51], s15 offen offset:0 lds
s_add_u32 m0, s11, 0x1c800
s_add_u32 s15, s79, 0x48000
buffer_load_dwordx4 v251, s[48:51], s15 offen offset:0 lds
s_add_u32 m0, s11, 0x1e000
s_add_u32 s15, s79, 0x60000
buffer_load_dwordx4 v251, s[48:51], s15 offen offset:0 lds
s_add_u32 m0, s11, 0x1e800
s_add_u32 s15, s79, 0x68000
buffer_load_dwordx4 v251, s[48:51], s15 offen offset:0 lds
s_waitcnt vmcnt(11)
s_barrier
s_cmp_ge_u32 s80, 3
s_cselect_b32 s13, -3, 7
s_add_u32 s13, s13, s80
s_lshl_b32 s78, s13, 7
s_lshl_b32 s79, s13, 19
s_add_u32 m0, s10, 0xf000
s_add_u32 s15, s78, 0x0
buffer_load_dwordx4 v250, s[44:47], s15 offen offset:0 lds
s_add_u32 m0, s10, 0x10000
s_add_u32 s15, s78, 0xa000
buffer_load_dwordx4 v250, s[44:47], s15 offen offset:0 lds
s_add_u32 m0, s10, 0x11000
s_add_u32 s15, s78, 0x14000
buffer_load_dwordx4 v250, s[44:47], s15 offen offset:0 lds
s_add_u32 m0, s11, 0x20000
s_add_u32 s15, s79, 0x0
buffer_load_dwordx4 v251, s[48:51], s15 offen offset:0 lds
s_add_u32 m0, s11, 0x20800
s_add_u32 s15, s79, 0x8000
buffer_load_dwordx4 v251, s[48:51], s15 offen offset:0 lds
s_add_u32 m0, s11, 0x22000
s_add_u32 s15, s79, 0x20000
buffer_load_dwordx4 v251, s[48:51], s15 offen offset:0 lds
s_add_u32 m0, s11, 0x22800
s_add_u32 s15, s79, 0x28000
buffer_load_dwordx4 v251, s[48:51], s15 offen offset:0 lds
s_waitcnt vmcnt(11)
s_barrier
s_add_u32 m0, s11, 0x24000
s_add_u32 s15, s79, 0x40000
buffer_load_dwordx4 v251, s[48:51], s15 offen offset:0 lds
s_add_u32 m0, s11, 0x24800
s_add_u32 s15, s79, 0x48000
buffer_load_dwordx4 v251, s[48:51], s15 offen offset:0 lds
s_add_u32 m0, s11, 0x26000
s_add_u32 s15, s79, 0x60000
buffer_load_dwordx4 v251, s[48:51], s15 offen offset:0 lds
s_add_u32 m0, s11, 0x26800
s_add_u32 s15, s79, 0x68000
buffer_load_dwordx4 v251, s[48:51], s15 offen offset:0 lds
s_cmp_ge_u32 s80, 2
s_cselect_b32 s13, -2, 8
s_add_u32 s13, s13, s80
s_lshl_b32 s78, s13, 7
s_lshl_b32 s79, s13, 19
s_add_u32 m0, s10, 0xc000
s_add_u32 s15, s78, 0x0
buffer_load_dwordx4 v250, s[44:47], s15 offen offset:0 lds
s_add_u32 m0, s10, 0xd000
s_add_u32 s15, s78, 0xa000
buffer_load_dwordx4 v250, s[44:47], s15 offen offset:0 lds
s_add_u32 m0, s10, 0xe000
s_add_u32 s15, s78, 0x14000
buffer_load_dwordx4 v250, s[44:47], s15 offen offset:0 lds
s_waitcnt vmcnt(14)
s_barrier
s_add_u32 m0, s11, 0x18000
s_add_u32 s15, s79, 0x0
buffer_load_dwordx4 v251, s[48:51], s15 offen offset:0 lds
s_add_u32 m0, s11, 0x18800
s_add_u32 s15, s79, 0x8000
buffer_load_dwordx4 v251, s[48:51], s15 offen offset:0 lds
s_add_u32 m0, s11, 0x1a000
s_add_u32 s15, s79, 0x20000
buffer_load_dwordx4 v251, s[48:51], s15 offen offset:0 lds
s_add_u32 m0, s11, 0x1a800
s_add_u32 s15, s79, 0x28000
buffer_load_dwordx4 v251, s[48:51], s15 offen offset:0 lds
s_waitcnt vmcnt(11)
s_barrier
s_add_u32 m0, s11, 0x1c000
s_add_u32 s15, s79, 0x40000
buffer_load_dwordx4 v251, s[48:51], s15 offen offset:0 lds
s_add_u32 m0, s11, 0x1c800
s_add_u32 s15, s79, 0x48000
buffer_load_dwordx4 v251, s[48:51], s15 offen offset:0 lds
s_add_u32 m0, s11, 0x1e000
s_add_u32 s15, s79, 0x60000
buffer_load_dwordx4 v251, s[48:51], s15 offen offset:0 lds
s_add_u32 m0, s11, 0x1e800
s_add_u32 s15, s79, 0x68000
buffer_load_dwordx4 v251, s[48:51], s15 offen offset:0 lds
s_add_u32 m0, s10, 0x12000
s_mov_b32 s15, 0x0
buffer_load_dwordx4 v248, s[56:59], s15 offen offset:0 nt lds
s_add_u32 m0, s10, 0x13000
s_mov_b32 s15, 0x2000
buffer_load_dwordx4 v248, s[56:59], s15 offen offset:0 nt lds
s_add_u32 m0, s10, 0x14000
s_mov_b32 s15, 0x4000
buffer_load_dwordx4 v248, s[56:59], s15 offen offset:0 nt lds
s_waitcnt vmcnt(14)
s_barrier
s_add_u32 m0, s10, 0x15000
s_mov_b32 s15, 0x6000
buffer_load_dwordx4 v248, s[56:59], s15 offen offset:0 nt lds
s_add_u32 m0, s10, 0x16000
s_mov_b32 s15, 0x8000
buffer_load_dwordx4 v248, s[56:59], s15 offen offset:0 nt lds
s_add_u32 m0, s10, 0x17000
s_mov_b32 s15, 0xa000
buffer_load_dwordx4 v248, s[56:59], s15 offen offset:0 nt lds
s_waitcnt vmcnt(10)
s_barrier
s_cmp_ge_u32 s80, 1
s_cselect_b32 s13, -1, 9
s_add_u32 s13, s13, s80
s_lshl_b32 s78, s13, 7
s_lshl_b32 s79, s13, 19
s_add_u32 m0, s10, 0xf000
s_add_u32 s15, s78, 0x0
buffer_load_dwordx4 v250, s[44:47], s15 offen offset:0 lds
s_add_u32 m0, s10, 0x10000
s_add_u32 s15, s78, 0xa000
buffer_load_dwordx4 v250, s[44:47], s15 offen offset:0 lds
s_add_u32 m0, s10, 0x11000
s_add_u32 s15, s78, 0x14000
buffer_load_dwordx4 v250, s[44:47], s15 offen offset:0 lds
s_add_u32 m0, s11, 0x20000
s_add_u32 s15, s79, 0x0
buffer_load_dwordx4 v251, s[48:51], s15 offen offset:0 lds
s_add_u32 m0, s11, 0x20800
s_add_u32 s15, s79, 0x8000
buffer_load_dwordx4 v251, s[48:51], s15 offen offset:0 lds
s_add_u32 m0, s11, 0x22000
s_add_u32 s15, s79, 0x20000
buffer_load_dwordx4 v251, s[48:51], s15 offen offset:0 lds
s_add_u32 m0, s11, 0x22800
s_add_u32 s15, s79, 0x28000
buffer_load_dwordx4 v251, s[48:51], s15 offen offset:0 lds
s_add_u32 m0, s11, 0x24000
s_add_u32 s15, s79, 0x40000
buffer_load_dwordx4 v251, s[48:51], s15 offen offset:0 lds
s_add_u32 m0, s11, 0x24800
s_add_u32 s15, s79, 0x48000
buffer_load_dwordx4 v251, s[48:51], s15 offen offset:0 lds
s_add_u32 m0, s11, 0x26000
s_add_u32 s15, s79, 0x60000
buffer_load_dwordx4 v251, s[48:51], s15 offen offset:0 lds
s_add_u32 m0, s11, 0x26800
s_add_u32 s15, s79, 0x68000
buffer_load_dwordx4 v251, s[48:51], s15 offen offset:0 lds
s_waitcnt vmcnt(17)
L_join:
s_barrier
s_add_u32 m0, s10, 0x18000
s_add_u32 s15, s82, 0x0
buffer_load_dwordx4 v239, s[60:63], s15 offen offset:0 lds
s_add_u32 m0, s10, 0x19000
s_add_u32 s15, s82, 0x80
buffer_load_dwordx4 v239, s[60:63], s15 offen offset:0 lds
s_add_u32 m0, s10, 0x1a000
s_add_u32 s15, s82, 0x28000
buffer_load_dwordx4 v239, s[60:63], s15 offen offset:0 lds
s_add_u32 m0, s10, 0x1b000
s_add_u32 s15, s82, 0x28080
buffer_load_dwordx4 v239, s[60:63], s15 offen offset:0 lds
s_waitcnt vmcnt(8)
s_barrier
s_add_u32 m0, s10, 0x1c000
s_add_u32 s15, s82, 0x0
buffer_load_dwordx4 v238, s[60:63], s15 offen offset:0 lds
s_add_u32 m0, s10, 0x1d000
s_add_u32 s15, s82, 0x28000
buffer_load_dwordx4 v238, s[60:63], s15 offen offset:0 lds
s_add_u32 m0, s10, 0xc000
s_mov_b32 s15, 0x80
buffer_load_dwordx4 v248, s[56:59], s15 offen offset:0 nt lds
s_add_u32 m0, s10, 0xd000
s_mov_b32 s15, 0x2080
buffer_load_dwordx4 v248, s[56:59], s15 offen offset:0 nt lds
s_add_u32 m0, s10, 0xe000
s_mov_b32 s15, 0x4080
buffer_load_dwordx4 v248, s[56:59], s15 offen offset:0 nt lds
s_waitcnt vmcnt(9)
s_barrier
s_cmp_ge_u32 s9, 2
s_cbranch_scc1 L_finx
v_lshrrev_b32 v254, 6, v0
v_bfe_u32 v253, v0, 4, 2
v_lshl_add_u32 v252, v254, 4, v253
v_mul_u32_u24 v242, 2560, v252
v_and_b32 v252, 15, v0
v_lshl_add_u32 v242, v252, 4, v242
s_mul_i32 s13, s5, 245760
s_mul_i32 s14, s4, 10240
s_add_u32 s13, s13, s14
s_mul_i32 s14, s3, 1280
s_add_u32 s13, s13, s14
s_lshr_b32 s14, s7, 1
s_mul_i32 s14, s14, 640
s_add_u32 s13, s13, s14
s_and_b32 s14, s7, 1
s_mul_i32 s14, s14, 384
s_add_u32 s13, s13, s14
v_add_u32 v242, s13, v242
v_lshlrev_b32 v243, 4, v253
v_mul_u32_u24 v253, 11, v254
v_lshrrev_b32 v253, 5, v253
v_lshl_add_u32 v243, v254, 8, v243
v_mul_u32_u24 v253, 5888, v253
v_add_u32 v243, v243, v253
v_lshrrev_b32 v253, 3, v252
v_mul_u32_u24 v253, 13312, v253
v_add_u32 v243, v243, v253
v_bfe_u32 v253, v252, 2, 1
v_mul_u32_u24 v253, 768, v253
v_add_u32 v243, v243, v253
v_bfe_u32 v253, v252, 1, 1
v_lshl_add_u32 v243, v253, 3, v243
v_and_b32 v253, 1, v252
v_lshl_add_u32 v243, v253, 7, v243
v_add_u32 v243, 98304, v243
s_branch L_fine
L_finx:
v_lshrrev_b32 v254, 4, v255
v_bfe_u32 v253, v255, 2, 2
v_lshl_add_u32 v252, v254, 4, v253
v_mul_u32_u24 v242, 2560, v252
v_and_b32 v252, 3, v255
v_lshl_add_u32 v242, v252, 4, v242
s_mul_i32 s13, s5, 245760
s_mul_i32 s14, s4, 10240
s_add_u32 s13, s13, s14
s_mul_i32 s14, s3, 1280
s_add_u32 s13, s13, s14
s_lshr_b32 s14, s7, 1
s_mul_i32 s14, s14, 640
s_add_u32 s13, s13, s14
s_and_b32 s14, s7, 1
s_lshl_b32 s14, s14, 6
s_add_u32 s13, s13, s14
s_add_u32 s13, s13, 256
s_and_b32 s15, s9, 1
s_mul_i32 s14, s15, 122880
s_add_u32 s13, s13, s14
v_add_u32 v242, s13, v242
v_min_u32 v254, 2, v254
v_lshlrev_b32 v243, 4, v253
v_lshl_add_u32 v243, v254, 8, v243
v_bfe_u32 v253, v252, 1, 1
v_lshl_add_u32 v243, v253, 3, v243
v_and_b32 v253, 1, v252
v_lshl_add_u32 v243, v253, 7, v243
s_mul_i32 s14, s15, 6144
s_add_u32 s14, s14, 124928
v_cmp_lt_u32 vcc, 47, v255
v_add_u32 v243, s14, v243
v_mov_b32 v252, 0x40000000
v_cndmask_b32 v242, v242, v252, vcc
L_fine:
s_barrier
s_add_u32 m0, s10, 0xf000
s_mov_b32 s15, 0x6080
buffer_load_dwordx4 v248, s[56:59], s15 offen offset:0 nt lds
s_add_u32 m0, s10, 0x10000
s_mov_b32 s15, 0x8080
buffer_load_dwordx4 v248, s[56:59], s15 offen offset:0 nt lds
s_add_u32 m0, s10, 0x11000
s_mov_b32 s15, 0xa080
buffer_load_dwordx4 v248, s[56:59], s15 offen offset:0 nt lds
buffer_load_dwordx4 v[4:7], v244, s[68:71], s90 offen offset:0 sc1
s_add_u32 m0, s10, 0x1e000
s_add_u32 s15, s82, 0x14000
buffer_load_dwordx4 v239, s[60:63], s15 offen offset:0 lds
s_add_u32 m0, s10, 0x1f000
s_add_u32 s15, s82, 0x14080
buffer_load_dwordx4 v239, s[60:63], s15 offen offset:0 lds
s_add_u32 m0, s10, 0x20000
s_add_u32 s15, s82, 0x3c000
buffer_load_dwordx4 v239, s[60:63], s15 offen offset:0 lds
s_add_u32 m0, s10, 0x21000
s_add_u32 s15, s82, 0x3c080
buffer_load_dwordx4 v239, s[60:63], s15 offen offset:0 lds
s_add_u32 m0, s10, 0x22000
s_add_u32 s15, s82, 0x14000
buffer_load_dwordx4 v238, s[60:63], s15 offen offset:0 lds
s_add_u32 m0, s10, 0x23000
s_add_u32 s15, s82, 0x3c000
buffer_load_dwordx4 v238, s[60:63], s15 offen offset:0 lds
s_add_u32 m0, s10, 0x24000
s_add_u32 s15, s82, 0x0
buffer_load_dwordx4 v237, s[60:63], s15 offen offset:0 lds
s_add_u32 m0, s10, 0x25000
s_add_u32 s15, s82, 0x80
buffer_load_dwordx4 v237, s[60:63], s15 offen offset:0 lds
s_add_u32 m0, s10, 0x26000
s_add_u32 s15, s82, 0x28000
buffer_load_dwordx4 v237, s[60:63], s15 offen offset:0 lds
s_add_u32 m0, s10, 0x27000
s_add_u32 s15, s82, 0x28080
buffer_load_dwordx4 v237, s[60:63], s15 offen offset:0 lds
s_barrier
s_add_u32 m0, s10, 0x0
s_add_u32 s15, s82, 0x0
buffer_load_dwordx4 v236, s[60:63], s15 offen offset:0 lds
s_add_u32 m0, s10, 0x1000
s_add_u32 s15, s82, 0x28000
buffer_load_dwordx4 v236, s[60:63], s15 offen offset:0 lds
s_add_u32 m0, s10, 0x2000
s_add_u32 s15, s82, 0x14000
buffer_load_dwordx4 v237, s[60:63], s15 offen offset:0 lds
s_add_u32 m0, s10, 0x3000
s_add_u32 s15, s82, 0x14080
buffer_load_dwordx4 v237, s[60:63], s15 offen offset:0 lds
s_add_u32 m0, s10, 0x4000
s_add_u32 s15, s82, 0x3c000
buffer_load_dwordx4 v237, s[60:63], s15 offen offset:0 lds
s_add_u32 m0, s10, 0x5000
s_add_u32 s15, s82, 0x3c080
buffer_load_dwordx4 v237, s[60:63], s15 offen offset:0 lds
s_waitcnt vmcnt(17)
s_barrier
s_waitcnt vmcnt(16)
s_mov_b32 s14, 0
L_hsa:
v_and_b32 v4, v4, v5
v_and_b32 v6, v6, v7
v_and_b32 v4, v4, v6
s_nop 0
v_readfirstlane_b32 s13, v4
s_add_u32 s14, s14, 1
s_cmp_eq_u32 s13, 1
s_cbranch_scc1 L_hsb
s_cmp_ge_u32 s14, 100000
s_cbranch_scc1 L_hsb
buffer_load_dwordx4 v[4:7], v244, s[68:71], s90 offen sc1
s_waitcnt vmcnt(0)
s_branch L_hsa
L_hsb:
s_add_u32 m0, s10, 0x12000
s_add_u32 s15, s82, 0x14000
buffer_load_dwordx4 v236, s[60:63], s15 offen offset:0 lds
s_add_u32 m0, s10, 0x13000
s_add_u32 s15, s82, 0x3c000
buffer_load_dwordx4 v236, s[60:63], s15 offen offset:0 lds
s_barrier
s_mov_b32 s32, 0x1
s_atomic_add s32, s[92:93], s29
s_atomic_add s32, s[92:93], s30
s_atomic_add s32, s[92:93], s31
s_add_u32 m0, s10, 0x14000
s_add_u32 s15, s83, 0x0
buffer_load_dwordx4 v239, s[60:63], s15 offen offset:0 lds
s_add_u32 m0, s10, 0x15000
s_add_u32 s15, s83, 0x80
buffer_load_dwordx4 v239, s[60:63], s15 offen offset:0 lds
s_add_u32 m0, s10, 0x16000
s_add_u32 s15, s83, 0x28000
buffer_load_dwordx4 v239, s[60:63], s15 offen offset:0 lds
s_add_u32 m0, s10, 0x17000
s_add_u32 s15, s83, 0x28080
buffer_load_dwordx4 v239, s[60:63], s15 offen offset:0 lds
s_waitcnt vmcnt(10)
s_barrier
s_mov_b32 s91, 0
s_atomic_add s91, s[92:93], s28 glc
s_add_u32 m0, s10, 0x18000
s_add_u32 s15, s83, 0x0
buffer_load_dwordx4 v238, s[60:63], s15 offen offset:0 lds
s_add_u32 m0, s10, 0x19000
s_add_u32 s15, s83, 0x28000
buffer_load_dwordx4 v238, s[60:63], s15 offen offset:0 lds
s_add_u32 m0, s10, 0x1a000
s_add_u32 s15, s84, 0x0
buffer_load_dwordx4 v239, s[60:63], s15 offen offset:0 lds
s_add_u32 m0, s10, 0x1b000
s_add_u32 s15, s84, 0x80
buffer_load_dwordx4 v239, s[60:63], s15 offen offset:0 lds
s_add_u32 m0, s10, 0x1c000
s_add_u32 s15, s84, 0x28000
buffer_load_dwordx4 v239, s[60:63], s15 offen offset:0 lds
s_add_u32 m0, s10, 0x1d000
s_add_u32 s15, s84, 0x28080
buffer_load_dwordx4 v239, s[60:63], s15 offen offset:0 lds
s_barrier
s_mov_b32 s14, 0
L_po0a:
s_waitcnt lgkmcnt(0)
s_add_u32 s14, s14, 1
s_and_b32 s13, s91, 0xff
s_cmp_eq_u32 s13, 0x3
s_cbranch_scc1 L_po0b
s_cmp_ge_u32 s14, 100000
s_cbranch_scc1 L_po0b
s_mov_b32 s91, 0
s_atomic_add s91, s[92:93], s28 glc
s_branch L_po0a
L_po0b:
s_add_u32 m0, s77, 0x6000
s_add_u32 s15, s87, 0x100000
buffer_load_dwordx4 v245, s[72:75], s15 offen offset:0 sc1 lds
buffer_load_dwordx4 v245, s[72:75], s15 offen offset:1024 sc1 lds
buffer_load_dwordx4 v245, s[72:75], s15 offen offset:2048 sc1 lds
s_add_u32 m0, s77, 0x9000
s_add_u32 s15, s88, 0x100000
buffer_load_dwordx4 v245, s[72:75], s15 offen offset:0 sc1 lds
buffer_load_dwordx4 v245, s[72:75], s15 offen offset:1024 sc1 lds
buffer_load_dwordx4 v245, s[72:75], s15 offen offset:2048 sc1 lds
s_mov_b32 s33, 0x100
s_atomic_add s33, s[92:93], s29
s_atomic_add s33, s[92:93], s30
s_atomic_add s33, s[92:93], s31
s_add_u32 m0, s10, 0x24000
s_add_u32 s15, s85, 0x0
buffer_load_dwordx4 v239, s[60:63], s15 offen offset:0 lds
s_add_u32 m0, s10, 0x25000
s_add_u32 s15, s85, 0x80
buffer_load_dwordx4 v239, s[60:63], s15 offen offset:0 lds
s_waitcnt vmcnt(18)
s_barrier
s_mov_b32 s34, 0x10000
s_atomic_add s34, s[92:93], s29
s_atomic_add s34, s[92:93], s30
s_atomic_add s34, s[92:93], s31
s_add_u32 m0, s77, 0xc000
s_add_u32 s15, s89, 0x100000
buffer_load_dwordx4 v245, s[72:75], s15 offen offset:0 sc1 lds
buffer_load_dwordx4 v245, s[72:75], s15 offen offset:1024 sc1 lds
buffer_load_dwordx4 v245, s[72:75], s15 offen offset:2048 sc1 lds
s_add_u32 m0, s10, 0x26000
s_add_u32 s15, s85, 0x28000
buffer_load_dwordx4 v239, s[60:63], s15 offen offset:0 lds
s_add_u32 m0, s10, 0x27000
s_add_u32 s15, s85, 0x28080
buffer_load_dwordx4 v239, s[60:63], s15 offen offset:0 lds
s_add_u32 m0, s10, 0x0
s_add_u32 s15, s83, 0x0
buffer_load_dwordx4 v237, s[60:63], s15 offen offset:0 lds
s_add_u32 m0, s10, 0x1000
s_add_u32 s15, s83, 0x80
buffer_load_dwordx4 v237, s[60:63], s15 offen offset:0 lds
s_mov_b32 s91, 0
s_atomic_add s91, s[92:93], s28 glc
s_waitcnt vmcnt(12)
s_barrier
s_mov_b32 s35, 0x1000000
s_atomic_add s35, s[92:93], s29
s_atomic_add s35, s[92:93], s30
s_atomic_add s35, s[92:93], s31
s_add_u32 m0, s10, 0x1e000
s_add_u32 s15, s83, 0x28000
buffer_load_dwordx4 v237, s[60:63], s15 offen offset:0 lds
s_add_u32 m0, s10, 0x1f000
s_add_u32 s15, s83, 0x28080
buffer_load_dwordx4 v237, s[60:63], s15 offen offset:0 lds
s_add_u32 m0, s10, 0x20000
s_add_u32 s15, s83, 0x0
buffer_load_dwordx4 v236, s[60:63], s15 offen offset:0 lds
s_add_u32 m0, s10, 0x21000
s_add_u32 s15, s83, 0x28000
buffer_load_dwordx4 v236, s[60:63], s15 offen offset:0 lds
s_mov_b32 s14, 0
L_po1a:
s_waitcnt lgkmcnt(0)
s_add_u32 s14, s14, 1
s_and_b32 s13, s91, 0xffff
s_cmp_eq_u32 s13, 0x303
s_cbranch_scc1 L_po1b
s_cmp_ge_u32 s14, 100000
s_cbranch_scc1 L_po1b
s_mov_b32 s91, 0
s_atomic_add s91, s[92:93], s28 glc
s_branch L_po1a
L_po1b:
s_add_u32 m0, s77, 0xf000
s_add_u32 s15, s87, 0x400000
buffer_load_dwordx4 v245, s[72:75], s15 offen offset:0 sc1 lds
buffer_load_dwordx4 v245, s[72:75], s15 offen offset:1024 sc1 lds
buffer_load_dwordx4 v245, s[72:75], s15 offen offset:2048 sc1 lds
s_waitcnt vmcnt(16)
s_barrier
s_add_u32 m0, s77, 0x6000
s_add_u32 s15, s88, 0x400000
buffer_load_dwordx4 v245, s[72:75], s15 offen offset:0 sc1 lds
buffer_load_dwordx4 v245, s[72:75], s15 offen offset:1024 sc1 lds
buffer_load_dwordx4 v245, s[72:75], s15 offen offset:2048 sc1 lds
s_mov_b32 s91, 0
s_atomic_add s91, s[92:93], s28 glc
s_add_u32 m0, s10, 0x22000
s_add_u32 s15, s84, 0x0
buffer_load_dwordx4 v237, s[60:63], s15 offen offset:0 lds
s_add_u32 m0, s10, 0x23000
s_add_u32 s15, s84, 0x80
buffer_load_dwordx4 v237, s[60:63], s15 offen offset:0 lds
s_add_u32 m0, s10, 0x2000
s_add_u32 s15, s84, 0x28000
buffer_load_dwordx4 v237, s[60:63], s15 offen offset:0 lds
s_add_u32 m0, s10, 0x3000
s_add_u32 s15, s84, 0x28080
buffer_load_dwordx4 v237, s[60:63], s15 offen offset:0 lds
s_waitcnt vmcnt(16)
s_barrier
s_mov_b32 s14, 0
L_po3a:
s_waitcnt lgkmcnt(0)
s_add_u32 s14, s14, 1
s_and_b32 s13, s91, 0xffffffff
s_cmp_eq_u32 s13, 0x3030303
s_cbranch_scc1 L_po3b
s_cmp_ge_u32 s14, 100000
s_cbranch_scc1 L_po3b
s_mov_b32 s91, 0
s_atomic_add s91, s[92:93], s28 glc
s_branch L_po3a
L_po3b:
s_add_u32 m0, s77, 0x9000
s_add_u32 s15, s87, 0x700000
buffer_load_dwordx4 v245, s[72:75], s15 offen offset:0 sc1 lds
buffer_load_dwordx4 v245, s[72:75], s15 offen offset:1024 sc1 lds
buffer_load_dwordx4 v245, s[72:75], s15 offen offset:2048 sc1 lds
s_add_u32 m0, s10, 0x4000
s_add_u32 s15, s83, 0x14000
buffer_load_dwordx4 v239, s[60:63], s15 offen offset:0 lds
s_add_u32 m0, s10, 0x5000
s_add_u32 s15, s83, 0x14080
buffer_load_dwordx4 v239, s[60:63], s15 offen offset:0 lds
s_add_u32 m0, s10, 0x12000
s_add_u32 s15, s83, 0x3c000
buffer_load_dwordx4 v239, s[60:63], s15 offen offset:0 lds
s_add_u32 m0, s10, 0x13000
s_add_u32 s15, s83, 0x3c080
buffer_load_dwordx4 v239, s[60:63], s15 offen offset:0 lds
s_waitcnt vmcnt(14)
s_barrier
s_add_u32 m0, s10, 0x14000
s_add_u32 s15, s83, 0x14000
buffer_load_dwordx4 v238, s[60:63], s15 offen offset:0 lds
s_add_u32 m0, s10, 0x15000
s_add_u32 s15, s83, 0x3c000
buffer_load_dwordx4 v238, s[60:63], s15 offen offset:0 lds
s_add_u32 m0, s77, 0xc000
s_add_u32 s15, s87, 0xa00000
buffer_load_dwordx4 v245, s[72:75], s15 offen offset:0 sc1 lds
buffer_load_dwordx4 v245, s[72:75], s15 offen offset:1024 sc1 lds
buffer_load_dwordx4 v245, s[72:75], s15 offen offset:2048 sc1 lds
s_add_u32 m0, s10, 0x16000
s_add_u32 s15, s83, 0x14000
buffer_load_dwordx4 v237, s[60:63], s15 offen offset:0 lds
s_add_u32 m0, s10, 0x17000
s_add_u32 s15, s83, 0x14080
buffer_load_dwordx4 v237, s[60:63], s15 offen offset:0 lds
s_waitcnt vmcnt(14)
s_barrier
s_add_u32 m0, s10, 0x18000
s_add_u32 s15, s83, 0x3c000
buffer_load_dwordx4 v237, s[60:63], s15 offen offset:0 lds
s_add_u32 m0, s10, 0x19000
s_add_u32 s15, s83, 0x3c080
buffer_load_dwordx4 v237, s[60:63], s15 offen offset:0 lds
s_add_u32 m0, s10, 0x1a000
s_add_u32 s15, s83, 0x14000
buffer_load_dwordx4 v236, s[60:63], s15 offen offset:0 lds
s_add_u32 m0, s10, 0x1b000
s_add_u32 s15, s83, 0x3c000
buffer_load_dwordx4 v236, s[60:63], s15 offen offset:0 lds
s_add_u32 m0, s77, 0xf000
s_add_u32 s15, s89, 0x400000
buffer_load_dwordx4 v245, s[72:75], s15 offen offset:0 sc1 lds
buffer_load_dwordx4 v245, s[72:75], s15 offen offset:1024 sc1 lds
buffer_load_dwordx4 v245, s[72:75], s15 offen offset:2048 sc1 lds
s_add_u32 m0, s10, 0x1c000
s_add_u32 s15, s85, 0x0
buffer_load_dwordx4 v237, s[60:63], s15 offen offset:0 lds
s_add_u32 m0, s10, 0x1d000
s_add_u32 s15, s85, 0x80
buffer_load_dwordx4 v237, s[60:63], s15 offen offset:0 lds
s_waitcnt vmcnt(14)
s_barrier
s_add_u32 m0, s10, 0x24000
s_add_u32 s15, s85, 0x28000
buffer_load_dwordx4 v237, s[60:63], s15 offen offset:0 lds
s_add_u32 m0, s10, 0x25000
s_add_u32 s15, s85, 0x28080
buffer_load_dwordx4 v237, s[60:63], s15 offen offset:0 lds
s_add_u32 m0, s77, 0x6000
s_add_u32 s15, s88, 0x700000
buffer_load_dwordx4 v245, s[72:75], s15 offen offset:0 sc1 lds
buffer_load_dwordx4 v245, s[72:75], s15 offen offset:1024 sc1 lds
buffer_load_dwordx4 v245, s[72:75], s15 offen offset:2048 sc1 lds
s_add_u32 m0, s10, 0x26000
s_add_u32 s15, s84, 0x14000
buffer_load_dwordx4 v239, s[60:63], s15 offen offset:0 lds
s_add_u32 m0, s10, 0x27000
s_add_u32 s15, s84, 0x14080
buffer_load_dwordx4 v239, s[60:63], s15 offen offset:0 lds
s_add_u32 m0, s10, 0x0
s_add_u32 s15, s84, 0x3c000
buffer_load_dwordx4 v239, s[60:63], s15 offen offset:0 lds
s_add_u32 m0, s10, 0x1000
s_add_u32 s15, s84, 0x3c080
buffer_load_dwordx4 v239, s[60:63], s15 offen offset:0 lds
s_waitcnt vmcnt(14)
s_barrier
s_add_u32 m0, s77, 0x9000
s_add_u32 s15, s89, 0x700000
buffer_load_dwordx4 v245, s[72:75], s15 offen offset:0 sc1 lds
buffer_load_dwordx4 v245, s[72:75], s15 offen offset:1024 sc1 lds
buffer_load_dwordx4 v245, s[72:75], s15 offen offset:2048 sc1 lds
s_add_u32 m0, s10, 0x1e000
s_add_u32 s15, s85, 0x14000
buffer_load_dwordx4 v239, s[60:63], s15 offen offset:0 lds
s_add_u32 m0, s10, 0x1f000
s_add_u32 s15, s85, 0x14080
buffer_load_dwordx4 v239, s[60:63], s15 offen offset:0 lds
s_add_u32 m0, s10, 0x20000
s_add_u32 s15, s85, 0x3c000
buffer_load_dwordx4 v239, s[60:63], s15 offen offset:0 lds
s_add_u32 m0, s10, 0x21000
s_add_u32 s15, s85, 0x3c080
buffer_load_dwordx4 v239, s[60:63], s15 offen offset:0 lds
s_add_u32 m0, s10, 0x22000
s_add_u32 s15, s84, 0x14000
buffer_load_dwordx4 v237, s[60:63], s15 offen offset:0 lds
s_add_u32 m0, s10, 0x23000
s_add_u32 s15, s84, 0x14080
buffer_load_dwordx4 v237, s[60:63], s15 offen offset:0 lds
s_waitcnt vmcnt(16)
s_barrier
s_add_u32 m0, s77, 0xc000
s_add_u32 s15, s88, 0xa00000
buffer_load_dwordx4 v245, s[72:75], s15 offen offset:0 sc1 lds
buffer_load_dwordx4 v245, s[72:75], s15 offen offset:1024 sc1 lds
buffer_load_dwordx4 v245, s[72:75], s15 offen offset:2048 sc1 lds
s_add_u32 m0, s10, 0x2000
s_add_u32 s15, s84, 0x3c000
buffer_load_dwordx4 v237, s[60:63], s15 offen offset:0 lds
s_add_u32 m0, s10, 0x3000
s_add_u32 s15, s84, 0x3c080
buffer_load_dwordx4 v237, s[60:63], s15 offen offset:0 lds
s_waitcnt vmcnt(14)
s_barrier
s_add_u32 m0, s77, 0xf000
s_add_u32 s15, s89, 0xa00000
buffer_load_dwordx4 v245, s[72:75], s15 offen offset:0 sc1 lds
buffer_load_dwordx4 v245, s[72:75], s15 offen offset:1024 sc1 lds
buffer_load_dwordx4 v245, s[72:75], s15 offen offset:2048 sc1 lds
s_add_u32 m0, s10, 0x4000
s_add_u32 s15, s85, 0x14000
buffer_load_dwordx4 v237, s[60:63], s15 offen offset:0 lds
s_add_u32 m0, s10, 0x5000
s_add_u32 s15, s85, 0x14080
buffer_load_dwordx4 v237, s[60:63], s15 offen offset:0 lds
s_add_u32 m0, s10, 0x12000
s_add_u32 s15, s85, 0x3c000
buffer_load_dwordx4 v237, s[60:63], s15 offen offset:0 lds
s_add_u32 m0, s10, 0x13000
s_add_u32 s15, s85, 0x3c080
buffer_load_dwordx4 v237, s[60:63], s15 offen offset:0 lds
s_waitcnt vmcnt(14)
s_barrier
s_waitcnt vmcnt(7)
s_barrier
s_waitcnt vmcnt(0)
s_barrier
s_and_b32 s15, s7, 1
s_lshr_b32 s14, s9, 1
s_add_u32 s14, s14, s6
s_sub_u32 s14, s14, s15
s_and_b32 s14, s14, 3
s_lshl_b32 s13, s14, 11
s_or_b32 s14, s9, 2
s_lshl_b32 s14, s14, 9
s_add_u32 s13, s13, s14
s_add_u32 s13, s13, s26
s_add_u32 s13, s13, 0x2000000
s_add_u32 s78, s40, s13
s_addc_u32 s79, s41, 0
s_mov_b32 s76, 0x100
s_atomic_add s76, s[78:79], 0
s_atomic_add s76, s[78:79], 128
s_atomic_add s76, s[78:79], 256
s_atomic_add s76, s[78:79], 384
s_lshl_b32 s13, s6, 11
s_lshl_b32 s14, s9, 9
s_add_u32 s13, s13, s14
s_lshl_b32 s14, s4, 7
s_add_u32 s13, s13, s14
s_add_u32 s13, s13, s26
s_add_u32 s81, s13, 0x2000000
s_add_u32 s92, s40, s81
s_addc_u32 s93, s41, 0
s_lshr_b32 s13, s26, 12
s_add_u32 s13, s13, s6
s_lshl_b32 s13, s13, 2
s_add_u32 s13, s13, s4
s_mul_i32 s82, s13, 18432
s_mul_i32 s14, s9, 4608
s_add_u32 s82, s82, s14
s_and_b32 s14, s9, 1
s_mul_i32 s84, s14, 6144
s_mul_i32 s83, s13, 12288
s_add_u32 s83, s83, s84
s_mul_i32 s85, s9, 6656
s_mov_b32 s91, 0
s_atomic_add s91, s[92:93], 0 glc
s_cmp_lt_u32 s9, 2
s_cbranch_scc1 L_nox
s_mov_b32 s14, 0
L_pxa:
s_waitcnt lgkmcnt(0)
s_add_u32 s14, s14, 1
s_cmp_ge_u32 s91, 0x800
s_cbranch_scc1 L_pxb
s_cmp_ge_u32 s14, 100000
s_cbranch_scc1 L_pxb
s_mov_b32 s91, 0
s_atomic_add s91, s[92:93], 0 glc
s_branch L_pxa
L_pxb:
s_add_u32 m0, s84, 0x1e800
s_add_u32 s15, s83, 0x1800000
buffer_load_dwordx4 v241, s[72:75], s15 offen offset:0 sc1 lds
buffer_load_dwordx4 v241, s[72:75], s15 offen offset:1024 sc1 lds
buffer_load_dwordx4 v241, s[72:75], s15 offen offset:2048 sc1 lds
s_add_u32 m0, s84, 0x1f400
s_add_u32 s15, s83, 0x1800c00
buffer_load_dwordx4 v241, s[72:75], s15 offen offset:0 sc1 lds
buffer_load_dwordx4 v241, s[72:75], s15 offen offset:1024 sc1 lds
buffer_load_dwordx4 v241, s[72:75], s15 offen offset:2048 sc1 lds
L_nox:
s_mov_b32 s14, 0
L_ppa:
s_waitcnt lgkmcnt(0)
s_add_u32 s14, s14, 1
s_and_b32 s13, s91, 0xff
s_cmp_eq_u32 s13, 3
s_cbranch_scc1 L_ppb
s_cmp_ge_u32 s14, 100000
s_cbranch_scc1 L_ppb
s_mov_b32 s91, 0
s_atomic_add s91, s[92:93], 0 glc
s_branch L_ppa
L_ppb:
s_add_u32 m0, s85, 0x18600
s_add_u32 s15, s82, 0x1000000
buffer_load_dwordx4 v241, s[72:75], s15 offen offset:0 sc1 lds
buffer_load_dwordx4 v241, s[72:75], s15 offen offset:1024 sc1 lds
buffer_load_dwordx4 v241, s[72:75], s15 offen offset:2048 sc1 lds
buffer_load_dwordx4 v241, s[72:75], s15 offen offset:3072 sc1 lds
s_add_u32 m0, s85, 0x19600
s_add_u32 s15, s82, 0x1001000
buffer_load_dwordx4 v240, s[72:75], s15 offen offset:0 sc1 lds
s_cmp_lt_u32 s9, 2
s_cbranch_scc1 L_main
s_waitcnt vmcnt(5)
ds_read_b64 v[8:9], v243 offset:0
ds_read_b64 v[10:11], v243 offset:64
ds_read_b64 v[12:13], v243 offset:768
ds_read_b64 v[14:15], v243 offset:832
ds_read_b64 v[16:17], v243 offset:1536
ds_read_b64 v[18:19], v243 offset:1600
ds_read_b64 v[20:21], v243 offset:2304
ds_read_b64 v[22:23], v243 offset:2368
ds_read_b64 v[24:25], v243 offset:3072
ds_read_b64 v[26:27], v243 offset:3136
ds_read_b64 v[28:29], v243 offset:3840
ds_read_b64 v[30:31], v243 offset:3904
ds_read_b64 v[32:33], v243 offset:4608
ds_read_b64 v[34:35], v243 offset:4672
ds_read_b64 v[36:37], v243 offset:5376
ds_read_b64 v[38:39], v243 offset:5440
s_waitcnt lgkmcnt(15)
v_lshlrev_b32 v40, 16, v8
v_and_b32 v41, 0xffff0000, v8
v_lshlrev_b32 v42, 16, v9
v_and_b32 v43, 0xffff0000, v9
s_waitcnt lgkmcnt(14)
v_lshlrev_b32 v44, 16, v10
v_and_b32 v45, 0xffff0000, v10
v_lshlrev_b32 v46, 16, v11
v_and_b32 v47, 0xffff0000, v11
s_waitcnt lgkmcnt(13)
v_lshlrev_b32 v48, 16, v12
v_and_b32 v49, 0xffff0000, v12
v_lshlrev_b32 v50, 16, v13
v_and_b32 v51, 0xffff0000, v13
s_waitcnt lgkmcnt(12)
v_lshlrev_b32 v52, 16, v14
v_and_b32 v53, 0xffff0000, v14
v_lshlrev_b32 v54, 16, v15
v_and_b32 v55, 0xffff0000, v15
v_pk_add_f32 v[40:41], v[40:41], v[48:49]
v_pk_add_f32 v[42:43], v[42:43], v[50:51]
v_pk_add_f32 v[44:45], v[44:45], v[52:53]
v_pk_add_f32 v[46:47], v[46:47], v[54:55]
s_waitcnt lgkmcnt(11)
v_lshlrev_b32 v48, 16, v16
v_and_b32 v49, 0xffff0000, v16
v_lshlrev_b32 v50, 16, v17
v_and_b32 v51, 0xffff0000, v17
s_waitcnt lgkmcnt(10)
v_lshlrev_b32 v52, 16, v18
v_and_b32 v53, 0xffff0000, v18
v_lshlrev_b32 v54, 16, v19
v_and_b32 v55, 0xffff0000, v19
v_pk_add_f32 v[40:41], v[40:41], v[48:49]
v_pk_add_f32 v[42:43], v[42:43], v[50:51]
v_pk_add_f32 v[44:45], v[44:45], v[52:53]
v_pk_add_f32 v[46:47], v[46:47], v[54:55]
s_waitcnt lgkmcnt(9)
v_lshlrev_b32 v48, 16, v20
v_and_b32 v49, 0xffff0000, v20
v_lshlrev_b32 v50, 16, v21
v_and_b32 v51, 0xffff0000, v21
s_waitcnt lgkmcnt(8)
v_lshlrev_b32 v52, 16, v22
v_and_b32 v53, 0xffff0000, v22
v_lshlrev_b32 v54, 16, v23
v_and_b32 v55, 0xffff0000, v23
v_pk_add_f32 v[40:41], v[40:41], v[48:49]
v_pk_add_f32 v[42:43], v[42:43], v[50:51]
v_pk_add_f32 v[44:45], v[44:45], v[52:53]
v_pk_add_f32 v[46:47], v[46:47], v[54:55]
s_waitcnt lgkmcnt(7)
v_lshlrev_b32 v48, 16, v24
v_and_b32 v49, 0xffff0000, v24
v_lshlrev_b32 v50, 16, v25
v_and_b32 v51, 0xffff0000, v25
s_waitcnt lgkmcnt(6)
v_lshlrev_b32 v52, 16, v26
v_and_b32 v53, 0xffff0000, v26
v_lshlrev_b32 v54, 16, v27
v_and_b32 v55, 0xffff0000, v27
v_pk_add_f32 v[40:41], v[40:41], v[48:49]
v_pk_add_f32 v[42:43], v[42:43], v[50:51]
v_pk_add_f32 v[44:45], v[44:45], v[52:53]
v_pk_add_f32 v[46:47], v[46:47], v[54:55]
s_waitcnt lgkmcnt(5)
v_lshlrev_b32 v48, 16, v28
v_and_b32 v49, 0xffff0000, v28
v_lshlrev_b32 v50, 16, v29
v_and_b32 v51, 0xffff0000, v29
s_waitcnt lgkmcnt(4)
v_lshlrev_b32 v52, 16, v30
v_and_b32 v53, 0xffff0000, v30
v_lshlrev_b32 v54, 16, v31
v_and_b32 v55, 0xffff0000, v31
v_pk_add_f32 v[40:41], v[40:41], v[48:49]
v_pk_add_f32 v[42:43], v[42:43], v[50:51]
v_pk_add_f32 v[44:45], v[44:45], v[52:53]
v_pk_add_f32 v[46:47], v[46:47], v[54:55]
s_waitcnt lgkmcnt(3)
v_lshlrev_b32 v48, 16, v32
v_and_b32 v49, 0xffff0000, v32
v_lshlrev_b32 v50, 16, v33
v_and_b32 v51, 0xffff0000, v33
s_waitcnt lgkmcnt(2)
v_lshlrev_b32 v52, 16, v34
v_and_b32 v53, 0xffff0000, v34
v_lshlrev_b32 v54, 16, v35
v_and_b32 v55, 0xffff0000, v35
v_pk_add_f32 v[40:41], v[40:41], v[48:49]
v_pk_add_f32 v[42:43], v[42:43], v[50:51]
v_pk_add_f32 v[44:45], v[44:45], v[52:53]
v_pk_add_f32 v[46:47], v[46:47], v[54:55]
s_waitcnt lgkmcnt(1)
v_lshlrev_b32 v48, 16, v36
v_and_b32 v49, 0xffff0000, v36
v_lshlrev_b32 v50, 16, v37
v_and_b32 v51, 0xffff0000, v37
s_waitcnt lgkmcnt(0)
v_lshlrev_b32 v52, 16, v38
v_and_b32 v53, 0xffff0000, v38
v_lshlrev_b32 v54, 16, v39
v_and_b32 v55, 0xffff0000, v39
v_pk_add_f32 v[40:41], v[40:41], v[48:49]
v_pk_add_f32 v[42:43], v[42:43], v[50:51]
v_pk_add_f32 v[44:45], v[44:45], v[52:53]
v_pk_add_f32 v[46:47], v[46:47], v[54:55]
v_cvt_pk_bf16_f32 v40, v40, v41
v_cvt_pk_bf16_f32 v41, v42, v43
v_cvt_pk_bf16_f32 v42, v44, v45
v_cvt_pk_bf16_f32 v43, v46, v47
buffer_store_dwordx4 v[40:43], v242, s[64:67], 0 offen offset:0 sc1
s_waitcnt vmcnt(1)
s_barrier
s_branch L_hend
L_main:
s_waitcnt vmcnt(0)
s_barrier
ds_read_b64 v[8:9], v243 offset:0
ds_read_b64 v[10:11], v243 offset:64
ds_read_b64 v[12:13], v243 offset:1536
ds_read_b64 v[14:15], v243 offset:1600
ds_read_b64 v[16:17], v243 offset:3072
ds_read_b64 v[18:19], v243 offset:3136
ds_read_b64 v[20:21], v243 offset:4608
ds_read_b64 v[22:23], v243 offset:4672
s_waitcnt lgkmcnt(7)
v_lshlrev_b32 v24, 16, v8
v_and_b32 v25, 0xffff0000, v8
v_lshlrev_b32 v26, 16, v9
v_and_b32 v27, 0xffff0000, v9
s_waitcnt lgkmcnt(6)
v_lshlrev_b32 v28, 16, v10
v_and_b32 v29, 0xffff0000, v10
v_lshlrev_b32 v30, 16, v11
v_and_b32 v31, 0xffff0000, v11
s_waitcnt lgkmcnt(5)
v_lshlrev_b32 v32, 16, v12
v_and_b32 v33, 0xffff0000, v12
v_lshlrev_b32 v34, 16, v13
v_and_b32 v35, 0xffff0000, v13
s_waitcnt lgkmcnt(4)
v_lshlrev_b32 v36, 16, v14
v_and_b32 v37, 0xffff0000, v14
v_lshlrev_b32 v38, 16, v15
v_and_b32 v39, 0xffff0000, v15
v_pk_add_f32 v[24:25], v[24:25], v[32:33]
v_pk_add_f32 v[26:27], v[26:27], v[34:35]
v_pk_add_f32 v[28:29], v[28:29], v[36:37]
v_pk_add_f32 v[30:31], v[30:31], v[38:39]
s_waitcnt lgkmcnt(3)
v_lshlrev_b32 v32, 16, v16
v_and_b32 v33, 0xffff0000, v16
v_lshlrev_b32 v34, 16, v17
v_and_b32 v35, 0xffff0000, v17
s_waitcnt lgkmcnt(2)
v_lshlrev_b32 v36, 16, v18
v_and_b32 v37, 0xffff0000, v18
v_lshlrev_b32 v38, 16, v19
v_and_b32 v39, 0xffff0000, v19
v_pk_add_f32 v[24:25], v[24:25], v[32:33]
v_pk_add_f32 v[26:27], v[26:27], v[34:35]
v_pk_add_f32 v[28:29], v[28:29], v[36:37]
v_pk_add_f32 v[30:31], v[30:31], v[38:39]
s_waitcnt lgkmcnt(1)
v_lshlrev_b32 v32, 16, v20
v_and_b32 v33, 0xffff0000, v20
v_lshlrev_b32 v34, 16, v21
v_and_b32 v35, 0xffff0000, v21
s_waitcnt lgkmcnt(0)
v_lshlrev_b32 v36, 16, v22
v_and_b32 v37, 0xffff0000, v22
v_lshlrev_b32 v38, 16, v23
v_and_b32 v39, 0xffff0000, v23
v_pk_add_f32 v[24:25], v[24:25], v[32:33]
v_pk_add_f32 v[26:27], v[26:27], v[34:35]
v_pk_add_f32 v[28:29], v[28:29], v[36:37]
v_pk_add_f32 v[30:31], v[30:31], v[38:39]
v_cvt_pk_bf16_f32 v24, v24, v25
v_cvt_pk_bf16_f32 v25, v26, v27
v_cvt_pk_bf16_f32 v26, v28, v29
v_cvt_pk_bf16_f32 v27, v30, v31
buffer_store_dwordx4 v[24:27], v242, s[64:67], 0 offen offset:0 sc1
L_hend:
s_endpgm
L_exit:
s_endpgm
.p2alignl 12, 0xbf810000
.fill 768, 4, 0xbf810000
L_compute:
s_lshr_b32 s9, s8, 1
s_and_b32 s10, s8, 1
v_and_b32 v255, 63, v0
v_lshrrev_b32 v254, 4, v255
v_and_b32 v253, 15, v255
v_lshrrev_b32 v252, 2, v253
v_and_b32 v251, 3, v255
s_waitcnt lgkmcnt(0)
s_mov_b32 s72, s40
s_mov_b32 s73, s41
s_mov_b32 s74, 0x10000000
s_mov_b32 s75, 0x20000
s_mov_b32 s68, s38
s_mov_b32 s69, s39
s_mov_b32 s70, 0x100
s_mov_b32 s71, 0x20000
s_mov_b32 s64, s36
s_mov_b32 s65, s37
s_mov_b32 s66, 0x1e0000
s_mov_b32 s67, 0x20000
s_lshl_b32 s13, s6, 11
s_lshl_b32 s14, s8, 9
s_add_u32 s13, s13, s14
s_add_u32 s13, s13, s26
s_add_u32 s13, s13, 0x2000000
s_add_u32 s76, s40, s13
s_addc_u32 s77, s41, 0
s_lshr_b32 s79, s26, 10
s_lshl_b32 s14, s4, 2
s_add_u32 s79, s79, s14
s_xor_b32 s78, s6, 1
s_or_b32 s78, s78, s8
v_mov_b32 v4, 0
v_mov_b32 v5, 1
v_lshlrev_b32 v250, 7, v255
s_lshl_b32 s14, s4, 12
s_add_u32 s13, s26, s14
s_add_u32 s83, s13, 0x2000000
s_cmp_lg_u32 s78, 0
s_cbranch_scc1 L_noclr
s_mov_b32 exec_hi, 0
buffer_store_dword v4, v250, s[72:75], s83 offen offset:0 sc0 sc1
s_mov_b64 exec, -1
L_noclr:
v_and_b32 v249, 1, v254
v_lshl_or_b32 v249, v249, 2, v252
v_lshl_add_u32 v248, v254, 3, v252
v_lshlrev_b32 v248, 9, v248
v_lshl_add_u32 v248, v251, 3, v248
v_lshl_add_u32 v248, v249, 5, v248
s_lshl_b32 s13, s9, 8
s_add_u32 s13, s13, 98304
v_add_u32 v247, s13, v248
v_xor_b32 v250, 32, v247
v_xor_b32 v246, 64, v247
v_xor_b32 v245, 96, v247
v_xor_b32 v244, 128, v247
v_xor_b32 v243, 160, v247
v_xor_b32 v242, 192, v247
v_xor_b32 v241, 224, v247
v_lshrrev_b32 v249, 1, v253
v_xor_b32 v249, v249, v254
v_lshlrev_b32 v249, 4, v249
v_lshl_add_u32 v249, v253, 7, v249
s_mul_i32 s13, s10, 6144
s_add_u32 s13, s13, 49152
v_add_u32 v240, s13, v249
v_xor_b32 v239, 64, v240
v_lshrrev_b32 v249, 1, v254
v_xor_b32 v249, v249, v253
v_lshlrev_b32 v249, 4, v249
v_lshl_add_u32 v249, v253, 8, v249
v_and_b32 v248, 1, v254
v_lshl_add_u32 v249, v248, 3, v249
s_mul_i32 s13, s9, 24576
s_add_u32 s13, s13, 0
v_add_u32 v238, s13, v249
v_xor_b32 v237, 32, v238
v_xor_b32 v236, 64, v238
v_xor_b32 v235, 96, v238
v_xor_b32 v234, 128, v238
v_xor_b32 v233, 160, v238
v_xor_b32 v232, 192, v238
v_xor_b32 v253, 224, v238
v_lshl_add_u32 v231, v254, 2, v252
v_bfe_u32 v249, v231, 1, 2
v_lshlrev_b32 v249, 5, v249
v_lshl_add_u32 v249, v231, 7, v249
v_lshl_add_u32 v249, v251, 3, v249
s_mul_i32 s13, s9, 12288
s_add_u32 s13, s13, 49152
v_add_u32 v230, s13, v249
s_and_b32 s13, s5, 4
s_lshl_b32 s13, s13, 4
v_xor_b32 v230, s13, v230
v_xor_b32 v229, 32, v230
v_xor_b32 v228, 64, v230
v_xor_b32 v227, 96, v230
s_lshl_b32 s13, s9, 12
v_add_u32 v226, s13, v249
v_xor_b32 v225, 32, v226
v_xor_b32 v224, 64, v226
v_xor_b32 v223, 96, v226
s_lshl_b32 s13, s9, 6
v_xor_b32 v222, s13, v249
v_xor_b32 v221, 32, v222
v_add_u32 v220, 98304, v226
v_add_u32 v219, 98304, v225
v_add_u32 v218, 98304, v224
v_add_u32 v217, 98304, v223
v_add_u32 v216, 98304, v222
v_add_u32 v215, 98304, v221
v_add_u32 v214, 73728, v226
v_add_u32 v213, 73728, v225
v_add_u32 v212, 73728, v224
v_add_u32 v211, 73728, v223
v_add_u32 v210, 73728, v222
v_add_u32 v209, 73728, v221
s_mul_i32 s13, s10, 3072
s_add_u32 s13, s13, 24576
v_lshlrev_b32 v249, 4, v255
v_add_u32 v208, s13, v249
s_mul_i32 s13, s9, 6144
v_add_u32 v207, s13, v208
s_mov_b32 s80, 0x3e0293ee
s_mov_b32 s81, s80
s_lshl_b32 s13, s4, 2
s_add_u32 s13, s13, s6
s_mul_i32 s13, s13, 12288
s_mul_i32 s14, s26, 12
s_add_u32 s13, s13, s14
s_add_u32 s90, s13, 0xfa000
s_add_u32 s91, s13, 0x3fa000
s_add_u32 s92, s13, 0x6fa000
s_add_u32 s93, s13, 0x9fa000
v_lshrrev_b32 v249, 6, v0
v_bfe_u32 v248, v0, 4, 2
v_lshl_add_u32 v231, v249, 4, v248
v_mul_u32_u24 v255, 2560, v231
v_and_b32 v231, 15, v0
v_lshl_add_u32 v255, v231, 4, v255
s_mul_i32 s13, s5, 245760
s_mul_i32 s14, s4, 10240
s_add_u32 s13, s13, s14
s_mul_i32 s14, s3, 1280
s_add_u32 s13, s13, s14
s_lshr_b32 s14, s7, 1
s_mul_i32 s14, s14, 640
s_add_u32 s13, s13, s14
s_and_b32 s14, s7, 1
s_mul_i32 s14, s14, 384
s_add_u32 s13, s13, s14
v_add_u32 v255, s13, v255
v_lshlrev_b32 v206, 4, v248
v_mul_u32_u24 v248, 11, v249
v_lshrrev_b32 v248, 5, v248
v_lshl_add_u32 v206, v249, 8, v206
v_mul_u32_u24 v248, 5888, v248
v_add_u32 v206, v206, v248
v_lshrrev_b32 v248, 3, v231
v_mul_u32_u24 v248, 13312, v248
v_add_u32 v206, v206, v248
v_bfe_u32 v248, v231, 2, 1
v_mul_u32_u24 v248, 768, v248
v_add_u32 v206, v206, v248
v_bfe_u32 v248, v231, 1, 1
v_lshl_add_u32 v206, v248, 3, v206
v_and_b32 v248, 1, v231
v_lshl_add_u32 v206, v248, 7, v206
v_add_u32 v206, 98304, v206
v_lshlrev_b32 v249, 4, v251
v_lshl_add_u32 v249, v254, 6, v249
s_mul_i32 s13, s8, 6656
s_add_u32 s13, s13, 98304
v_add_u32 v205, s13, v249
v_sub_u32 v248, s4, v252
v_and_b32 v248, 3, v248
v_cmp_eq_u32 s[84:85], 0, v248
v_mul_u32_u24 v248, 1536, v248
v_mul_u32_u24 v231, 18432, v252
v_add3_u32 v204, v249, v248, v231
v_mov_b32 v231, 0x40000000
s_lshr_b32 s13, s26, 12
s_add_u32 s14, s13, s6
s_mul_i32 s82, s14, 73728
s_mul_i32 s14, s8, 4608
s_add_u32 s82, s82, s14
s_add_u32 s82, s82, 0xfffa00
v_cndmask_b32 v204, v204, v231, s[84:85]
v_mul_u32_u24 v231, 12288, v252
v_add_u32 v254, v249, v231
s_and_b32 s15, s7, 1
s_add_u32 s14, s6, s9
s_sub_u32 s14, s14, s15
s_and_b32 s14, s14, 3
s_add_u32 s13, s13, s14
s_mul_i32 s89, s13, 49152
s_mul_i32 s14, s10, 6144
s_add_u32 s89, s89, s14
s_lshl_b32 s14, s4, 1
s_add_u32 s14, s14, s15
s_mul_i32 s14, s14, 768
s_add_u32 s89, s89, s14
s_add_u32 s89, s89, 0x1800000
s_add_u32 s13, s4, 1
s_and_b32 s13, s13, 3
s_lshl_b32 s86, s13, 7
s_add_u32 s13, s4, 2
s_and_b32 s13, s13, 3
s_lshl_b32 s87, s13, 7
s_add_u32 s13, s4, 3
s_and_b32 s13, s13, 3
s_lshl_b32 s88, s13, 7
s_barrier
ds_read_b128 v[8:11], v240 offset:0
ds_read_b128 v[12:15], v240 offset:2048
ds_read_b128 v[16:19], v240 offset:4096
ds_read_b64_tr_b16 v[20:21], v247 offset:0
ds_read_b64_tr_b16 v[22:23], v247 offset:2048
ds_read_b64_tr_b16 v[24:25], v250 offset:0
ds_read_b64_tr_b16 v[26:27], v250 offset:2048
ds_read_b64_tr_b16 v[28:29], v246 offset:0
ds_read_b64_tr_b16 v[30:31], v246 offset:2048
ds_read_b64_tr_b16 v[32:33], v245 offset:0
ds_read_b64_tr_b16 v[34:35], v245 offset:2048
ds_read_b64_tr_b16 v[36:37], v244 offset:0
ds_read_b64_tr_b16 v[38:39], v244 offset:2048
ds_read_b64_tr_b16 v[40:41], v243 offset:0
ds_read_b64_tr_b16 v[42:43], v243 offset:2048
ds_read_b64_tr_b16 v[44:45], v242 offset:0
ds_read_b64_tr_b16 v[46:47], v242 offset:2048
ds_read_b64_tr_b16 v[48:49], v241 offset:0
ds_read_b64_tr_b16 v[50:51], v241 offset:2048
s_waitcnt lgkmcnt(0)
s_barrier
v_mfma_f32_16x16x32_bf16 v[52:55], v[20:23], v[8:11], 0
ds_read_b128 v[56:59], v239 offset:0
ds_read_b128 v[60:63], v239 offset:2048
v_mfma_f32_16x16x32_bf16 v[64:67], v[20:23], v[12:15], 0
ds_read_b128 v[68:71], v239 offset:4096
v_mfma_f32_16x16x32_bf16 v[72:75], v[20:23], v[16:19], 0
ds_read_b64_tr_b16 v[76:77], v247 offset:16384
v_mfma_f32_16x16x32_bf16 v[80:83], v[24:27], v[16:19], 0
ds_read_b64_tr_b16 v[78:79], v247 offset:18432
v_mfma_f32_16x16x32_bf16 v[84:87], v[24:27], v[12:15], 0
ds_read_b64_tr_b16 v[88:89], v250 offset:16384
v_mfma_f32_16x16x32_bf16 v[92:95], v[24:27], v[8:11], 0
ds_read_b64_tr_b16 v[90:91], v250 offset:18432
ds_read_b64_tr_b16 v[96:97], v246 offset:16384
v_mfma_f32_16x16x32_bf16 v[100:103], v[28:31], v[8:11], 0
ds_read_b64_tr_b16 v[98:99], v246 offset:18432
v_mfma_f32_16x16x32_bf16 v[104:107], v[28:31], v[12:15], 0
ds_read_b64_tr_b16 v[20:21], v245 offset:16384
v_mfma_f32_16x16x32_bf16 v[108:111], v[28:31], v[16:19], 0
ds_read_b64_tr_b16 v[22:23], v245 offset:18432
v_mfma_f32_16x16x32_bf16 v[112:115], v[32:35], v[16:19], 0
ds_read_b64_tr_b16 v[116:117], v244 offset:16384
v_mfma_f32_16x16x32_bf16 v[120:123], v[32:35], v[12:15], 0
ds_read_b64_tr_b16 v[118:119], v244 offset:18432
ds_read_b64_tr_b16 v[24:25], v243 offset:16384
v_mfma_f32_16x16x32_bf16 v[124:127], v[32:35], v[8:11], 0
ds_read_b64_tr_b16 v[26:27], v243 offset:18432
v_mfma_f32_16x16x32_bf16 v[128:131], v[36:39], v[8:11], 0
ds_read_b64_tr_b16 v[132:133], v242 offset:16384
v_mfma_f32_16x16x32_bf16 v[136:139], v[36:39], v[12:15], 0
ds_read_b64_tr_b16 v[134:135], v242 offset:18432
v_mfma_f32_16x16x32_bf16 v[28:31], v[36:39], v[16:19], 0
ds_read_b64_tr_b16 v[140:141], v241 offset:16384
v_mfma_f32_16x16x32_bf16 v[144:147], v[40:43], v[16:19], 0
ds_read_b64_tr_b16 v[142:143], v241 offset:18432
v_mfma_f32_16x16x32_bf16 v[148:151], v[40:43], v[12:15], 0
v_mfma_f32_16x16x32_bf16 v[152:155], v[40:43], v[8:11], 0
v_mfma_f32_16x16x32_bf16 v[32:35], v[44:47], v[8:11], 0
v_mfma_f32_16x16x32_bf16 v[156:159], v[44:47], v[12:15], 0
v_mfma_f32_16x16x32_bf16 v[160:163], v[44:47], v[16:19], 0
v_mfma_f32_16x16x32_bf16 v[164:167], v[48:51], v[16:19], 0
v_mfma_f32_16x16x32_bf16 v[168:171], v[48:51], v[12:15], 0
v_mfma_f32_16x16x32_bf16 v[172:175], v[48:51], v[8:11], 0
s_waitcnt lgkmcnt(0)
s_barrier
v_mfma_f32_16x16x32_bf16 v[52:55], v[76:79], v[56:59], v[52:55]
ds_read_b128 v[36:39], v240 offset:12288
ds_read_b128 v[176:179], v240 offset:14336
v_mfma_f32_16x16x32_bf16 v[64:67], v[76:79], v[60:63], v[64:67]
ds_read_b128 v[40:43], v240 offset:16384
v_mfma_f32_16x16x32_bf16 v[72:75], v[76:79], v[68:71], v[72:75]
ds_read_b64_tr_b16 v[44:45], v247 offset:32768
v_mfma_f32_16x16x32_bf16 v[80:83], v[88:91], v[68:71], v[80:83]
ds_read_b64_tr_b16 v[46:47], v247 offset:34816
v_mfma_f32_16x16x32_bf16 v[84:87], v[88:91], v[60:63], v[84:87]
ds_read_b64_tr_b16 v[8:9], v250 offset:32768
v_mfma_f32_16x16x32_bf16 v[92:95], v[88:91], v[56:59], v[92:95]
ds_read_b64_tr_b16 v[10:11], v250 offset:34816
ds_read_b64_tr_b16 v[12:13], v246 offset:32768
v_mfma_f32_16x16x32_bf16 v[100:103], v[96:99], v[56:59], v[100:103]
ds_read_b64_tr_b16 v[14:15], v246 offset:34816
v_mfma_f32_16x16x32_bf16 v[104:107], v[96:99], v[60:63], v[104:107]
ds_read_b64_tr_b16 v[16:17], v245 offset:32768
v_mfma_f32_16x16x32_bf16 v[108:111], v[96:99], v[68:71], v[108:111]
ds_read_b64_tr_b16 v[18:19], v245 offset:34816
v_mfma_f32_16x16x32_bf16 v[112:115], v[20:23], v[68:71], v[112:115]
ds_read_b64_tr_b16 v[48:49], v244 offset:32768
v_mfma_f32_16x16x32_bf16 v[120:123], v[20:23], v[60:63], v[120:123]
ds_read_b64_tr_b16 v[50:51], v244 offset:34816
ds_read_b64_tr_b16 v[76:77], v243 offset:32768
v_mfma_f32_16x16x32_bf16 v[124:127], v[20:23], v[56:59], v[124:127]
ds_read_b64_tr_b16 v[78:79], v243 offset:34816
v_mfma_f32_16x16x32_bf16 v[128:131], v[116:119], v[56:59], v[128:131]
ds_read_b64_tr_b16 v[88:89], v242 offset:32768
v_mfma_f32_16x16x32_bf16 v[136:139], v[116:119], v[60:63], v[136:139]
ds_read_b64_tr_b16 v[90:91], v242 offset:34816
v_mfma_f32_16x16x32_bf16 v[28:31], v[116:119], v[68:71], v[28:31]
ds_read_b64_tr_b16 v[96:97], v241 offset:32768
v_mfma_f32_16x16x32_bf16 v[144:147], v[24:27], v[68:71], v[144:147]
ds_read_b64_tr_b16 v[98:99], v241 offset:34816
v_mfma_f32_16x16x32_bf16 v[148:151], v[24:27], v[60:63], v[148:151]
v_mfma_f32_16x16x32_bf16 v[152:155], v[24:27], v[56:59], v[152:155]
v_mfma_f32_16x16x32_bf16 v[32:35], v[132:135], v[56:59], v[32:35]
v_mfma_f32_16x16x32_bf16 v[156:159], v[132:135], v[60:63], v[156:159]
v_mfma_f32_16x16x32_bf16 v[160:163], v[132:135], v[68:71], v[160:163]
v_mfma_f32_16x16x32_bf16 v[164:167], v[140:143], v[68:71], v[164:167]
v_mfma_f32_16x16x32_bf16 v[168:171], v[140:143], v[60:63], v[168:171]
v_mfma_f32_16x16x32_bf16 v[172:175], v[140:143], v[56:59], v[172:175]
s_waitcnt lgkmcnt(0)
s_barrier
v_mfma_f32_16x16x32_bf16 v[52:55], v[44:47], v[36:39], v[52:55]
ds_read_b128 v[20:23], v239 offset:12288
ds_read_b128 v[116:119], v239 offset:14336
v_mfma_f32_16x16x32_bf16 v[64:67], v[44:47], v[176:179], v[64:67]
ds_read_b128 v[24:27], v239 offset:16384
v_mfma_f32_16x16x32_bf16 v[72:75], v[44:47], v[40:43], v[72:75]
ds_read_b64_tr_b16 v[132:133], v247 offset:49152
v_mfma_f32_16x16x32_bf16 v[80:83], v[8:11], v[40:43], v[80:83]
ds_read_b64_tr_b16 v[134:135], v247 offset:51200
v_mfma_f32_16x16x32_bf16 v[84:87], v[8:11], v[176:179], v[84:87]
ds_read_b64_tr_b16 v[56:57], v250 offset:49152
v_mfma_f32_16x16x32_bf16 v[92:95], v[8:11], v[36:39], v[92:95]
ds_read_b64_tr_b16 v[58:59], v250 offset:51200
ds_read_b64_tr_b16 v[60:61], v246 offset:49152
v_mfma_f32_16x16x32_bf16 v[100:103], v[12:15], v[36:39], v[100:103]
ds_read_b64_tr_b16 v[62:63], v246 offset:51200
v_mfma_f32_16x16x32_bf16 v[104:107], v[12:15], v[176:179], v[104:107]
ds_read_b64_tr_b16 v[44:45], v245 offset:49152
v_mfma_f32_16x16x32_bf16 v[108:111], v[12:15], v[40:43], v[108:111]
ds_read_b64_tr_b16 v[46:47], v245 offset:51200
v_mfma_f32_16x16x32_bf16 v[112:115], v[16:19], v[40:43], v[112:115]
ds_read_b64_tr_b16 v[68:69], v244 offset:49152
v_mfma_f32_16x16x32_bf16 v[120:123], v[16:19], v[176:179], v[120:123]
ds_read_b64_tr_b16 v[70:71], v244 offset:51200
ds_read_b64_tr_b16 v[8:9], v243 offset:49152
v_mfma_f32_16x16x32_bf16 v[124:127], v[16:19], v[36:39], v[124:127]
ds_read_b64_tr_b16 v[10:11], v243 offset:51200
v_mfma_f32_16x16x32_bf16 v[128:131], v[48:51], v[36:39], v[128:131]
ds_read_b64_tr_b16 v[140:141], v242 offset:49152
v_mfma_f32_16x16x32_bf16 v[136:139], v[48:51], v[176:179], v[136:139]
ds_read_b64_tr_b16 v[142:143], v242 offset:51200
v_mfma_f32_16x16x32_bf16 v[28:31], v[48:51], v[40:43], v[28:31]
ds_read_b64_tr_b16 v[12:13], v241 offset:49152
v_mfma_f32_16x16x32_bf16 v[144:147], v[76:79], v[40:43], v[144:147]
ds_read_b64_tr_b16 v[14:15], v241 offset:51200
v_mfma_f32_16x16x32_bf16 v[148:151], v[76:79], v[176:179], v[148:151]
v_mfma_f32_16x16x32_bf16 v[152:155], v[76:79], v[36:39], v[152:155]
v_mfma_f32_16x16x32_bf16 v[32:35], v[88:91], v[36:39], v[32:35]
v_mfma_f32_16x16x32_bf16 v[156:159], v[88:91], v[176:179], v[156:159]
v_mfma_f32_16x16x32_bf16 v[160:163], v[88:91], v[40:43], v[160:163]
v_mfma_f32_16x16x32_bf16 v[164:167], v[96:99], v[40:43], v[164:167]
v_mfma_f32_16x16x32_bf16 v[168:171], v[96:99], v[176:179], v[168:171]
v_mfma_f32_16x16x32_bf16 v[172:175], v[96:99], v[36:39], v[172:175]
s_waitcnt vmcnt(0)
s_cmp_lg_u32 s78, 0
s_cbranch_scc1 L_nopub
s_mov_b64 exec, 1
buffer_store_dword v5, v4, s[68:71], s79 offen offset:0 sc0 sc1
s_mov_b64 exec, -1
L_nopub:
s_waitcnt lgkmcnt(0)
s_barrier
v_mfma_f32_16x16x32_bf16 v[52:55], v[132:135], v[20:23], v[52:55]
ds_read_b128 v[16:19], v240 offset:24576
ds_read_b128 v[36:39], v240 offset:26624
v_mfma_f32_16x16x32_bf16 v[64:67], v[132:135], v[116:119], v[64:67]
ds_read_b128 v[40:43], v240 offset:28672
v_mfma_f32_16x16x32_bf16 v[72:75], v[132:135], v[24:27], v[72:75]
ds_read_b64_tr_b16 v[48:49], v247 offset:0
v_mfma_f32_16x16x32_bf16 v[80:83], v[56:59], v[24:27], v[80:83]
ds_read_b64_tr_b16 v[50:51], v247 offset:2048
v_mfma_f32_16x16x32_bf16 v[84:87], v[56:59], v[116:119], v[84:87]
ds_read_b64_tr_b16 v[4:5], v250 offset:0
v_mfma_f32_16x16x32_bf16 v[92:95], v[56:59], v[20:23], v[92:95]
ds_read_b64_tr_b16 v[6:7], v250 offset:2048
ds_read_b64_tr_b16 v[76:77], v246 offset:0
v_mfma_f32_16x16x32_bf16 v[100:103], v[60:63], v[20:23], v[100:103]
ds_read_b64_tr_b16 v[78:79], v246 offset:2048
v_mfma_f32_16x16x32_bf16 v[104:107], v[60:63], v[116:119], v[104:107]
ds_read_b64_tr_b16 v[88:89], v245 offset:0
v_mfma_f32_16x16x32_bf16 v[108:111], v[60:63], v[24:27], v[108:111]
ds_read_b64_tr_b16 v[90:91], v245 offset:2048
v_mfma_f32_16x16x32_bf16 v[112:115], v[44:47], v[24:27], v[112:115]
ds_read_b64_tr_b16 v[96:97], v244 offset:0
v_mfma_f32_16x16x32_bf16 v[120:123], v[44:47], v[116:119], v[120:123]
ds_read_b64_tr_b16 v[98:99], v244 offset:2048
ds_read_b64_tr_b16 v[56:57], v243 offset:0
v_mfma_f32_16x16x32_bf16 v[124:127], v[44:47], v[20:23], v[124:127]
ds_read_b64_tr_b16 v[58:59], v243 offset:2048
v_mfma_f32_16x16x32_bf16 v[128:131], v[68:71], v[20:23], v[128:131]
ds_read_b64_tr_b16 v[132:133], v242 offset:0
v_mfma_f32_16x16x32_bf16 v[136:139], v[68:71], v[116:119], v[136:139]
ds_read_b64_tr_b16 v[134:135], v242 offset:2048
v_mfma_f32_16x16x32_bf16 v[28:31], v[68:71], v[24:27], v[28:31]
ds_read_b64_tr_b16 v[60:61], v241 offset:0
v_mfma_f32_16x16x32_bf16 v[144:147], v[8:11], v[24:27], v[144:147]
ds_read_b64_tr_b16 v[62:63], v241 offset:2048
v_mfma_f32_16x16x32_bf16 v[148:151], v[8:11], v[116:119], v[148:151]
v_mfma_f32_16x16x32_bf16 v[152:155], v[8:11], v[20:23], v[152:155]
v_mfma_f32_16x16x32_bf16 v[32:35], v[140:143], v[20:23], v[32:35]
v_mfma_f32_16x16x32_bf16 v[156:159], v[140:143], v[116:119], v[156:159]
v_mfma_f32_16x16x32_bf16 v[160:163], v[140:143], v[24:27], v[160:163]
v_mfma_f32_16x16x32_bf16 v[164:167], v[12:15], v[24:27], v[164:167]
v_mfma_f32_16x16x32_bf16 v[168:171], v[12:15], v[116:119], v[168:171]
v_mfma_f32_16x16x32_bf16 v[172:175], v[12:15], v[20:23], v[172:175]
s_waitcnt lgkmcnt(0)
s_barrier
v_mfma_f32_16x16x32_bf16 v[52:55], v[48:51], v[16:19], v[52:55]
ds_read_b128 v[44:47], v239 offset:24576
ds_read_b128 v[68:71], v239 offset:26624
v_mfma_f32_16x16x32_bf16 v[64:67], v[48:51], v[36:39], v[64:67]
ds_read_b128 v[8:11], v239 offset:28672
v_mfma_f32_16x16x32_bf16 v[72:75], v[48:51], v[40:43], v[72:75]
ds_read_b64_tr_b16 v[140:141], v247 offset:16384
v_mfma_f32_16x16x32_bf16 v[80:83], v[4:7], v[40:43], v[80:83]
ds_read_b64_tr_b16 v[142:143], v247 offset:18432
v_mfma_f32_16x16x32_bf16 v[84:87], v[4:7], v[36:39], v[84:87]
ds_read_b64_tr_b16 v[12:13], v250 offset:16384
v_mfma_f32_16x16x32_bf16 v[92:95], v[4:7], v[16:19], v[92:95]
ds_read_b64_tr_b16 v[14:15], v250 offset:18432
ds_read_b64_tr_b16 v[20:21], v246 offset:16384
v_mfma_f32_16x16x32_bf16 v[100:103], v[76:79], v[16:19], v[100:103]
ds_read_b64_tr_b16 v[22:23], v246 offset:18432
v_mfma_f32_16x16x32_bf16 v[104:107], v[76:79], v[36:39], v[104:107]
ds_read_b64_tr_b16 v[24:25], v245 offset:16384
v_mfma_f32_16x16x32_bf16 v[108:111], v[76:79], v[40:43], v[108:111]
ds_read_b64_tr_b16 v[26:27], v245 offset:18432
v_mfma_f32_16x16x32_bf16 v[112:115], v[88:91], v[40:43], v[112:115]
ds_read_b64_tr_b16 v[48:49], v244 offset:16384
v_mfma_f32_16x16x32_bf16 v[120:123], v[88:91], v[36:39], v[120:123]
ds_read_b64_tr_b16 v[50:51], v244 offset:18432
ds_read_b64_tr_b16 v[4:5], v243 offset:16384
v_mfma_f32_16x16x32_bf16 v[124:127], v[88:91], v[16:19], v[124:127]
ds_read_b64_tr_b16 v[6:7], v243 offset:18432
v_mfma_f32_16x16x32_bf16 v[128:131], v[96:99], v[16:19], v[128:131]
ds_read_b64_tr_b16 v[116:117], v242 offset:16384
v_mfma_f32_16x16x32_bf16 v[136:139], v[96:99], v[36:39], v[136:139]
ds_read_b64_tr_b16 v[118:119], v242 offset:18432
v_mfma_f32_16x16x32_bf16 v[28:31], v[96:99], v[40:43], v[28:31]
ds_read_b64_tr_b16 v[76:77], v241 offset:16384
v_mfma_f32_16x16x32_bf16 v[144:147], v[56:59], v[40:43], v[144:147]
ds_read_b64_tr_b16 v[78:79], v241 offset:18432
v_mfma_f32_16x16x32_bf16 v[148:151], v[56:59], v[36:39], v[148:151]
v_mfma_f32_16x16x32_bf16 v[152:155], v[56:59], v[16:19], v[152:155]
v_mfma_f32_16x16x32_bf16 v[32:35], v[132:135], v[16:19], v[32:35]
v_mfma_f32_16x16x32_bf16 v[156:159], v[132:135], v[36:39], v[156:159]
v_mfma_f32_16x16x32_bf16 v[160:163], v[132:135], v[40:43], v[160:163]
v_mfma_f32_16x16x32_bf16 v[164:167], v[60:63], v[40:43], v[164:167]
v_mfma_f32_16x16x32_bf16 v[168:171], v[60:63], v[36:39], v[168:171]
v_mfma_f32_16x16x32_bf16 v[172:175], v[60:63], v[16:19], v[172:175]
s_waitcnt lgkmcnt(0)
s_barrier
v_mfma_f32_16x16x32_bf16 v[52:55], v[140:143], v[44:47], v[52:55]
ds_read_b128 v[88:91], v240 offset:36864
ds_read_b128 v[96:99], v240 offset:38912
v_mfma_f32_16x16x32_bf16 v[64:67], v[140:143], v[68:71], v[64:67]
ds_read_b128 v[56:59], v240 offset:40960
v_mfma_f32_16x16x32_bf16 v[72:75], v[140:143], v[8:11], v[72:75]
ds_read_b64_tr_b16 v[132:133], v247 offset:32768
v_mfma_f32_16x16x32_bf16 v[80:83], v[12:15], v[8:11], v[80:83]
ds_read_b64_tr_b16 v[134:135], v247 offset:34816
v_mfma_f32_16x16x32_bf16 v[84:87], v[12:15], v[68:71], v[84:87]
ds_read_b64_tr_b16 v[16:17], v250 offset:32768
v_mfma_f32_16x16x32_bf16 v[92:95], v[12:15], v[44:47], v[92:95]
ds_read_b64_tr_b16 v[18:19], v250 offset:34816
ds_read_b64_tr_b16 v[36:37], v246 offset:32768
v_mfma_f32_16x16x32_bf16 v[100:103], v[20:23], v[44:47], v[100:103]
ds_read_b64_tr_b16 v[38:39], v246 offset:34816
v_mfma_f32_16x16x32_bf16 v[104:107], v[20:23], v[68:71], v[104:107]
ds_read_b64_tr_b16 v[40:41], v245 offset:32768
v_mfma_f32_16x16x32_bf16 v[108:111], v[20:23], v[8:11], v[108:111]
ds_read_b64_tr_b16 v[42:43], v245 offset:34816
v_mfma_f32_16x16x32_bf16 v[112:115], v[24:27], v[8:11], v[112:115]
ds_read_b64_tr_b16 v[60:61], v244 offset:32768
v_mfma_f32_16x16x32_bf16 v[120:123], v[24:27], v[68:71], v[120:123]
ds_read_b64_tr_b16 v[62:63], v244 offset:34816
ds_read_b64_tr_b16 v[12:13], v243 offset:32768
v_mfma_f32_16x16x32_bf16 v[124:127], v[24:27], v[44:47], v[124:127]
ds_read_b64_tr_b16 v[14:15], v243 offset:34816
v_mfma_f32_16x16x32_bf16 v[128:131], v[48:51], v[44:47], v[128:131]
ds_read_b64_tr_b16 v[140:141], v242 offset:32768
v_mfma_f32_16x16x32_bf16 v[136:139], v[48:51], v[68:71], v[136:139]
ds_read_b64_tr_b16 v[142:143], v242 offset:34816
v_mfma_f32_16x16x32_bf16 v[28:31], v[48:51], v[8:11], v[28:31]
ds_read_b64_tr_b16 v[20:21], v241 offset:32768
v_mfma_f32_16x16x32_bf16 v[144:147], v[4:7], v[8:11], v[144:147]
ds_read_b64_tr_b16 v[22:23], v241 offset:34816
v_mfma_f32_16x16x32_bf16 v[148:151], v[4:7], v[68:71], v[148:151]
v_mfma_f32_16x16x32_bf16 v[152:155], v[4:7], v[44:47], v[152:155]
v_mfma_f32_16x16x32_bf16 v[32:35], v[116:119], v[44:47], v[32:35]
v_mfma_f32_16x16x32_bf16 v[156:159], v[116:119], v[68:71], v[156:159]
v_mfma_f32_16x16x32_bf16 v[160:163], v[116:119], v[8:11], v[160:163]
v_mfma_f32_16x16x32_bf16 v[164:167], v[76:79], v[8:11], v[164:167]
v_mfma_f32_16x16x32_bf16 v[168:171], v[76:79], v[68:71], v[168:171]
v_mfma_f32_16x16x32_bf16 v[172:175], v[76:79], v[44:47], v[172:175]
s_waitcnt lgkmcnt(0)
s_barrier
v_mfma_f32_16x16x32_bf16 v[52:55], v[132:135], v[88:91], v[52:55]
ds_read_b128 v[24:27], v239 offset:36864
ds_read_b128 v[48:51], v239 offset:38912
v_mfma_f32_16x16x32_bf16 v[64:67], v[132:135], v[96:99], v[64:67]
ds_read_b128 v[4:7], v239 offset:40960
v_mfma_f32_16x16x32_bf16 v[72:75], v[132:135], v[56:59], v[72:75]
ds_read_b64_tr_b16 v[116:117], v247 offset:49152
v_mfma_f32_16x16x32_bf16 v[80:83], v[16:19], v[56:59], v[80:83]
ds_read_b64_tr_b16 v[118:119], v247 offset:51200
v_mfma_f32_16x16x32_bf16 v[84:87], v[16:19], v[96:99], v[84:87]
ds_read_b64_tr_b16 v[8:9], v250 offset:49152
v_mfma_f32_16x16x32_bf16 v[92:95], v[16:19], v[88:91], v[92:95]
ds_read_b64_tr_b16 v[10:11], v250 offset:51200
ds_read_b64_tr_b16 v[44:45], v246 offset:49152
v_mfma_f32_16x16x32_bf16 v[100:103], v[36:39], v[88:91], v[100:103]
ds_read_b64_tr_b16 v[46:47], v246 offset:51200
v_mfma_f32_16x16x32_bf16 v[104:107], v[36:39], v[96:99], v[104:107]
ds_read_b64_tr_b16 v[68:69], v245 offset:49152
v_mfma_f32_16x16x32_bf16 v[108:111], v[36:39], v[56:59], v[108:111]
ds_read_b64_tr_b16 v[70:71], v245 offset:51200
v_mfma_f32_16x16x32_bf16 v[112:115], v[40:43], v[56:59], v[112:115]
ds_read_b64_tr_b16 v[76:77], v244 offset:49152
v_mfma_f32_16x16x32_bf16 v[120:123], v[40:43], v[96:99], v[120:123]
ds_read_b64_tr_b16 v[78:79], v244 offset:51200
ds_read_b64_tr_b16 v[16:17], v243 offset:49152
v_mfma_f32_16x16x32_bf16 v[124:127], v[40:43], v[88:91], v[124:127]
ds_read_b64_tr_b16 v[18:19], v243 offset:51200
v_mfma_f32_16x16x32_bf16 v[128:131], v[60:63], v[88:91], v[128:131]
ds_read_b64_tr_b16 v[132:133], v242 offset:49152
v_mfma_f32_16x16x32_bf16 v[136:139], v[60:63], v[96:99], v[136:139]
ds_read_b64_tr_b16 v[134:135], v242 offset:51200
v_mfma_f32_16x16x32_bf16 v[28:31], v[60:63], v[56:59], v[28:31]
ds_read_b64_tr_b16 v[36:37], v241 offset:49152
v_mfma_f32_16x16x32_bf16 v[144:147], v[12:15], v[56:59], v[144:147]
ds_read_b64_tr_b16 v[38:39], v241 offset:51200
v_mfma_f32_16x16x32_bf16 v[148:151], v[12:15], v[96:99], v[148:151]
v_mfma_f32_16x16x32_bf16 v[152:155], v[12:15], v[88:91], v[152:155]
v_mfma_f32_16x16x32_bf16 v[32:35], v[140:143], v[88:91], v[32:35]
v_mfma_f32_16x16x32_bf16 v[156:159], v[140:143], v[96:99], v[156:159]
v_mfma_f32_16x16x32_bf16 v[160:163], v[140:143], v[56:59], v[160:163]
v_mfma_f32_16x16x32_bf16 v[164:167], v[20:23], v[56:59], v[164:167]
v_mfma_f32_16x16x32_bf16 v[168:171], v[20:23], v[96:99], v[168:171]
v_mfma_f32_16x16x32_bf16 v[172:175], v[20:23], v[88:91], v[172:175]
s_waitcnt lgkmcnt(0)
s_barrier
v_mfma_f32_16x16x32_bf16 v[52:55], v[116:119], v[24:27], v[52:55]
ds_read_b128 v[40:43], v240 offset:0
ds_read_b128 v[60:63], v240 offset:2048
v_mfma_f32_16x16x32_bf16 v[64:67], v[116:119], v[48:51], v[64:67]
ds_read_b128 v[12:15], v240 offset:4096
v_mfma_f32_16x16x32_bf16 v[72:75], v[116:119], v[4:7], v[72:75]
ds_read_b64_tr_b16 v[140:141], v247 offset:0
v_mfma_f32_16x16x32_bf16 v[80:83], v[8:11], v[4:7], v[80:83]
ds_read_b64_tr_b16 v[142:143], v247 offset:2048
v_mfma_f32_16x16x32_bf16 v[84:87], v[8:11], v[48:51], v[84:87]
ds_read_b64_tr_b16 v[20:21], v250 offset:0
v_mfma_f32_16x16x32_bf16 v[92:95], v[8:11], v[24:27], v[92:95]
ds_read_b64_tr_b16 v[22:23], v250 offset:2048
ds_read_b64_tr_b16 v[56:57], v246 offset:0
v_mfma_f32_16x16x32_bf16 v[100:103], v[44:47], v[24:27], v[100:103]
ds_read_b64_tr_b16 v[58:59], v246 offset:2048
v_mfma_f32_16x16x32_bf16 v[104:107], v[44:47], v[48:51], v[104:107]
ds_read_b64_tr_b16 v[88:89], v245 offset:0
v_mfma_f32_16x16x32_bf16 v[108:111], v[44:47], v[4:7], v[108:111]
ds_read_b64_tr_b16 v[90:91], v245 offset:2048
v_mfma_f32_16x16x32_bf16 v[112:115], v[68:71], v[4:7], v[112:115]
ds_read_b64_tr_b16 v[96:97], v244 offset:0
v_mfma_f32_16x16x32_bf16 v[120:123], v[68:71], v[48:51], v[120:123]
ds_read_b64_tr_b16 v[98:99], v244 offset:2048
ds_read_b64_tr_b16 v[8:9], v243 offset:0
v_mfma_f32_16x16x32_bf16 v[124:127], v[68:71], v[24:27], v[124:127]
ds_read_b64_tr_b16 v[10:11], v243 offset:2048
v_mfma_f32_16x16x32_bf16 v[128:131], v[76:79], v[24:27], v[128:131]
ds_read_b64_tr_b16 v[116:117], v242 offset:0
v_mfma_f32_16x16x32_bf16 v[136:139], v[76:79], v[48:51], v[136:139]
ds_read_b64_tr_b16 v[118:119], v242 offset:2048
v_mfma_f32_16x16x32_bf16 v[28:31], v[76:79], v[4:7], v[28:31]
ds_read_b64_tr_b16 v[44:45], v241 offset:0
v_mfma_f32_16x16x32_bf16 v[144:147], v[16:19], v[4:7], v[144:147]
ds_read_b64_tr_b16 v[46:47], v241 offset:2048
v_mfma_f32_16x16x32_bf16 v[148:151], v[16:19], v[48:51], v[148:151]
v_mfma_f32_16x16x32_bf16 v[152:155], v[16:19], v[24:27], v[152:155]
v_mfma_f32_16x16x32_bf16 v[32:35], v[132:135], v[24:27], v[32:35]
v_mfma_f32_16x16x32_bf16 v[156:159], v[132:135], v[48:51], v[156:159]
v_mfma_f32_16x16x32_bf16 v[160:163], v[132:135], v[4:7], v[160:163]
v_mfma_f32_16x16x32_bf16 v[164:167], v[36:39], v[4:7], v[164:167]
v_mfma_f32_16x16x32_bf16 v[168:171], v[36:39], v[48:51], v[168:171]
v_mfma_f32_16x16x32_bf16 v[172:175], v[36:39], v[24:27], v[172:175]
s_waitcnt lgkmcnt(0)
s_barrier
v_mfma_f32_16x16x32_bf16 v[52:55], v[140:143], v[40:43], v[52:55]
ds_read_b128 v[68:71], v239 offset:0
ds_read_b128 v[76:79], v239 offset:2048
v_mfma_f32_16x16x32_bf16 v[64:67], v[140:143], v[60:63], v[64:67]
ds_read_b128 v[16:19], v239 offset:4096
v_mfma_f32_16x16x32_bf16 v[72:75], v[140:143], v[12:15], v[72:75]
ds_read_b64_tr_b16 v[132:133], v247 offset:16384
v_mfma_f32_16x16x32_bf16 v[80:83], v[20:23], v[12:15], v[80:83]
ds_read_b64_tr_b16 v[134:135], v247 offset:18432
v_mfma_f32_16x16x32_bf16 v[84:87], v[20:23], v[60:63], v[84:87]
ds_read_b64_tr_b16 v[4:5], v250 offset:16384
v_mfma_f32_16x16x32_bf16 v[92:95], v[20:23], v[40:43], v[92:95]
ds_read_b64_tr_b16 v[6:7], v250 offset:18432
ds_read_b64_tr_b16 v[24:25], v246 offset:16384
v_mfma_f32_16x16x32_bf16 v[100:103], v[56:59], v[40:43], v[100:103]
ds_read_b64_tr_b16 v[26:27], v246 offset:18432
v_mfma_f32_16x16x32_bf16 v[104:107], v[56:59], v[60:63], v[104:107]
ds_read_b64_tr_b16 v[36:37], v245 offset:16384
v_mfma_f32_16x16x32_bf16 v[108:111], v[56:59], v[12:15], v[108:111]
ds_read_b64_tr_b16 v[38:39], v245 offset:18432
v_mfma_f32_16x16x32_bf16 v[112:115], v[88:91], v[12:15], v[112:115]
ds_read_b64_tr_b16 v[48:49], v244 offset:16384
v_mfma_f32_16x16x32_bf16 v[120:123], v[88:91], v[60:63], v[120:123]
ds_read_b64_tr_b16 v[50:51], v244 offset:18432
ds_read_b64_tr_b16 v[20:21], v243 offset:16384
v_mfma_f32_16x16x32_bf16 v[124:127], v[88:91], v[40:43], v[124:127]
ds_read_b64_tr_b16 v[22:23], v243 offset:18432
v_mfma_f32_16x16x32_bf16 v[128:131], v[96:99], v[40:43], v[128:131]
ds_read_b64_tr_b16 v[140:141], v242 offset:16384
v_mfma_f32_16x16x32_bf16 v[136:139], v[96:99], v[60:63], v[136:139]
ds_read_b64_tr_b16 v[142:143], v242 offset:18432
v_mfma_f32_16x16x32_bf16 v[28:31], v[96:99], v[12:15], v[28:31]
ds_read_b64_tr_b16 v[56:57], v241 offset:16384
v_mfma_f32_16x16x32_bf16 v[144:147], v[8:11], v[12:15], v[144:147]
ds_read_b64_tr_b16 v[58:59], v241 offset:18432
v_mfma_f32_16x16x32_bf16 v[148:151], v[8:11], v[60:63], v[148:151]
v_mfma_f32_16x16x32_bf16 v[152:155], v[8:11], v[40:43], v[152:155]
v_mfma_f32_16x16x32_bf16 v[32:35], v[116:119], v[40:43], v[32:35]
v_mfma_f32_16x16x32_bf16 v[156:159], v[116:119], v[60:63], v[156:159]
v_mfma_f32_16x16x32_bf16 v[160:163], v[116:119], v[12:15], v[160:163]
v_mfma_f32_16x16x32_bf16 v[164:167], v[44:47], v[12:15], v[164:167]
v_mfma_f32_16x16x32_bf16 v[168:171], v[44:47], v[60:63], v[168:171]
v_mfma_f32_16x16x32_bf16 v[172:175], v[44:47], v[40:43], v[172:175]
s_waitcnt lgkmcnt(0)
s_barrier
v_mfma_f32_16x16x32_bf16 v[52:55], v[132:135], v[68:71], v[52:55]
ds_read_b128 v[88:91], v240 offset:24576
ds_read_b128 v[96:99], v240 offset:26624
v_mfma_f32_16x16x32_bf16 v[64:67], v[132:135], v[76:79], v[64:67]
ds_read_b128 v[8:11], v240 offset:28672
v_mfma_f32_16x16x32_bf16 v[72:75], v[132:135], v[16:19], v[72:75]
ds_read_b64_tr_b16 v[116:117], v247 offset:32768
v_mfma_f32_16x16x32_bf16 v[80:83], v[4:7], v[16:19], v[80:83]
ds_read_b64_tr_b16 v[118:119], v247 offset:34816
v_mfma_f32_16x16x32_bf16 v[84:87], v[4:7], v[76:79], v[84:87]
ds_read_b64_tr_b16 v[12:13], v250 offset:32768
v_mfma_f32_16x16x32_bf16 v[92:95], v[4:7], v[68:71], v[92:95]
ds_read_b64_tr_b16 v[14:15], v250 offset:34816
ds_read_b64_tr_b16 v[40:41], v246 offset:32768
v_mfma_f32_16x16x32_bf16 v[100:103], v[24:27], v[68:71], v[100:103]
ds_read_b64_tr_b16 v[42:43], v246 offset:34816
v_mfma_f32_16x16x32_bf16 v[104:107], v[24:27], v[76:79], v[104:107]
ds_read_b64_tr_b16 v[44:45], v245 offset:32768
v_mfma_f32_16x16x32_bf16 v[108:111], v[24:27], v[16:19], v[108:111]
ds_read_b64_tr_b16 v[46:47], v245 offset:34816
v_mfma_f32_16x16x32_bf16 v[112:115], v[36:39], v[16:19], v[112:115]
ds_read_b64_tr_b16 v[60:61], v244 offset:32768
v_mfma_f32_16x16x32_bf16 v[120:123], v[36:39], v[76:79], v[120:123]
ds_read_b64_tr_b16 v[62:63], v244 offset:34816
ds_read_b64_tr_b16 v[4:5], v243 offset:32768
v_mfma_f32_16x16x32_bf16 v[124:127], v[36:39], v[68:71], v[124:127]
ds_read_b64_tr_b16 v[6:7], v243 offset:34816
v_mfma_f32_16x16x32_bf16 v[128:131], v[48:51], v[68:71], v[128:131]
ds_read_b64_tr_b16 v[132:133], v242 offset:32768
v_mfma_f32_16x16x32_bf16 v[136:139], v[48:51], v[76:79], v[136:139]
ds_read_b64_tr_b16 v[134:135], v242 offset:34816
v_mfma_f32_16x16x32_bf16 v[28:31], v[48:51], v[16:19], v[28:31]
ds_read_b64_tr_b16 v[24:25], v241 offset:32768
v_mfma_f32_16x16x32_bf16 v[144:147], v[20:23], v[16:19], v[144:147]
ds_read_b64_tr_b16 v[26:27], v241 offset:34816
v_mfma_f32_16x16x32_bf16 v[148:151], v[20:23], v[76:79], v[148:151]
v_mfma_f32_16x16x32_bf16 v[152:155], v[20:23], v[68:71], v[152:155]
v_mfma_f32_16x16x32_bf16 v[32:35], v[140:143], v[68:71], v[32:35]
v_mfma_f32_16x16x32_bf16 v[156:159], v[140:143], v[76:79], v[156:159]
v_mfma_f32_16x16x32_bf16 v[160:163], v[140:143], v[16:19], v[160:163]
v_mfma_f32_16x16x32_bf16 v[164:167], v[56:59], v[16:19], v[164:167]
v_mfma_f32_16x16x32_bf16 v[168:171], v[56:59], v[76:79], v[168:171]
v_mfma_f32_16x16x32_bf16 v[172:175], v[56:59], v[68:71], v[172:175]
s_waitcnt lgkmcnt(0)
s_barrier
v_mfma_f32_16x16x32_bf16 v[52:55], v[116:119], v[88:91], v[52:55]
ds_read_b128 v[36:39], v239 offset:24576
ds_read_b128 v[48:51], v239 offset:26624
v_mfma_f32_16x16x32_bf16 v[64:67], v[116:119], v[96:99], v[64:67]
ds_read_b128 v[20:23], v239 offset:28672
v_mfma_f32_16x16x32_bf16 v[72:75], v[116:119], v[8:11], v[72:75]
ds_read_b64_tr_b16 v[140:141], v247 offset:49152
v_mfma_f32_16x16x32_bf16 v[80:83], v[12:15], v[8:11], v[80:83]
ds_read_b64_tr_b16 v[142:143], v247 offset:51200
v_mfma_f32_16x16x32_bf16 v[84:87], v[12:15], v[96:99], v[84:87]
ds_read_b64_tr_b16 v[16:17], v250 offset:49152
v_mfma_f32_16x16x32_bf16 v[92:95], v[12:15], v[88:91], v[92:95]
ds_read_b64_tr_b16 v[18:19], v250 offset:51200
ds_read_b64_tr_b16 v[56:57], v246 offset:49152
v_mfma_f32_16x16x32_bf16 v[100:103], v[40:43], v[88:91], v[100:103]
ds_read_b64_tr_b16 v[58:59], v246 offset:51200
v_mfma_f32_16x16x32_bf16 v[104:107], v[40:43], v[96:99], v[104:107]
ds_read_b64_tr_b16 v[68:69], v245 offset:49152
v_mfma_f32_16x16x32_bf16 v[108:111], v[40:43], v[8:11], v[108:111]
ds_read_b64_tr_b16 v[70:71], v245 offset:51200
v_mfma_f32_16x16x32_bf16 v[112:115], v[44:47], v[8:11], v[112:115]
ds_read_b64_tr_b16 v[76:77], v244 offset:49152
v_mfma_f32_16x16x32_bf16 v[120:123], v[44:47], v[96:99], v[120:123]
ds_read_b64_tr_b16 v[78:79], v244 offset:51200
ds_read_b64_tr_b16 v[12:13], v243 offset:49152
v_mfma_f32_16x16x32_bf16 v[124:127], v[44:47], v[88:91], v[124:127]
ds_read_b64_tr_b16 v[14:15], v243 offset:51200
v_mfma_f32_16x16x32_bf16 v[128:131], v[60:63], v[88:91], v[128:131]
ds_read_b64_tr_b16 v[116:117], v242 offset:49152
v_mfma_f32_16x16x32_bf16 v[136:139], v[60:63], v[96:99], v[136:139]
ds_read_b64_tr_b16 v[118:119], v242 offset:51200
v_mfma_f32_16x16x32_bf16 v[28:31], v[60:63], v[8:11], v[28:31]
ds_read_b64_tr_b16 v[40:41], v241 offset:49152
v_mfma_f32_16x16x32_bf16 v[144:147], v[4:7], v[8:11], v[144:147]
ds_read_b64_tr_b16 v[42:43], v241 offset:51200
v_mfma_f32_16x16x32_bf16 v[148:151], v[4:7], v[96:99], v[148:151]
v_mfma_f32_16x16x32_bf16 v[152:155], v[4:7], v[88:91], v[152:155]
v_mfma_f32_16x16x32_bf16 v[32:35], v[132:135], v[88:91], v[32:35]
v_mfma_f32_16x16x32_bf16 v[156:159], v[132:135], v[96:99], v[156:159]
v_mfma_f32_16x16x32_bf16 v[160:163], v[132:135], v[8:11], v[160:163]
v_mfma_f32_16x16x32_bf16 v[164:167], v[24:27], v[8:11], v[164:167]
v_mfma_f32_16x16x32_bf16 v[168:171], v[24:27], v[96:99], v[168:171]
v_mfma_f32_16x16x32_bf16 v[172:175], v[24:27], v[88:91], v[172:175]
s_waitcnt lgkmcnt(0)
s_barrier
v_mfma_f32_16x16x32_bf16 v[52:55], v[140:143], v[36:39], v[52:55]
ds_read_b128 v[44:47], v240 offset:36864
ds_read_b128 v[60:63], v240 offset:38912
v_mfma_f32_16x16x32_bf16 v[64:67], v[140:143], v[48:51], v[64:67]
ds_read_b128 v[4:7], v240 offset:40960
v_mfma_f32_16x16x32_bf16 v[72:75], v[140:143], v[20:23], v[72:75]
ds_read_b64_tr_b16 v[132:133], v247 offset:0
v_mfma_f32_16x16x32_bf16 v[80:83], v[16:19], v[20:23], v[80:83]
ds_read_b64_tr_b16 v[134:135], v247 offset:2048
v_mfma_f32_16x16x32_bf16 v[84:87], v[16:19], v[48:51], v[84:87]
ds_read_b64_tr_b16 v[8:9], v250 offset:0
v_mfma_f32_16x16x32_bf16 v[92:95], v[16:19], v[36:39], v[92:95]
ds_read_b64_tr_b16 v[10:11], v250 offset:2048
ds_read_b64_tr_b16 v[24:25], v246 offset:0
v_mfma_f32_16x16x32_bf16 v[100:103], v[56:59], v[36:39], v[100:103]
ds_read_b64_tr_b16 v[26:27], v246 offset:2048
v_mfma_f32_16x16x32_bf16 v[104:107], v[56:59], v[48:51], v[104:107]
ds_read_b64_tr_b16 v[88:89], v245 offset:0
v_mfma_f32_16x16x32_bf16 v[108:111], v[56:59], v[20:23], v[108:111]
ds_read_b64_tr_b16 v[90:91], v245 offset:2048
v_mfma_f32_16x16x32_bf16 v[112:115], v[68:71], v[20:23], v[112:115]
ds_read_b64_tr_b16 v[96:97], v244 offset:0
v_mfma_f32_16x16x32_bf16 v[120:123], v[68:71], v[48:51], v[120:123]
ds_read_b64_tr_b16 v[98:99], v244 offset:2048
ds_read_b64_tr_b16 v[16:17], v243 offset:0
v_mfma_f32_16x16x32_bf16 v[124:127], v[68:71], v[36:39], v[124:127]
ds_read_b64_tr_b16 v[18:19], v243 offset:2048
v_mfma_f32_16x16x32_bf16 v[128:131], v[76:79], v[36:39], v[128:131]
ds_read_b64_tr_b16 v[140:141], v242 offset:0
v_mfma_f32_16x16x32_bf16 v[136:139], v[76:79], v[48:51], v[136:139]
ds_read_b64_tr_b16 v[142:143], v242 offset:2048
v_mfma_f32_16x16x32_bf16 v[28:31], v[76:79], v[20:23], v[28:31]
ds_read_b64_tr_b16 v[56:57], v241 offset:0
v_mfma_f32_16x16x32_bf16 v[144:147], v[12:15], v[20:23], v[144:147]
ds_read_b64_tr_b16 v[58:59], v241 offset:2048
v_mfma_f32_16x16x32_bf16 v[148:151], v[12:15], v[48:51], v[148:151]
v_mfma_f32_16x16x32_bf16 v[152:155], v[12:15], v[36:39], v[152:155]
v_mfma_f32_16x16x32_bf16 v[32:35], v[116:119], v[36:39], v[32:35]
v_mfma_f32_16x16x32_bf16 v[156:159], v[116:119], v[48:51], v[156:159]
v_mfma_f32_16x16x32_bf16 v[160:163], v[116:119], v[20:23], v[160:163]
v_mfma_f32_16x16x32_bf16 v[164:167], v[40:43], v[20:23], v[164:167]
v_mfma_f32_16x16x32_bf16 v[168:171], v[40:43], v[48:51], v[168:171]
v_mfma_f32_16x16x32_bf16 v[172:175], v[40:43], v[36:39], v[172:175]
s_waitcnt lgkmcnt(0)
s_barrier
v_mfma_f32_16x16x32_bf16 v[52:55], v[132:135], v[44:47], v[52:55]
ds_read_b128 v[68:71], v239 offset:36864
ds_read_b128 v[76:79], v239 offset:38912
v_mfma_f32_16x16x32_bf16 v[64:67], v[132:135], v[60:63], v[64:67]
ds_read_b128 v[12:15], v239 offset:40960
v_mfma_f32_16x16x32_bf16 v[72:75], v[132:135], v[4:7], v[72:75]
ds_read_b64_tr_b16 v[116:117], v247 offset:16384
v_mfma_f32_16x16x32_bf16 v[80:83], v[8:11], v[4:7], v[80:83]
ds_read_b64_tr_b16 v[118:119], v247 offset:18432
v_mfma_f32_16x16x32_bf16 v[84:87], v[8:11], v[60:63], v[84:87]
ds_read_b64_tr_b16 v[20:21], v250 offset:16384
v_mfma_f32_16x16x32_bf16 v[92:95], v[8:11], v[44:47], v[92:95]
ds_read_b64_tr_b16 v[22:23], v250 offset:18432
ds_read_b64_tr_b16 v[36:37], v246 offset:16384
v_mfma_f32_16x16x32_bf16 v[100:103], v[24:27], v[44:47], v[100:103]
ds_read_b64_tr_b16 v[38:39], v246 offset:18432
v_mfma_f32_16x16x32_bf16 v[104:107], v[24:27], v[60:63], v[104:107]
ds_read_b64_tr_b16 v[40:41], v245 offset:16384
v_mfma_f32_16x16x32_bf16 v[108:111], v[24:27], v[4:7], v[108:111]
ds_read_b64_tr_b16 v[42:43], v245 offset:18432
v_mfma_f32_16x16x32_bf16 v[112:115], v[88:91], v[4:7], v[112:115]
ds_read_b64_tr_b16 v[48:49], v244 offset:16384
v_mfma_f32_16x16x32_bf16 v[120:123], v[88:91], v[60:63], v[120:123]
ds_read_b64_tr_b16 v[50:51], v244 offset:18432
ds_read_b64_tr_b16 v[8:9], v243 offset:16384
v_mfma_f32_16x16x32_bf16 v[124:127], v[88:91], v[44:47], v[124:127]
ds_read_b64_tr_b16 v[10:11], v243 offset:18432
v_mfma_f32_16x16x32_bf16 v[128:131], v[96:99], v[44:47], v[128:131]
ds_read_b64_tr_b16 v[132:133], v242 offset:16384
v_mfma_f32_16x16x32_bf16 v[136:139], v[96:99], v[60:63], v[136:139]
ds_read_b64_tr_b16 v[134:135], v242 offset:18432
v_mfma_f32_16x16x32_bf16 v[28:31], v[96:99], v[4:7], v[28:31]
ds_read_b64_tr_b16 v[24:25], v241 offset:16384
v_mfma_f32_16x16x32_bf16 v[144:147], v[16:19], v[4:7], v[144:147]
ds_read_b64_tr_b16 v[26:27], v241 offset:18432
v_mfma_f32_16x16x32_bf16 v[148:151], v[16:19], v[60:63], v[148:151]
v_mfma_f32_16x16x32_bf16 v[152:155], v[16:19], v[44:47], v[152:155]
v_mfma_f32_16x16x32_bf16 v[32:35], v[140:143], v[44:47], v[32:35]
v_mfma_f32_16x16x32_bf16 v[156:159], v[140:143], v[60:63], v[156:159]
v_mfma_f32_16x16x32_bf16 v[160:163], v[140:143], v[4:7], v[160:163]
v_mfma_f32_16x16x32_bf16 v[164:167], v[56:59], v[4:7], v[164:167]
v_mfma_f32_16x16x32_bf16 v[168:171], v[56:59], v[60:63], v[168:171]
v_mfma_f32_16x16x32_bf16 v[172:175], v[56:59], v[44:47], v[172:175]
s_waitcnt lgkmcnt(0)
s_barrier
v_mfma_f32_16x16x32_bf16 v[52:55], v[116:119], v[68:71], v[52:55]
ds_read_b128 v[88:91], v240 offset:12288
ds_read_b128 v[96:99], v240 offset:14336
v_mfma_f32_16x16x32_bf16 v[64:67], v[116:119], v[76:79], v[64:67]
ds_read_b128 v[16:19], v240 offset:16384
v_mfma_f32_16x16x32_bf16 v[72:75], v[116:119], v[12:15], v[72:75]
ds_read_b64_tr_b16 v[140:141], v247 offset:32768
v_mfma_f32_16x16x32_bf16 v[80:83], v[20:23], v[12:15], v[80:83]
ds_read_b64_tr_b16 v[142:143], v247 offset:34816
v_mfma_f32_16x16x32_bf16 v[84:87], v[20:23], v[76:79], v[84:87]
ds_read_b64_tr_b16 v[4:5], v250 offset:32768
v_mfma_f32_16x16x32_bf16 v[92:95], v[20:23], v[68:71], v[92:95]
ds_read_b64_tr_b16 v[6:7], v250 offset:34816
ds_read_b64_tr_b16 v[44:45], v246 offset:32768
v_mfma_f32_16x16x32_bf16 v[100:103], v[36:39], v[68:71], v[100:103]
ds_read_b64_tr_b16 v[46:47], v246 offset:34816
v_mfma_f32_16x16x32_bf16 v[104:107], v[36:39], v[76:79], v[104:107]
ds_read_b64_tr_b16 v[56:57], v245 offset:32768
v_mfma_f32_16x16x32_bf16 v[108:111], v[36:39], v[12:15], v[108:111]
ds_read_b64_tr_b16 v[58:59], v245 offset:34816
v_mfma_f32_16x16x32_bf16 v[112:115], v[40:43], v[12:15], v[112:115]
ds_read_b64_tr_b16 v[60:61], v244 offset:32768
v_mfma_f32_16x16x32_bf16 v[120:123], v[40:43], v[76:79], v[120:123]
ds_read_b64_tr_b16 v[62:63], v244 offset:34816
ds_read_b64_tr_b16 v[20:21], v243 offset:32768
v_mfma_f32_16x16x32_bf16 v[124:127], v[40:43], v[68:71], v[124:127]
ds_read_b64_tr_b16 v[22:23], v243 offset:34816
v_mfma_f32_16x16x32_bf16 v[128:131], v[48:51], v[68:71], v[128:131]
ds_read_b64_tr_b16 v[116:117], v242 offset:32768
v_mfma_f32_16x16x32_bf16 v[136:139], v[48:51], v[76:79], v[136:139]
ds_read_b64_tr_b16 v[118:119], v242 offset:34816
v_mfma_f32_16x16x32_bf16 v[28:31], v[48:51], v[12:15], v[28:31]
ds_read_b64_tr_b16 v[36:37], v241 offset:32768
v_mfma_f32_16x16x32_bf16 v[144:147], v[8:11], v[12:15], v[144:147]
ds_read_b64_tr_b16 v[38:39], v241 offset:34816
v_mfma_f32_16x16x32_bf16 v[148:151], v[8:11], v[76:79], v[148:151]
v_mfma_f32_16x16x32_bf16 v[152:155], v[8:11], v[68:71], v[152:155]
v_mfma_f32_16x16x32_bf16 v[32:35], v[132:135], v[68:71], v[32:35]
v_mfma_f32_16x16x32_bf16 v[156:159], v[132:135], v[76:79], v[156:159]
v_mfma_f32_16x16x32_bf16 v[160:163], v[132:135], v[12:15], v[160:163]
v_mfma_f32_16x16x32_bf16 v[164:167], v[24:27], v[12:15], v[164:167]
v_mfma_f32_16x16x32_bf16 v[168:171], v[24:27], v[76:79], v[168:171]
v_mfma_f32_16x16x32_bf16 v[172:175], v[24:27], v[68:71], v[172:175]
s_waitcnt lgkmcnt(0)
s_barrier
v_mfma_f32_16x16x32_bf16 v[52:55], v[140:143], v[88:91], v[52:55]
ds_read_b128 v[40:43], v239 offset:12288
ds_read_b128 v[48:51], v239 offset:14336
v_mfma_f32_16x16x32_bf16 v[64:67], v[140:143], v[96:99], v[64:67]
ds_read_b128 v[8:11], v239 offset:16384
v_mfma_f32_16x16x32_bf16 v[72:75], v[140:143], v[16:19], v[72:75]
ds_read_b64_tr_b16 v[132:133], v247 offset:49152
v_mfma_f32_16x16x32_bf16 v[80:83], v[4:7], v[16:19], v[80:83]
ds_read_b64_tr_b16 v[134:135], v247 offset:51200
v_mfma_f32_16x16x32_bf16 v[84:87], v[4:7], v[96:99], v[84:87]
ds_read_b64_tr_b16 v[12:13], v250 offset:49152
v_mfma_f32_16x16x32_bf16 v[92:95], v[4:7], v[88:91], v[92:95]
ds_read_b64_tr_b16 v[14:15], v250 offset:51200
ds_read_b64_tr_b16 v[24:25], v246 offset:49152
v_mfma_f32_16x16x32_bf16 v[100:103], v[44:47], v[88:91], v[100:103]
ds_read_b64_tr_b16 v[26:27], v246 offset:51200
v_mfma_f32_16x16x32_bf16 v[104:107], v[44:47], v[96:99], v[104:107]
ds_read_b64_tr_b16 v[68:69], v245 offset:49152
v_mfma_f32_16x16x32_bf16 v[108:111], v[44:47], v[16:19], v[108:111]
ds_read_b64_tr_b16 v[70:71], v245 offset:51200
v_mfma_f32_16x16x32_bf16 v[112:115], v[56:59], v[16:19], v[112:115]
ds_read_b64_tr_b16 v[76:77], v244 offset:49152
v_mfma_f32_16x16x32_bf16 v[120:123], v[56:59], v[96:99], v[120:123]
ds_read_b64_tr_b16 v[78:79], v244 offset:51200
ds_read_b64_tr_b16 v[4:5], v243 offset:49152
v_mfma_f32_16x16x32_bf16 v[124:127], v[56:59], v[88:91], v[124:127]
ds_read_b64_tr_b16 v[6:7], v243 offset:51200
v_mfma_f32_16x16x32_bf16 v[128:131], v[60:63], v[88:91], v[128:131]
ds_read_b64_tr_b16 v[140:141], v242 offset:49152
v_mfma_f32_16x16x32_bf16 v[136:139], v[60:63], v[96:99], v[136:139]
ds_read_b64_tr_b16 v[142:143], v242 offset:51200
v_mfma_f32_16x16x32_bf16 v[28:31], v[60:63], v[16:19], v[28:31]
ds_read_b64_tr_b16 v[44:45], v241 offset:49152
v_mfma_f32_16x16x32_bf16 v[144:147], v[20:23], v[16:19], v[144:147]
ds_read_b64_tr_b16 v[46:47], v241 offset:51200
v_mfma_f32_16x16x32_bf16 v[148:151], v[20:23], v[96:99], v[148:151]
v_mfma_f32_16x16x32_bf16 v[152:155], v[20:23], v[88:91], v[152:155]
v_mfma_f32_16x16x32_bf16 v[32:35], v[116:119], v[88:91], v[32:35]
v_mfma_f32_16x16x32_bf16 v[156:159], v[116:119], v[96:99], v[156:159]
v_mfma_f32_16x16x32_bf16 v[160:163], v[116:119], v[16:19], v[160:163]
v_mfma_f32_16x16x32_bf16 v[164:167], v[36:39], v[16:19], v[164:167]
v_mfma_f32_16x16x32_bf16 v[168:171], v[36:39], v[96:99], v[168:171]
v_mfma_f32_16x16x32_bf16 v[172:175], v[36:39], v[88:91], v[172:175]
s_waitcnt lgkmcnt(0)
s_barrier
v_mfma_f32_16x16x32_bf16 v[52:55], v[132:135], v[40:43], v[52:55]
ds_read_b128 v[56:59], v240 offset:0
ds_read_b128 v[60:63], v240 offset:2048
v_mfma_f32_16x16x32_bf16 v[64:67], v[132:135], v[48:51], v[64:67]
ds_read_b128 v[20:23], v240 offset:4096
v_mfma_f32_16x16x32_bf16 v[72:75], v[132:135], v[8:11], v[72:75]
ds_read_b64_tr_b16 v[116:117], v247 offset:0
v_mfma_f32_16x16x32_bf16 v[80:83], v[12:15], v[8:11], v[80:83]
ds_read_b64_tr_b16 v[118:119], v247 offset:2048
v_mfma_f32_16x16x32_bf16 v[84:87], v[12:15], v[48:51], v[84:87]
ds_read_b64_tr_b16 v[16:17], v250 offset:0
v_mfma_f32_16x16x32_bf16 v[92:95], v[12:15], v[40:43], v[92:95]
ds_read_b64_tr_b16 v[18:19], v250 offset:2048
ds_read_b64_tr_b16 v[36:37], v246 offset:0
v_mfma_f32_16x16x32_bf16 v[100:103], v[24:27], v[40:43], v[100:103]
ds_read_b64_tr_b16 v[38:39], v246 offset:2048
v_mfma_f32_16x16x32_bf16 v[104:107], v[24:27], v[48:51], v[104:107]
ds_read_b64_tr_b16 v[88:89], v245 offset:0
v_mfma_f32_16x16x32_bf16 v[108:111], v[24:27], v[8:11], v[108:111]
ds_read_b64_tr_b16 v[90:91], v245 offset:2048
v_mfma_f32_16x16x32_bf16 v[112:115], v[68:71], v[8:11], v[112:115]
ds_read_b64_tr_b16 v[96:97], v244 offset:0
v_mfma_f32_16x16x32_bf16 v[120:123], v[68:71], v[48:51], v[120:123]
ds_read_b64_tr_b16 v[98:99], v244 offset:2048
ds_read_b64_tr_b16 v[12:13], v243 offset:0
v_mfma_f32_16x16x32_bf16 v[124:127], v[68:71], v[40:43], v[124:127]
ds_read_b64_tr_b16 v[14:15], v243 offset:2048
v_mfma_f32_16x16x32_bf16 v[128:131], v[76:79], v[40:43], v[128:131]
ds_read_b64_tr_b16 v[132:133], v242 offset:0
v_mfma_f32_16x16x32_bf16 v[136:139], v[76:79], v[48:51], v[136:139]
ds_read_b64_tr_b16 v[134:135], v242 offset:2048
v_mfma_f32_16x16x32_bf16 v[28:31], v[76:79], v[8:11], v[28:31]
ds_read_b64_tr_b16 v[24:25], v241 offset:0
v_mfma_f32_16x16x32_bf16 v[144:147], v[4:7], v[8:11], v[144:147]
ds_read_b64_tr_b16 v[26:27], v241 offset:2048
v_mfma_f32_16x16x32_bf16 v[148:151], v[4:7], v[48:51], v[148:151]
v_mfma_f32_16x16x32_bf16 v[152:155], v[4:7], v[40:43], v[152:155]
v_mfma_f32_16x16x32_bf16 v[32:35], v[140:143], v[40:43], v[32:35]
v_mfma_f32_16x16x32_bf16 v[156:159], v[140:143], v[48:51], v[156:159]
v_mfma_f32_16x16x32_bf16 v[160:163], v[140:143], v[8:11], v[160:163]
v_mfma_f32_16x16x32_bf16 v[164:167], v[44:47], v[8:11], v[164:167]
v_mfma_f32_16x16x32_bf16 v[168:171], v[44:47], v[48:51], v[168:171]
v_mfma_f32_16x16x32_bf16 v[172:175], v[44:47], v[40:43], v[172:175]
s_waitcnt lgkmcnt(0)
s_barrier
v_mfma_f32_16x16x32_bf16 v[52:55], v[116:119], v[56:59], v[52:55]
ds_read_b128 v[68:71], v239 offset:0
ds_read_b128 v[76:79], v239 offset:2048
v_mfma_f32_16x16x32_bf16 v[64:67], v[116:119], v[60:63], v[64:67]
ds_read_b128 v[4:7], v239 offset:4096
v_mfma_f32_16x16x32_bf16 v[72:75], v[116:119], v[20:23], v[72:75]
ds_read_b64_tr_b16 v[140:141], v247 offset:16384
v_mfma_f32_16x16x32_bf16 v[80:83], v[16:19], v[20:23], v[80:83]
ds_read_b64_tr_b16 v[142:143], v247 offset:18432
v_mfma_f32_16x16x32_bf16 v[84:87], v[16:19], v[60:63], v[84:87]
ds_read_b64_tr_b16 v[8:9], v250 offset:16384
v_mfma_f32_16x16x32_bf16 v[92:95], v[16:19], v[56:59], v[92:95]
ds_read_b64_tr_b16 v[10:11], v250 offset:18432
ds_read_b64_tr_b16 v[40:41], v246 offset:16384
v_mfma_f32_16x16x32_bf16 v[100:103], v[36:39], v[56:59], v[100:103]
ds_read_b64_tr_b16 v[42:43], v246 offset:18432
v_mfma_f32_16x16x32_bf16 v[104:107], v[36:39], v[60:63], v[104:107]
ds_read_b64_tr_b16 v[44:45], v245 offset:16384
v_mfma_f32_16x16x32_bf16 v[108:111], v[36:39], v[20:23], v[108:111]
ds_read_b64_tr_b16 v[46:47], v245 offset:18432
v_mfma_f32_16x16x32_bf16 v[112:115], v[88:91], v[20:23], v[112:115]
ds_read_b64_tr_b16 v[48:49], v244 offset:16384
v_mfma_f32_16x16x32_bf16 v[120:123], v[88:91], v[60:63], v[120:123]
ds_read_b64_tr_b16 v[50:51], v244 offset:18432
ds_read_b64_tr_b16 v[16:17], v243 offset:16384
v_mfma_f32_16x16x32_bf16 v[124:127], v[88:91], v[56:59], v[124:127]
ds_read_b64_tr_b16 v[18:19], v243 offset:18432
v_mfma_f32_16x16x32_bf16 v[128:131], v[96:99], v[56:59], v[128:131]
ds_read_b64_tr_b16 v[116:117], v242 offset:16384
v_mfma_f32_16x16x32_bf16 v[136:139], v[96:99], v[60:63], v[136:139]
ds_read_b64_tr_b16 v[118:119], v242 offset:18432
v_mfma_f32_16x16x32_bf16 v[28:31], v[96:99], v[20:23], v[28:31]
ds_read_b64_tr_b16 v[36:37], v241 offset:16384
v_mfma_f32_16x16x32_bf16 v[144:147], v[12:15], v[20:23], v[144:147]
ds_read_b64_tr_b16 v[38:39], v241 offset:18432
v_mfma_f32_16x16x32_bf16 v[148:151], v[12:15], v[60:63], v[148:151]
v_mfma_f32_16x16x32_bf16 v[152:155], v[12:15], v[56:59], v[152:155]
v_mfma_f32_16x16x32_bf16 v[32:35], v[132:135], v[56:59], v[32:35]
v_mfma_f32_16x16x32_bf16 v[156:159], v[132:135], v[60:63], v[156:159]
v_mfma_f32_16x16x32_bf16 v[160:163], v[132:135], v[20:23], v[160:163]
v_mfma_f32_16x16x32_bf16 v[164:167], v[24:27], v[20:23], v[164:167]
v_mfma_f32_16x16x32_bf16 v[168:171], v[24:27], v[60:63], v[168:171]
v_mfma_f32_16x16x32_bf16 v[172:175], v[24:27], v[56:59], v[172:175]
s_waitcnt lgkmcnt(0)
s_barrier
v_mfma_f32_16x16x32_bf16 v[52:55], v[140:143], v[68:71], v[52:55]
ds_read_b128 v[88:91], v240 offset:12288
ds_read_b128 v[96:99], v240 offset:14336
v_mfma_f32_16x16x32_bf16 v[64:67], v[140:143], v[76:79], v[64:67]
ds_read_b128 v[12:15], v240 offset:16384
v_mfma_f32_16x16x32_bf16 v[72:75], v[140:143], v[4:7], v[72:75]
ds_read_b64_tr_b16 v[132:133], v247 offset:32768
v_mfma_f32_16x16x32_bf16 v[80:83], v[8:11], v[4:7], v[80:83]
ds_read_b64_tr_b16 v[134:135], v247 offset:34816
v_mfma_f32_16x16x32_bf16 v[84:87], v[8:11], v[76:79], v[84:87]
ds_read_b64_tr_b16 v[20:21], v250 offset:32768
v_mfma_f32_16x16x32_bf16 v[92:95], v[8:11], v[68:71], v[92:95]
ds_read_b64_tr_b16 v[22:23], v250 offset:34816
ds_read_b64_tr_b16 v[24:25], v246 offset:32768
v_mfma_f32_16x16x32_bf16 v[100:103], v[40:43], v[68:71], v[100:103]
ds_read_b64_tr_b16 v[26:27], v246 offset:34816
v_mfma_f32_16x16x32_bf16 v[104:107], v[40:43], v[76:79], v[104:107]
ds_read_b64_tr_b16 v[56:57], v245 offset:32768
v_mfma_f32_16x16x32_bf16 v[108:111], v[40:43], v[4:7], v[108:111]
ds_read_b64_tr_b16 v[58:59], v245 offset:34816
v_mfma_f32_16x16x32_bf16 v[112:115], v[44:47], v[4:7], v[112:115]
ds_read_b64_tr_b16 v[60:61], v244 offset:32768
v_mfma_f32_16x16x32_bf16 v[120:123], v[44:47], v[76:79], v[120:123]
ds_read_b64_tr_b16 v[62:63], v244 offset:34816
ds_read_b64_tr_b16 v[8:9], v243 offset:32768
v_mfma_f32_16x16x32_bf16 v[124:127], v[44:47], v[68:71], v[124:127]
ds_read_b64_tr_b16 v[10:11], v243 offset:34816
v_mfma_f32_16x16x32_bf16 v[128:131], v[48:51], v[68:71], v[128:131]
ds_read_b64_tr_b16 v[140:141], v242 offset:32768
v_mfma_f32_16x16x32_bf16 v[136:139], v[48:51], v[76:79], v[136:139]
ds_read_b64_tr_b16 v[142:143], v242 offset:34816
v_mfma_f32_16x16x32_bf16 v[28:31], v[48:51], v[4:7], v[28:31]
ds_read_b64_tr_b16 v[40:41], v241 offset:32768
v_mfma_f32_16x16x32_bf16 v[144:147], v[16:19], v[4:7], v[144:147]
ds_read_b64_tr_b16 v[42:43], v241 offset:34816
v_mfma_f32_16x16x32_bf16 v[148:151], v[16:19], v[76:79], v[148:151]
v_mfma_f32_16x16x32_bf16 v[152:155], v[16:19], v[68:71], v[152:155]
v_mfma_f32_16x16x32_bf16 v[32:35], v[116:119], v[68:71], v[32:35]
v_mfma_f32_16x16x32_bf16 v[156:159], v[116:119], v[76:79], v[156:159]
v_mfma_f32_16x16x32_bf16 v[160:163], v[116:119], v[4:7], v[160:163]
v_mfma_f32_16x16x32_bf16 v[164:167], v[36:39], v[4:7], v[164:167]
v_mfma_f32_16x16x32_bf16 v[168:171], v[36:39], v[76:79], v[168:171]
v_mfma_f32_16x16x32_bf16 v[172:175], v[36:39], v[68:71], v[172:175]
s_waitcnt lgkmcnt(0)
s_barrier
v_mfma_f32_16x16x32_bf16 v[52:55], v[132:135], v[88:91], v[52:55]
ds_read_b128 v[44:47], v239 offset:12288
ds_read_b128 v[48:51], v239 offset:14336
v_mfma_f32_16x16x32_bf16 v[64:67], v[132:135], v[96:99], v[64:67]
ds_read_b128 v[16:19], v239 offset:16384
v_mfma_f32_16x16x32_bf16 v[72:75], v[132:135], v[12:15], v[72:75]
ds_read_b64_tr_b16 v[116:117], v247 offset:49152
v_mfma_f32_16x16x32_bf16 v[80:83], v[20:23], v[12:15], v[80:83]
ds_read_b64_tr_b16 v[118:119], v247 offset:51200
v_mfma_f32_16x16x32_bf16 v[84:87], v[20:23], v[96:99], v[84:87]
ds_read_b64_tr_b16 v[4:5], v250 offset:49152
v_mfma_f32_16x16x32_bf16 v[92:95], v[20:23], v[88:91], v[92:95]
ds_read_b64_tr_b16 v[6:7], v250 offset:51200
ds_read_b64_tr_b16 v[36:37], v246 offset:49152
v_mfma_f32_16x16x32_bf16 v[100:103], v[24:27], v[88:91], v[100:103]
ds_read_b64_tr_b16 v[38:39], v246 offset:51200
v_mfma_f32_16x16x32_bf16 v[104:107], v[24:27], v[96:99], v[104:107]
ds_read_b64_tr_b16 v[68:69], v245 offset:49152
v_mfma_f32_16x16x32_bf16 v[108:111], v[24:27], v[12:15], v[108:111]
ds_read_b64_tr_b16 v[70:71], v245 offset:51200
v_mfma_f32_16x16x32_bf16 v[112:115], v[56:59], v[12:15], v[112:115]
ds_read_b64_tr_b16 v[76:77], v244 offset:49152
v_mfma_f32_16x16x32_bf16 v[120:123], v[56:59], v[96:99], v[120:123]
ds_read_b64_tr_b16 v[78:79], v244 offset:51200
ds_read_b64_tr_b16 v[20:21], v243 offset:49152
v_mfma_f32_16x16x32_bf16 v[124:127], v[56:59], v[88:91], v[124:127]
ds_read_b64_tr_b16 v[22:23], v243 offset:51200
v_mfma_f32_16x16x32_bf16 v[128:131], v[60:63], v[88:91], v[128:131]
ds_read_b64_tr_b16 v[132:133], v242 offset:49152
v_mfma_f32_16x16x32_bf16 v[136:139], v[60:63], v[96:99], v[136:139]
ds_read_b64_tr_b16 v[134:135], v242 offset:51200
v_mfma_f32_16x16x32_bf16 v[28:31], v[60:63], v[12:15], v[28:31]
ds_read_b64_tr_b16 v[24:25], v241 offset:49152
v_mfma_f32_16x16x32_bf16 v[144:147], v[8:11], v[12:15], v[144:147]
ds_read_b64_tr_b16 v[26:27], v241 offset:51200
v_mfma_f32_16x16x32_bf16 v[148:151], v[8:11], v[96:99], v[148:151]
v_mfma_f32_16x16x32_bf16 v[152:155], v[8:11], v[88:91], v[152:155]
v_mfma_f32_16x16x32_bf16 v[32:35], v[140:143], v[88:91], v[32:35]
v_mfma_f32_16x16x32_bf16 v[156:159], v[140:143], v[96:99], v[156:159]
v_mfma_f32_16x16x32_bf16 v[160:163], v[140:143], v[12:15], v[160:163]
v_mfma_f32_16x16x32_bf16 v[164:167], v[40:43], v[12:15], v[164:167]
v_mfma_f32_16x16x32_bf16 v[168:171], v[40:43], v[96:99], v[168:171]
v_mfma_f32_16x16x32_bf16 v[172:175], v[40:43], v[88:91], v[172:175]
s_waitcnt lgkmcnt(0)
s_barrier
v_mfma_f32_16x16x32_bf16 v[52:55], v[116:119], v[44:47], v[52:55]
ds_read_b64 v[56:57], v238 offset:0
ds_read_b64 v[58:59], v237 offset:0
v_mfma_f32_16x16x32_bf16 v[92:95], v[4:7], v[44:47], v[92:95]
ds_read_b64 v[8:9], v238 offset:4096
ds_read_b64 v[10:11], v237 offset:4096
v_mfma_f32_16x16x32_bf16 v[100:103], v[36:39], v[44:47], v[100:103]
ds_read_b64 v[12:13], v238 offset:8192
ds_read_b64 v[14:15], v237 offset:8192
v_mfma_f32_16x16x32_bf16 v[124:127], v[68:71], v[44:47], v[124:127]
ds_read_b64 v[40:41], v238 offset:12288
ds_read_b64 v[42:43], v237 offset:12288
v_mfma_f32_16x16x32_bf16 v[128:131], v[76:79], v[44:47], v[128:131]
ds_read_b64 v[60:61], v238 offset:16384
ds_read_b64 v[62:63], v237 offset:16384
v_mfma_f32_16x16x32_bf16 v[152:155], v[20:23], v[44:47], v[152:155]
ds_read_b64 v[88:89], v238 offset:20480
ds_read_b64 v[90:91], v237 offset:20480
v_mfma_f32_16x16x32_bf16 v[32:35], v[132:135], v[44:47], v[32:35]
ds_read_b64 v[96:97], v236 offset:0
ds_read_b64 v[98:99], v235 offset:0
v_mfma_f32_16x16x32_bf16 v[172:175], v[24:27], v[44:47], v[172:175]
ds_read_b64 v[140:141], v236 offset:4096
ds_read_b64 v[142:143], v235 offset:4096
v_mfma_f32_16x16x32_bf16 v[168:171], v[24:27], v[48:51], v[168:171]
ds_read_b64 v[176:177], v236 offset:8192
ds_read_b64 v[178:179], v235 offset:8192
v_mfma_f32_16x16x32_bf16 v[156:159], v[132:135], v[48:51], v[156:159]
ds_read_b64 v[180:181], v236 offset:12288
ds_read_b64 v[182:183], v235 offset:12288
v_mfma_f32_16x16x32_bf16 v[148:151], v[20:23], v[48:51], v[148:151]
ds_read_b64 v[184:185], v236 offset:16384
ds_read_b64 v[186:187], v235 offset:16384
v_mfma_f32_16x16x32_bf16 v[136:139], v[76:79], v[48:51], v[136:139]
ds_read_b64 v[44:45], v236 offset:20480
ds_read_b64 v[46:47], v235 offset:20480
v_mfma_f32_16x16x32_bf16 v[120:123], v[68:71], v[48:51], v[120:123]
v_cvt_pk_bf16_f32 v52, v52, v53
v_cvt_pk_bf16_f32 v53, v54, v55
v_mfma_f32_16x16x32_bf16 v[104:107], v[36:39], v[48:51], v[104:107]
v_cvt_pk_bf16_f32 v54, v92, v93
v_cvt_pk_bf16_f32 v55, v94, v95
v_mfma_f32_16x16x32_bf16 v[84:87], v[4:7], v[48:51], v[84:87]
v_cvt_pk_bf16_f32 v100, v100, v101
v_cvt_pk_bf16_f32 v101, v102, v103
v_mfma_f32_16x16x32_bf16 v[64:67], v[116:119], v[48:51], v[64:67]
v_cvt_pk_bf16_f32 v102, v124, v125
v_cvt_pk_bf16_f32 v103, v126, v127
v_mfma_f32_16x16x32_bf16 v[72:75], v[116:119], v[16:19], v[72:75]
v_cvt_pk_bf16_f32 v128, v128, v129
v_cvt_pk_bf16_f32 v129, v130, v131
v_mfma_f32_16x16x32_bf16 v[80:83], v[4:7], v[16:19], v[80:83]
v_cvt_pk_bf16_f32 v130, v152, v153
v_cvt_pk_bf16_f32 v131, v154, v155
v_mfma_f32_16x16x32_bf16 v[108:111], v[36:39], v[16:19], v[108:111]
v_cvt_pk_bf16_f32 v32, v32, v33
v_cvt_pk_bf16_f32 v33, v34, v35
v_mfma_f32_16x16x32_bf16 v[112:115], v[68:71], v[16:19], v[112:115]
v_cvt_pk_bf16_f32 v34, v172, v173
v_cvt_pk_bf16_f32 v35, v174, v175
v_mfma_f32_16x16x32_bf16 v[28:31], v[76:79], v[16:19], v[28:31]
v_cvt_pk_bf16_f32 v156, v156, v157
v_cvt_pk_bf16_f32 v157, v158, v159
v_mfma_f32_16x16x32_bf16 v[144:147], v[20:23], v[16:19], v[144:147]
v_cvt_pk_bf16_f32 v158, v168, v169
v_cvt_pk_bf16_f32 v159, v170, v171
v_mfma_f32_16x16x32_bf16 v[160:163], v[132:135], v[16:19], v[160:163]
v_cvt_pk_bf16_f32 v136, v136, v137
v_cvt_pk_bf16_f32 v137, v138, v139
v_mfma_f32_16x16x32_bf16 v[164:167], v[24:27], v[16:19], v[164:167]
v_cvt_pk_bf16_f32 v138, v148, v149
v_cvt_pk_bf16_f32 v139, v150, v151
s_waitcnt lgkmcnt(0)
v_mfma_f32_16x16x32_bf16 v[4:7], v[56:59], v[52:55], 0
ds_read_b64 v[36:37], v234 offset:0
ds_read_b64 v[38:39], v233 offset:0
v_mfma_f32_16x16x32_bf16 v[20:23], v[8:11], v[52:55], 0
ds_read_b64 v[48:49], v234 offset:4096
ds_read_b64 v[50:51], v233 offset:4096
v_mfma_f32_16x16x32_bf16 v[68:71], v[12:15], v[52:55], 0
ds_read_b64 v[76:77], v234 offset:8192
ds_read_b64 v[78:79], v233 offset:8192
v_mfma_f32_16x16x32_bf16 v[16:19], v[40:43], v[52:55], 0
ds_read_b64 v[24:25], v234 offset:12288
ds_read_b64 v[26:27], v233 offset:12288
v_mfma_f32_16x16x32_bf16 v[92:95], v[60:63], v[52:55], 0
ds_read_b64 v[116:117], v234 offset:16384
ds_read_b64 v[118:119], v233 offset:16384
v_mfma_f32_16x16x32_bf16 v[124:127], v[88:91], v[52:55], 0
ds_read_b64 v[132:133], v234 offset:20480
ds_read_b64 v[134:135], v233 offset:20480
v_mfma_f32_16x16x32_bf16 v[4:7], v[96:99], v[100:103], v[4:7]
ds_read_b64 v[148:149], v232 offset:0
ds_read_b64 v[150:151], v253 offset:0
v_mfma_f32_16x16x32_bf16 v[20:23], v[140:143], v[100:103], v[20:23]
ds_read_b64 v[152:153], v232 offset:4096
ds_read_b64 v[154:155], v253 offset:4096
v_mfma_f32_16x16x32_bf16 v[68:71], v[176:179], v[100:103], v[68:71]
ds_read_b64 v[168:169], v232 offset:8192
ds_read_b64 v[170:171], v253 offset:8192
v_mfma_f32_16x16x32_bf16 v[16:19], v[180:183], v[100:103], v[16:19]
ds_read_b64 v[52:53], v232 offset:12288
ds_read_b64 v[54:55], v253 offset:12288
v_mfma_f32_16x16x32_bf16 v[92:95], v[184:187], v[100:103], v[92:95]
ds_read_b64 v[172:173], v232 offset:16384
ds_read_b64 v[174:175], v253 offset:16384
v_mfma_f32_16x16x32_bf16 v[124:127], v[44:47], v[100:103], v[124:127]
ds_read_b64 v[188:189], v232 offset:20480
ds_read_b64 v[190:191], v253 offset:20480
s_waitcnt lgkmcnt(12)
v_mfma_f32_16x16x32_bf16 v[4:7], v[36:39], v[128:131], v[4:7]
v_cvt_pk_bf16_f32 v104, v104, v105
v_cvt_pk_bf16_f32 v105, v106, v107
v_mfma_f32_16x16x32_bf16 v[20:23], v[48:51], v[128:131], v[20:23]
v_cvt_pk_bf16_f32 v106, v120, v121
v_cvt_pk_bf16_f32 v107, v122, v123
v_mfma_f32_16x16x32_bf16 v[68:71], v[76:79], v[128:131], v[68:71]
v_cvt_pk_bf16_f32 v64, v64, v65
v_cvt_pk_bf16_f32 v65, v66, v67
v_mfma_f32_16x16x32_bf16 v[16:19], v[24:27], v[128:131], v[16:19]
v_cvt_pk_bf16_f32 v66, v84, v85
v_cvt_pk_bf16_f32 v67, v86, v87
v_mfma_f32_16x16x32_bf16 v[92:95], v[116:119], v[128:131], v[92:95]
v_cvt_pk_bf16_f32 v72, v72, v73
v_cvt_pk_bf16_f32 v73, v74, v75
v_mfma_f32_16x16x32_bf16 v[124:127], v[132:135], v[128:131], v[124:127]
v_cvt_pk_bf16_f32 v74, v80, v81
v_cvt_pk_bf16_f32 v75, v82, v83
s_waitcnt lgkmcnt(0)
v_mfma_f32_16x16x32_bf16 v[4:7], v[148:151], v[32:35], v[4:7]
v_cvt_pk_bf16_f32 v108, v108, v109
v_cvt_pk_bf16_f32 v109, v110, v111
v_mfma_f32_16x16x32_bf16 v[20:23], v[152:155], v[32:35], v[20:23]
v_cvt_pk_bf16_f32 v110, v112, v113
v_cvt_pk_bf16_f32 v111, v114, v115
v_mfma_f32_16x16x32_bf16 v[68:71], v[168:171], v[32:35], v[68:71]
v_cvt_pk_bf16_f32 v28, v28, v29
v_cvt_pk_bf16_f32 v29, v30, v31
v_mfma_f32_16x16x32_bf16 v[16:19], v[52:55], v[32:35], v[16:19]
v_cvt_pk_bf16_f32 v30, v144, v145
v_cvt_pk_bf16_f32 v31, v146, v147
v_mfma_f32_16x16x32_bf16 v[92:95], v[172:175], v[32:35], v[92:95]
v_cvt_pk_bf16_f32 v160, v160, v161
v_cvt_pk_bf16_f32 v161, v162, v163
v_mfma_f32_16x16x32_bf16 v[124:127], v[188:191], v[32:35], v[124:127]
v_cvt_pk_bf16_f32 v162, v164, v165
v_cvt_pk_bf16_f32 v163, v166, v167
v_mfma_f32_16x16x32_bf16 v[80:83], v[56:59], v[64:67], 0
v_mov_b32 v84, 0x3f803f80
v_mov_b32 v85, 0x3f803f80
v_mfma_f32_16x16x32_bf16 v[100:103], v[8:11], v[64:67], 0
v_mov_b32 v86, 0x3f803f80
v_max3_f32 v112, v4, v5, v6
v_mfma_f32_16x16x32_bf16 v[120:123], v[12:15], v[64:67], 0
v_max_f32 v112, v112, v7
v_max3_f32 v112, v112, v20, v21
v_mfma_f32_16x16x32_bf16 v[32:35], v[40:43], v[64:67], 0
v_max3_f32 v112, v112, v22, v23
v_max3_f32 v112, v112, v68, v69
v_mfma_f32_16x16x32_bf16 v[128:131], v[60:63], v[64:67], 0
v_max3_f32 v112, v112, v70, v71
v_max3_f32 v112, v112, v16, v17
v_mfma_f32_16x16x32_bf16 v[144:147], v[88:91], v[64:67], 0
v_max3_f32 v112, v112, v18, v19
v_max3_f32 v112, v112, v92, v93
v_mfma_f32_16x16x32_bf16 v[80:83], v[96:99], v[104:107], v[80:83]
v_max3_f32 v112, v112, v94, v95
v_max3_f32 v112, v112, v124, v125
v_mfma_f32_16x16x32_bf16 v[100:103], v[140:143], v[104:107], v[100:103]
v_max3_f32 v112, v112, v126, v127
v_mov_b32 v253, v112
v_mfma_f32_16x16x32_bf16 v[120:123], v[176:179], v[104:107], v[120:123]
s_nop 0
v_permlane32_swap_b32 v112, v253
v_mfma_f32_16x16x32_bf16 v[32:35], v[180:183], v[104:107], v[32:35]
v_max_f32 v112, v112, v253
v_mov_b32 v253, v112
v_mfma_f32_16x16x32_bf16 v[128:131], v[184:187], v[104:107], v[128:131]
s_nop 0
v_permlane16_swap_b32 v112, v253
v_mfma_f32_16x16x32_bf16 v[144:147], v[44:47], v[104:107], v[144:147]
v_max_f32 v112, v112, v253
v_mul_f32 v112, s80, v112
v_mfma_f32_16x16x32_bf16 v[80:83], v[36:39], v[136:139], v[80:83]
v_fma_f32 v4, v4, s80, -v112
v_fma_f32 v5, v5, s80, -v112
v_mfma_f32_16x16x32_bf16 v[100:103], v[48:51], v[136:139], v[100:103]
v_fma_f32 v6, v6, s80, -v112
v_fma_f32 v7, v7, s80, -v112
v_mfma_f32_16x16x32_bf16 v[120:123], v[76:79], v[136:139], v[120:123]
v_fma_f32 v20, v20, s80, -v112
v_fma_f32 v21, v21, s80, -v112
v_mfma_f32_16x16x32_bf16 v[32:35], v[24:27], v[136:139], v[32:35]
v_fma_f32 v22, v22, s80, -v112
v_fma_f32 v23, v23, s80, -v112
v_mfma_f32_16x16x32_bf16 v[128:131], v[116:119], v[136:139], v[128:131]
v_fma_f32 v68, v68, s80, -v112
v_fma_f32 v69, v69, s80, -v112
v_mfma_f32_16x16x32_bf16 v[144:147], v[132:135], v[136:139], v[144:147]
v_fma_f32 v70, v70, s80, -v112
v_fma_f32 v71, v71, s80, -v112
v_mfma_f32_16x16x32_bf16 v[80:83], v[148:151], v[156:159], v[80:83]
v_fma_f32 v16, v16, s80, -v112
v_fma_f32 v17, v17, s80, -v112
v_mfma_f32_16x16x32_bf16 v[100:103], v[152:155], v[156:159], v[100:103]
v_fma_f32 v18, v18, s80, -v112
v_fma_f32 v19, v19, s80, -v112
v_mfma_f32_16x16x32_bf16 v[120:123], v[168:171], v[156:159], v[120:123]
v_fma_f32 v92, v92, s80, -v112
v_fma_f32 v93, v93, s80, -v112
v_mfma_f32_16x16x32_bf16 v[32:35], v[52:55], v[156:159], v[32:35]
v_fma_f32 v94, v94, s80, -v112
v_fma_f32 v95, v95, s80, -v112
v_mfma_f32_16x16x32_bf16 v[128:131], v[172:175], v[156:159], v[128:131]
v_fma_f32 v124, v124, s80, -v112
v_fma_f32 v125, v125, s80, -v112
v_mfma_f32_16x16x32_bf16 v[144:147], v[188:191], v[156:159], v[144:147]
v_fma_f32 v126, v126, s80, -v112
v_fma_f32 v127, v127, s80, -v112
v_mfma_f32_16x16x32_bf16 v[64:67], v[56:59], v[72:75], 0
v_exp_f32 v4, v4
v_mfma_f32_16x16x32_bf16 v[104:107], v[8:11], v[72:75], 0
v_exp_f32 v5, v5
v_mfma_f32_16x16x32_bf16 v[136:139], v[12:15], v[72:75], 0
v_mov_b32 v87, 0x3f803f80
v_max3_f32 v114, v80, v81, v82
v_mfma_f32_16x16x32_bf16 v[164:167], v[40:43], v[72:75], 0
v_max_f32 v114, v114, v83
v_max3_f32 v114, v114, v100, v101
v_mfma_f32_16x16x32_bf16 v[156:159], v[60:63], v[72:75], 0
v_max3_f32 v114, v114, v102, v103
v_max3_f32 v114, v114, v120, v121
v_mfma_f32_16x16x32_bf16 v[56:59], v[88:91], v[72:75], 0
v_max3_f32 v114, v114, v122, v123
v_max3_f32 v114, v114, v32, v33
v_mfma_f32_16x16x32_bf16 v[64:67], v[96:99], v[108:111], v[64:67]
v_max3_f32 v114, v114, v34, v35
v_max3_f32 v114, v114, v128, v129
v_mfma_f32_16x16x32_bf16 v[104:107], v[140:143], v[108:111], v[104:107]
v_max3_f32 v114, v114, v130, v131
v_max3_f32 v114, v114, v144, v145
v_mfma_f32_16x16x32_bf16 v[136:139], v[176:179], v[108:111], v[136:139]
v_max3_f32 v114, v114, v146, v147
v_mov_b32 v253, v114
v_mfma_f32_16x16x32_bf16 v[164:167], v[180:183], v[108:111], v[164:167]
s_nop 0
v_permlane32_swap_b32 v114, v253
v_mfma_f32_16x16x32_bf16 v[156:159], v[184:187], v[108:111], v[156:159]
v_max_f32 v114, v114, v253
v_mov_b32 v253, v114
v_mfma_f32_16x16x32_bf16 v[56:59], v[44:47], v[108:111], v[56:59]
s_nop 0
v_permlane16_swap_b32 v114, v253
v_mfma_f32_16x16x32_bf16 v[64:67], v[36:39], v[28:31], v[64:67]
v_max_f32 v114, v114, v253
v_mul_f32 v114, s80, v114
v_mfma_f32_16x16x32_bf16 v[104:107], v[48:51], v[28:31], v[104:107]
v_exp_f32 v6, v6
v_mfma_f32_16x16x32_bf16 v[136:139], v[76:79], v[28:31], v[136:139]
v_exp_f32 v7, v7
v_mfma_f32_16x16x32_bf16 v[164:167], v[24:27], v[28:31], v[164:167]
v_exp_f32 v20, v20
v_mfma_f32_16x16x32_bf16 v[156:159], v[116:119], v[28:31], v[156:159]
v_exp_f32 v21, v21
v_mfma_f32_16x16x32_bf16 v[56:59], v[132:135], v[28:31], v[56:59]
v_exp_f32 v22, v22
v_mfma_f32_16x16x32_bf16 v[64:67], v[148:151], v[160:163], v[64:67]
v_exp_f32 v23, v23
v_mfma_f32_16x16x32_bf16 v[104:107], v[152:155], v[160:163], v[104:107]
v_exp_f32 v68, v68
v_mfma_f32_16x16x32_bf16 v[136:139], v[168:171], v[160:163], v[136:139]
v_exp_f32 v69, v69
v_mfma_f32_16x16x32_bf16 v[164:167], v[52:55], v[160:163], v[164:167]
v_exp_f32 v70, v70
v_mfma_f32_16x16x32_bf16 v[156:159], v[172:175], v[160:163], v[156:159]
v_exp_f32 v71, v71
v_mfma_f32_16x16x32_bf16 v[56:59], v[188:191], v[160:163], v[56:59]
v_exp_f32 v16, v16
v_exp_f32 v17, v17
v_exp_f32 v18, v18
v_exp_f32 v19, v19
v_exp_f32 v92, v92
v_max3_f32 v8, v64, v65, v66
v_max_f32 v8, v8, v67
v_max3_f32 v8, v8, v104, v105
v_max3_f32 v8, v8, v106, v107
v_max3_f32 v8, v8, v136, v137
v_max3_f32 v8, v8, v138, v139
v_max3_f32 v8, v8, v164, v165
v_max3_f32 v8, v8, v166, v167
v_max3_f32 v8, v8, v156, v157
v_max3_f32 v8, v8, v158, v159
v_max3_f32 v8, v8, v56, v57
v_max3_f32 v8, v8, v58, v59
v_mov_b32 v253, v8
v_exp_f32 v93, v93
v_exp_f32 v94, v94
v_permlane32_swap_b32 v8, v253
v_max_f32 v8, v8, v253
v_mov_b32 v253, v8
v_exp_f32 v95, v95
v_exp_f32 v124, v124
v_permlane16_swap_b32 v8, v253
v_max_f32 v8, v8, v253
v_mul_f32 v8, s80, v8
v_exp_f32 v125, v125
v_exp_f32 v126, v126
v_exp_f32 v127, v127
v_cvt_pk_bf16_f32 v4, v4, v5
v_cvt_pk_bf16_f32 v5, v6, v7
v_cvt_pk_bf16_f32 v6, v20, v21
v_cvt_pk_bf16_f32 v7, v22, v23
v_cvt_pk_bf16_f32 v68, v68, v69
v_cvt_pk_bf16_f32 v69, v70, v71
v_cvt_pk_bf16_f32 v70, v16, v17
v_cvt_pk_bf16_f32 v71, v18, v19
v_cvt_pk_bf16_f32 v92, v92, v93
v_cvt_pk_bf16_f32 v93, v94, v95
v_cvt_pk_bf16_f32 v94, v124, v125
v_cvt_pk_bf16_f32 v95, v126, v127
v_pk_fma_f32 v[80:81], v[80:81], s[80:81], v[114:115] op_sel_hi:[1,0,0] neg_lo:[0,0,1] neg_hi:[0,0,1]
v_pk_fma_f32 v[82:83], v[82:83], s[80:81], v[114:115] op_sel_hi:[1,0,0] neg_lo:[0,0,1] neg_hi:[0,0,1]
v_pk_fma_f32 v[100:101], v[100:101], s[80:81], v[114:115] op_sel_hi:[1,0,0] neg_lo:[0,0,1] neg_hi:[0,0,1]
v_pk_fma_f32 v[102:103], v[102:103], s[80:81], v[114:115] op_sel_hi:[1,0,0] neg_lo:[0,0,1] neg_hi:[0,0,1]
v_exp_f32 v80, v80
v_mfma_f32_16x16x32_bf16 v[12:15], v[84:87], v[4:7], 0
v_exp_f32 v81, v81
v_mfma_f32_16x16x32_bf16 v[12:15], v[84:87], v[68:71], v[12:15]
v_exp_f32 v82, v82
v_mfma_f32_16x16x32_bf16 v[12:15], v[84:87], v[92:95], v[12:15]
v_exp_f32 v83, v83
v_exp_f32 v100, v100
v_exp_f32 v101, v101
v_exp_f32 v102, v102
v_exp_f32 v103, v103
v_cvt_pk_bf16_f32 v80, v80, v81
v_cvt_pk_bf16_f32 v81, v82, v83
v_cvt_pk_bf16_f32 v82, v100, v101
v_cvt_pk_bf16_f32 v83, v102, v103
v_pk_fma_f32 v[120:121], v[120:121], s[80:81], v[114:115] op_sel_hi:[1,0,0] neg_lo:[0,0,1] neg_hi:[0,0,1]
v_pk_fma_f32 v[122:123], v[122:123], s[80:81], v[114:115] op_sel_hi:[1,0,0] neg_lo:[0,0,1] neg_hi:[0,0,1]
v_pk_fma_f32 v[32:33], v[32:33], s[80:81], v[114:115] op_sel_hi:[1,0,0] neg_lo:[0,0,1] neg_hi:[0,0,1]
v_pk_fma_f32 v[34:35], v[34:35], s[80:81], v[114:115] op_sel_hi:[1,0,0] neg_lo:[0,0,1] neg_hi:[0,0,1]
v_exp_f32 v120, v120
v_mfma_f32_16x16x32_bf16 v[16:19], v[84:87], v[80:83], 0
v_exp_f32 v121, v121
v_exp_f32 v122, v122
v_exp_f32 v123, v123
v_exp_f32 v32, v32
v_exp_f32 v33, v33
v_exp_f32 v34, v34
v_exp_f32 v35, v35
v_cvt_pk_bf16_f32 v120, v120, v121
v_cvt_pk_bf16_f32 v121, v122, v123
v_cvt_pk_bf16_f32 v122, v32, v33
v_cvt_pk_bf16_f32 v123, v34, v35
v_pk_fma_f32 v[128:129], v[128:129], s[80:81], v[114:115] op_sel_hi:[1,0,0] neg_lo:[0,0,1] neg_hi:[0,0,1]
v_pk_fma_f32 v[130:131], v[130:131], s[80:81], v[114:115] op_sel_hi:[1,0,0] neg_lo:[0,0,1] neg_hi:[0,0,1]
v_pk_fma_f32 v[144:145], v[144:145], s[80:81], v[114:115] op_sel_hi:[1,0,0] neg_lo:[0,0,1] neg_hi:[0,0,1]
v_pk_fma_f32 v[146:147], v[146:147], s[80:81], v[114:115] op_sel_hi:[1,0,0] neg_lo:[0,0,1] neg_hi:[0,0,1]
v_exp_f32 v128, v128
v_mfma_f32_16x16x32_bf16 v[16:19], v[84:87], v[120:123], v[16:19]
v_exp_f32 v129, v129
v_exp_f32 v130, v130
v_exp_f32 v131, v131
v_exp_f32 v144, v144
v_exp_f32 v145, v145
v_exp_f32 v146, v146
v_exp_f32 v147, v147
v_cvt_pk_bf16_f32 v128, v128, v129
v_cvt_pk_bf16_f32 v129, v130, v131
v_cvt_pk_bf16_f32 v130, v144, v145
v_cvt_pk_bf16_f32 v131, v146, v147
s_barrier
ds_read_b64_tr_b16 v[20:21], v230 offset:24576
ds_read_b64_tr_b16 v[22:23], v230 offset:26624
ds_read_b64_tr_b16 v[24:25], v230 offset:28672
ds_read_b64_tr_b16 v[26:27], v230 offset:30720
ds_read_b64_tr_b16 v[28:29], v230 offset:32768
ds_read_b64_tr_b16 v[30:31], v230 offset:34816
ds_read_b64_tr_b16 v[32:33], v229 offset:24576
ds_read_b64_tr_b16 v[34:35], v229 offset:26624
ds_read_b64_tr_b16 v[36:37], v229 offset:28672
ds_read_b64_tr_b16 v[38:39], v229 offset:30720
ds_read_b64_tr_b16 v[40:41], v229 offset:32768
ds_read_b64_tr_b16 v[42:43], v229 offset:34816
v_pk_fma_f32 v[64:65], v[64:65], s[80:81], v[8:9] op_sel_hi:[1,0,0] neg_lo:[0,0,1] neg_hi:[0,0,1]
v_pk_fma_f32 v[66:67], v[66:67], s[80:81], v[8:9] op_sel_hi:[1,0,0] neg_lo:[0,0,1] neg_hi:[0,0,1]
v_pk_fma_f32 v[104:105], v[104:105], s[80:81], v[8:9] op_sel_hi:[1,0,0] neg_lo:[0,0,1] neg_hi:[0,0,1]
v_pk_fma_f32 v[106:107], v[106:107], s[80:81], v[8:9] op_sel_hi:[1,0,0] neg_lo:[0,0,1] neg_hi:[0,0,1]
v_exp_f32 v64, v64
v_mfma_f32_16x16x32_bf16 v[16:19], v[84:87], v[128:131], v[16:19]
v_exp_f32 v65, v65
v_exp_f32 v66, v66
v_exp_f32 v67, v67
v_exp_f32 v104, v104
v_exp_f32 v105, v105
v_exp_f32 v106, v106
v_exp_f32 v107, v107
v_cvt_pk_bf16_f32 v64, v64, v65
v_cvt_pk_bf16_f32 v65, v66, v67
v_cvt_pk_bf16_f32 v66, v104, v105
v_cvt_pk_bf16_f32 v67, v106, v107
s_waitcnt lgkmcnt(0)
v_pk_fma_f32 v[136:137], v[136:137], s[80:81], v[8:9] op_sel_hi:[1,0,0] neg_lo:[0,0,1] neg_hi:[0,0,1]
v_pk_fma_f32 v[138:139], v[138:139], s[80:81], v[8:9] op_sel_hi:[1,0,0] neg_lo:[0,0,1] neg_hi:[0,0,1]
v_pk_fma_f32 v[164:165], v[164:165], s[80:81], v[8:9] op_sel_hi:[1,0,0] neg_lo:[0,0,1] neg_hi:[0,0,1]
v_pk_fma_f32 v[166:167], v[166:167], s[80:81], v[8:9] op_sel_hi:[1,0,0] neg_lo:[0,0,1] neg_hi:[0,0,1]
v_exp_f32 v136, v136
v_mfma_f32_16x16x32_bf16 v[44:47], v[84:87], v[64:67], 0
ds_read_b64_tr_b16 v[48:49], v228 offset:24576
v_exp_f32 v137, v137
v_mfma_f32_16x16x32_bf16 v[52:55], v[20:23], v[4:7], 0
ds_read_b64_tr_b16 v[50:51], v228 offset:26624
v_exp_f32 v138, v138
v_mfma_f32_16x16x32_bf16 v[60:63], v[32:35], v[4:7], 0
ds_read_b64_tr_b16 v[72:73], v228 offset:28672
v_exp_f32 v139, v139
v_mfma_f32_16x16x32_bf16 v[52:55], v[24:27], v[68:71], v[52:55]
ds_read_b64_tr_b16 v[74:75], v228 offset:30720
v_exp_f32 v164, v164
v_mfma_f32_16x16x32_bf16 v[60:63], v[36:39], v[68:71], v[60:63]
ds_read_b64_tr_b16 v[76:77], v228 offset:32768
v_exp_f32 v165, v165
v_mfma_f32_16x16x32_bf16 v[52:55], v[28:31], v[92:95], v[52:55]
ds_read_b64_tr_b16 v[78:79], v228 offset:34816
v_exp_f32 v166, v166
v_mfma_f32_16x16x32_bf16 v[60:63], v[40:43], v[92:95], v[60:63]
ds_read_b64_tr_b16 v[88:89], v227 offset:24576
v_exp_f32 v167, v167
v_mfma_f32_16x16x32_bf16 v[96:99], v[20:23], v[80:83], 0
ds_read_b64_tr_b16 v[90:91], v227 offset:26624
v_cvt_pk_bf16_f32 v136, v136, v137
v_cvt_pk_bf16_f32 v137, v138, v139
v_cvt_pk_bf16_f32 v138, v164, v165
v_cvt_pk_bf16_f32 v139, v166, v167
v_pk_fma_f32 v[156:157], v[156:157], s[80:81], v[8:9] op_sel_hi:[1,0,0] neg_lo:[0,0,1] neg_hi:[0,0,1]
v_pk_fma_f32 v[158:159], v[158:159], s[80:81], v[8:9] op_sel_hi:[1,0,0] neg_lo:[0,0,1] neg_hi:[0,0,1]
v_pk_fma_f32 v[56:57], v[56:57], s[80:81], v[8:9] op_sel_hi:[1,0,0] neg_lo:[0,0,1] neg_hi:[0,0,1]
v_pk_fma_f32 v[58:59], v[58:59], s[80:81], v[8:9] op_sel_hi:[1,0,0] neg_lo:[0,0,1] neg_hi:[0,0,1]
v_exp_f32 v156, v156
v_mfma_f32_16x16x32_bf16 v[44:47], v[84:87], v[136:139], v[44:47]
ds_read_b64_tr_b16 v[100:101], v227 offset:28672
v_exp_f32 v157, v157
v_mfma_f32_16x16x32_bf16 v[104:107], v[32:35], v[80:83], 0
ds_read_b64_tr_b16 v[102:103], v227 offset:30720
v_exp_f32 v158, v158
v_mfma_f32_16x16x32_bf16 v[96:99], v[24:27], v[120:123], v[96:99]
ds_read_b64_tr_b16 v[108:109], v227 offset:32768
v_exp_f32 v159, v159
v_mfma_f32_16x16x32_bf16 v[104:107], v[36:39], v[120:123], v[104:107]
ds_read_b64_tr_b16 v[110:111], v227 offset:34816
v_exp_f32 v56, v56
v_mfma_f32_16x16x32_bf16 v[96:99], v[28:31], v[128:131], v[96:99]
v_exp_f32 v57, v57
v_mfma_f32_16x16x32_bf16 v[104:107], v[40:43], v[128:131], v[104:107]
v_exp_f32 v58, v58
v_mfma_f32_16x16x32_bf16 v[8:11], v[20:23], v[64:67], 0
v_exp_f32 v59, v59
v_mfma_f32_16x16x32_bf16 v[112:115], v[32:35], v[64:67], 0
v_cvt_pk_bf16_f32 v156, v156, v157
v_cvt_pk_bf16_f32 v157, v158, v159
v_cvt_pk_bf16_f32 v158, v56, v57
v_cvt_pk_bf16_f32 v159, v58, v59
v_mfma_f32_16x16x32_bf16 v[8:11], v[24:27], v[136:139], v[8:11]
v_rcp_f32 v253, v12
v_mfma_f32_16x16x32_bf16 v[112:115], v[36:39], v[136:139], v[112:115]
v_rcp_f32 v252, v16
v_mfma_f32_16x16x32_bf16 v[44:47], v[84:87], v[156:159], v[44:47]
v_mfma_f32_16x16x32_bf16 v[8:11], v[28:31], v[156:159], v[8:11]
v_mfma_f32_16x16x32_bf16 v[112:115], v[40:43], v[156:159], v[112:115]
s_waitcnt lgkmcnt(0)
s_barrier
v_mfma_f32_16x16x32_bf16 v[20:23], v[48:51], v[4:7], 0
ds_read_b64_tr_b16 v[32:33], v230 offset:0
ds_read_b64_tr_b16 v[34:35], v230 offset:2048
v_mfma_f32_16x16x32_bf16 v[24:27], v[48:51], v[80:83], 0
ds_read_b64_tr_b16 v[12:13], v230 offset:4096
ds_read_b64_tr_b16 v[14:15], v230 offset:6144
v_mfma_f32_16x16x32_bf16 v[16:19], v[48:51], v[64:67], 0
ds_read_b64_tr_b16 v[36:37], v230 offset:8192
ds_read_b64_tr_b16 v[38:39], v230 offset:10240
v_mfma_f32_16x16x32_bf16 v[16:19], v[72:75], v[136:139], v[16:19]
v_rcp_f32 v251, v44
ds_read_b64_tr_b16 v[28:29], v229 offset:0
ds_read_b64_tr_b16 v[30:31], v229 offset:2048
v_mfma_f32_16x16x32_bf16 v[24:27], v[72:75], v[120:123], v[24:27]
ds_read_b64_tr_b16 v[40:41], v229 offset:4096
ds_read_b64_tr_b16 v[42:43], v229 offset:6144
v_mul_f32 v52, v52, v253
v_mul_f32 v53, v53, v253
v_mul_f32 v54, v54, v253
v_mfma_f32_16x16x32_bf16 v[20:23], v[72:75], v[68:71], v[20:23]
ds_read_b64_tr_b16 v[48:49], v229 offset:8192
ds_read_b64_tr_b16 v[50:51], v229 offset:10240
v_mul_f32 v55, v55, v253
v_cvt_pk_bf16_f32 v52, v52, v53
v_cvt_pk_bf16_f32 v53, v54, v55
v_mfma_f32_16x16x32_bf16 v[20:23], v[76:79], v[92:95], v[20:23]
v_mul_f32 v60, v60, v253
v_mul_f32 v61, v61, v253
v_mul_f32 v62, v62, v253
v_mfma_f32_16x16x32_bf16 v[24:27], v[76:79], v[128:131], v[24:27]
v_mul_f32 v63, v63, v253
v_cvt_pk_bf16_f32 v54, v60, v61
v_cvt_pk_bf16_f32 v55, v62, v63
v_mfma_f32_16x16x32_bf16 v[16:19], v[76:79], v[156:159], v[16:19]
buffer_store_dwordx4 v[52:55], v207, s[72:75], s90 offen offset:0 sc1
v_mul_f32 v96, v96, v252
v_mfma_f32_16x16x32_bf16 v[44:47], v[88:91], v[4:7], 0
ds_write_b128 v207, v[52:55] offset:0
v_mul_f32 v97, v97, v252
v_mul_f32 v98, v98, v252
v_mul_f32 v99, v99, v252
v_mfma_f32_16x16x32_bf16 v[56:59], v[88:91], v[80:83], 0
v_cvt_pk_bf16_f32 v96, v96, v97
v_cvt_pk_bf16_f32 v97, v98, v99
v_mul_f32 v104, v104, v252
v_mfma_f32_16x16x32_bf16 v[60:63], v[88:91], v[64:67], 0
v_mul_f32 v105, v105, v252
v_mul_f32 v106, v106, v252
v_mul_f32 v107, v107, v252
v_mfma_f32_16x16x32_bf16 v[60:63], v[100:103], v[136:139], v[60:63]
v_cvt_pk_bf16_f32 v98, v104, v105
v_cvt_pk_bf16_f32 v99, v106, v107
buffer_store_dwordx4 v[96:99], v207, s[72:75], s90 offen offset:1024 sc1
v_mfma_f32_16x16x32_bf16 v[56:59], v[100:103], v[120:123], v[56:59]
v_mul_f32 v8, v8, v251
v_mul_f32 v9, v9, v251
v_mfma_f32_16x16x32_bf16 v[44:47], v[100:103], v[68:71], v[44:47]
ds_write_b128 v207, v[96:99] offset:1024
v_mul_f32 v10, v10, v251
v_mul_f32 v11, v11, v251
v_cvt_pk_bf16_f32 v8, v8, v9
v_mfma_f32_16x16x32_bf16 v[44:47], v[108:111], v[92:95], v[44:47]
v_cvt_pk_bf16_f32 v9, v10, v11
v_mul_f32 v112, v112, v251
v_mul_f32 v113, v113, v251
v_mfma_f32_16x16x32_bf16 v[56:59], v[108:111], v[128:131], v[56:59]
v_mul_f32 v114, v114, v251
v_mul_f32 v115, v115, v251
v_cvt_pk_bf16_f32 v10, v112, v113
v_mfma_f32_16x16x32_bf16 v[60:63], v[108:111], v[156:159], v[60:63]
v_cvt_pk_bf16_f32 v11, v114, v115
buffer_store_dwordx4 v[8:11], v207, s[72:75], s90 offen offset:2048 sc1
ds_write_b128 v207, v[8:11] offset:2048
s_waitcnt lgkmcnt(3)
v_mfma_f32_16x16x32_bf16 v[52:55], v[32:35], v[4:7], 0
ds_read_b64_tr_b16 v[72:73], v228 offset:0
ds_read_b64_tr_b16 v[74:75], v228 offset:2048
v_mfma_f32_16x16x32_bf16 v[76:79], v[32:35], v[80:83], 0
ds_read_b64_tr_b16 v[84:85], v228 offset:4096
ds_read_b64_tr_b16 v[86:87], v228 offset:6144
v_mfma_f32_16x16x32_bf16 v[88:91], v[32:35], v[64:67], 0
ds_read_b64_tr_b16 v[96:97], v228 offset:8192
ds_read_b64_tr_b16 v[98:99], v228 offset:10240
v_mfma_f32_16x16x32_bf16 v[88:91], v[12:15], v[136:139], v[88:91]
ds_read_b64_tr_b16 v[8:9], v227 offset:0
ds_read_b64_tr_b16 v[10:11], v227 offset:2048
v_mfma_f32_16x16x32_bf16 v[76:79], v[12:15], v[120:123], v[76:79]
ds_read_b64_tr_b16 v[100:101], v227 offset:4096
ds_read_b64_tr_b16 v[102:103], v227 offset:6144
v_mul_f32 v20, v20, v253
v_mul_f32 v21, v21, v253
v_mul_f32 v22, v22, v253
v_mfma_f32_16x16x32_bf16 v[52:55], v[12:15], v[68:71], v[52:55]
ds_read_b64_tr_b16 v[32:33], v227 offset:8192
ds_read_b64_tr_b16 v[34:35], v227 offset:10240
v_mul_f32 v23, v23, v253
v_cvt_pk_bf16_f32 v20, v20, v21
v_cvt_pk_bf16_f32 v21, v22, v23
v_mfma_f32_16x16x32_bf16 v[52:55], v[36:39], v[92:95], v[52:55]
v_mul_f32 v44, v44, v253
v_mul_f32 v45, v45, v253
v_mul_f32 v46, v46, v253
v_mfma_f32_16x16x32_bf16 v[76:79], v[36:39], v[128:131], v[76:79]
v_mul_f32 v47, v47, v253
v_cvt_pk_bf16_f32 v22, v44, v45
v_cvt_pk_bf16_f32 v23, v46, v47
v_mfma_f32_16x16x32_bf16 v[88:91], v[36:39], v[156:159], v[88:91]
buffer_store_dwordx4 v[20:23], v207, s[72:75], s91 offen offset:0 sc1
v_mul_f32 v24, v24, v252
v_mfma_f32_16x16x32_bf16 v[12:15], v[28:31], v[4:7], 0
ds_write_b128 v207, v[20:23] offset:12288
v_mul_f32 v25, v25, v252
v_mul_f32 v26, v26, v252
v_mul_f32 v27, v27, v252
v_mfma_f32_16x16x32_bf16 v[104:107], v[28:31], v[80:83], 0
v_cvt_pk_bf16_f32 v24, v24, v25
v_cvt_pk_bf16_f32 v25, v26, v27
v_mul_f32 v56, v56, v252
v_mfma_f32_16x16x32_bf16 v[36:39], v[28:31], v[64:67], 0
v_mul_f32 v57, v57, v252
v_mul_f32 v58, v58, v252
v_mul_f32 v59, v59, v252
v_mfma_f32_16x16x32_bf16 v[36:39], v[40:43], v[136:139], v[36:39]
v_cvt_pk_bf16_f32 v26, v56, v57
v_cvt_pk_bf16_f32 v27, v58, v59
buffer_store_dwordx4 v[24:27], v207, s[72:75], s91 offen offset:1024 sc1
v_mfma_f32_16x16x32_bf16 v[104:107], v[40:43], v[120:123], v[104:107]
v_mul_f32 v16, v16, v251
v_mul_f32 v17, v17, v251
v_mfma_f32_16x16x32_bf16 v[12:15], v[40:43], v[68:71], v[12:15]
ds_write_b128 v207, v[24:27] offset:13312
v_mul_f32 v18, v18, v251
v_mul_f32 v19, v19, v251
v_cvt_pk_bf16_f32 v16, v16, v17
v_mfma_f32_16x16x32_bf16 v[12:15], v[48:51], v[92:95], v[12:15]
v_cvt_pk_bf16_f32 v17, v18, v19
v_mul_f32 v60, v60, v251
v_mul_f32 v61, v61, v251
v_mfma_f32_16x16x32_bf16 v[104:107], v[48:51], v[128:131], v[104:107]
v_mul_f32 v62, v62, v251
v_mul_f32 v63, v63, v251
v_cvt_pk_bf16_f32 v18, v60, v61
v_mfma_f32_16x16x32_bf16 v[36:39], v[48:51], v[156:159], v[36:39]
v_cvt_pk_bf16_f32 v19, v62, v63
buffer_store_dwordx4 v[16:19], v207, s[72:75], s91 offen offset:2048 sc1
ds_write_b128 v207, v[16:19] offset:14336
s_waitcnt lgkmcnt(0)
s_waitcnt vmcnt(3)
s_barrier
v_mfma_f32_16x16x32_bf16 v[20:23], v[72:75], v[4:7], 0
ds_read_b128 v[24:27], v208 offset:0
ds_read_b128 v[28:31], v208 offset:1024
v_mfma_f32_16x16x32_bf16 v[40:43], v[72:75], v[80:83], 0
ds_read_b128 v[44:47], v208 offset:2048
ds_read_b64_tr_b16 v[48:49], v220 offset:0
v_mfma_f32_16x16x32_bf16 v[56:59], v[72:75], v[64:67], 0
ds_read_b64_tr_b16 v[50:51], v220 offset:2048
ds_read_b64_tr_b16 v[16:17], v219 offset:0
v_mfma_f32_16x16x32_bf16 v[56:59], v[84:87], v[136:139], v[56:59]
ds_read_b64_tr_b16 v[18:19], v219 offset:2048
ds_read_b64_tr_b16 v[60:61], v218 offset:0
v_mfma_f32_16x16x32_bf16 v[40:43], v[84:87], v[120:123], v[40:43]
ds_read_b64_tr_b16 v[62:63], v218 offset:2048
ds_read_b64_tr_b16 v[108:109], v217 offset:0
v_mul_f32 v52, v52, v253
v_mul_f32 v53, v53, v253
v_mul_f32 v54, v54, v253
v_mfma_f32_16x16x32_bf16 v[20:23], v[84:87], v[68:71], v[20:23]
ds_read_b64_tr_b16 v[110:111], v217 offset:2048
ds_read_b64_tr_b16 v[72:73], v216 offset:16384
v_mul_f32 v55, v55, v253
v_cvt_pk_bf16_f32 v52, v52, v53
v_cvt_pk_bf16_f32 v53, v54, v55
v_mfma_f32_16x16x32_bf16 v[20:23], v[96:99], v[92:95], v[20:23]
ds_read_b64_tr_b16 v[74:75], v216 offset:18432
ds_read_b64_tr_b16 v[112:113], v215 offset:16384
v_mul_f32 v12, v12, v253
v_mul_f32 v13, v13, v253
v_mul_f32 v14, v14, v253
v_mfma_f32_16x16x32_bf16 v[40:43], v[96:99], v[128:131], v[40:43]
ds_read_b64_tr_b16 v[114:115], v215 offset:18432
v_mul_f32 v15, v15, v253
v_cvt_pk_bf16_f32 v54, v12, v13
v_cvt_pk_bf16_f32 v55, v14, v15
v_mfma_f32_16x16x32_bf16 v[56:59], v[96:99], v[156:159], v[56:59]
buffer_store_dwordx4 v[52:55], v207, s[72:75], s92 offen offset:0 sc1
v_mul_f32 v76, v76, v252
v_mfma_f32_16x16x32_bf16 v[84:87], v[8:11], v[4:7], 0
ds_write_b128 v207, v[52:55] offset:24576
v_mul_f32 v77, v77, v252
v_mul_f32 v78, v78, v252
v_mul_f32 v79, v79, v252
v_mfma_f32_16x16x32_bf16 v[116:119], v[8:11], v[80:83], 0
v_cvt_pk_bf16_f32 v76, v76, v77
v_cvt_pk_bf16_f32 v77, v78, v79
v_mul_f32 v104, v104, v252
v_mfma_f32_16x16x32_bf16 v[12:15], v[8:11], v[64:67], 0
v_mul_f32 v105, v105, v252
v_mul_f32 v106, v106, v252
v_mul_f32 v107, v107, v252
v_mfma_f32_16x16x32_bf16 v[12:15], v[100:103], v[136:139], v[12:15]
v_cvt_pk_bf16_f32 v78, v104, v105
v_cvt_pk_bf16_f32 v79, v106, v107
buffer_store_dwordx4 v[76:79], v207, s[72:75], s92 offen offset:1024 sc1
v_mfma_f32_16x16x32_bf16 v[116:119], v[100:103], v[120:123], v[116:119]
v_mul_f32 v88, v88, v251
v_mul_f32 v89, v89, v251
v_mfma_f32_16x16x32_bf16 v[84:87], v[100:103], v[68:71], v[84:87]
ds_write_b128 v207, v[76:79] offset:25600
v_mul_f32 v90, v90, v251
v_mul_f32 v91, v91, v251
v_cvt_pk_bf16_f32 v88, v88, v89
v_mfma_f32_16x16x32_bf16 v[84:87], v[32:35], v[92:95], v[84:87]
v_cvt_pk_bf16_f32 v89, v90, v91
v_mul_f32 v36, v36, v251
v_mul_f32 v37, v37, v251
v_mfma_f32_16x16x32_bf16 v[116:119], v[32:35], v[128:131], v[116:119]
v_mul_f32 v38, v38, v251
v_mul_f32 v39, v39, v251
v_cvt_pk_bf16_f32 v90, v36, v37
v_mfma_f32_16x16x32_bf16 v[12:15], v[32:35], v[156:159], v[12:15]
v_cvt_pk_bf16_f32 v91, v38, v39
buffer_store_dwordx4 v[88:91], v207, s[72:75], s92 offen offset:2048 sc1
ds_write_b128 v207, v[88:91] offset:26624
s_waitcnt lgkmcnt(0)
v_mfma_f32_16x16x32_bf16 v[4:7], v[48:51], v[24:27], 0
ds_read_b128 v[8:11], v208 offset:6144
ds_read_b128 v[52:55], v208 offset:7168
v_mfma_f32_16x16x32_bf16 v[64:67], v[48:51], v[28:31], 0
ds_read_b128 v[68:71], v208 offset:8192
ds_read_b64_tr_b16 v[76:77], v220 offset:8192
v_mfma_f32_16x16x32_bf16 v[80:83], v[48:51], v[44:47], 0
ds_read_b64_tr_b16 v[78:79], v220 offset:10240
ds_read_b64_tr_b16 v[32:33], v219 offset:8192
v_mfma_f32_16x16x32_bf16 v[36:39], v[16:19], v[44:47], 0
ds_read_b64_tr_b16 v[34:35], v219 offset:10240
ds_read_b64_tr_b16 v[88:89], v218 offset:8192
v_mfma_f32_16x16x32_bf16 v[92:95], v[16:19], v[28:31], 0
ds_read_b64_tr_b16 v[90:91], v218 offset:10240
ds_read_b64_tr_b16 v[96:97], v217 offset:8192
v_mfma_f32_16x16x32_bf16 v[100:103], v[16:19], v[24:27], 0
ds_read_b64_tr_b16 v[98:99], v217 offset:10240
ds_read_b64_tr_b16 v[104:105], v216 offset:20480
v_mfma_f32_16x16x32_bf16 v[48:51], v[60:63], v[24:27], 0
ds_read_b64_tr_b16 v[106:107], v216 offset:22528
ds_read_b64_tr_b16 v[120:121], v215 offset:20480
v_mfma_f32_16x16x32_bf16 v[124:127], v[60:63], v[28:31], 0
ds_read_b64_tr_b16 v[122:123], v215 offset:22528
v_mfma_f32_16x16x32_bf16 v[128:131], v[60:63], v[44:47], 0
v_mul_f32 v20, v20, v253
v_mul_f32 v21, v21, v253
v_mfma_f32_16x16x32_bf16 v[132:135], v[108:111], v[44:47], 0
v_mul_f32 v22, v22, v253
v_mul_f32 v23, v23, v253
v_mfma_f32_16x16x32_bf16 v[16:19], v[108:111], v[28:31], 0
v_cvt_pk_bf16_f32 v20, v20, v21
v_cvt_pk_bf16_f32 v21, v22, v23
v_mfma_f32_16x16x32_bf16 v[136:139], v[108:111], v[24:27], 0
v_mul_f32 v84, v84, v253
v_mul_f32 v85, v85, v253
v_mfma_f32_16x16x32_bf16 v[60:63], v[72:75], v[24:27], 0
v_mul_f32 v86, v86, v253
v_mul_f32 v87, v87, v253
v_mfma_f32_16x16x32_bf16 v[140:143], v[72:75], v[28:31], 0
v_cvt_pk_bf16_f32 v22, v84, v85
v_cvt_pk_bf16_f32 v23, v86, v87
v_mfma_f32_16x16x32_bf16 v[144:147], v[72:75], v[44:47], 0
buffer_store_dwordx4 v[20:23], v207, s[72:75], s93 offen offset:0 sc1
v_mfma_f32_16x16x32_bf16 v[148:151], v[112:115], v[44:47], 0
ds_write_b128 v207, v[20:23] offset:36864
v_mfma_f32_16x16x32_bf16 v[108:111], v[112:115], v[28:31], 0
v_mfma_f32_16x16x32_bf16 v[152:155], v[112:115], v[24:27], 0
s_waitcnt lgkmcnt(0)
s_barrier
v_mfma_f32_16x16x32_bf16 v[4:7], v[76:79], v[8:11], v[4:7]
ds_read_b128 v[156:159], v208 offset:12288
ds_read_b128 v[160:163], v208 offset:13312
v_mfma_f32_16x16x32_bf16 v[64:67], v[76:79], v[52:55], v[64:67]
ds_read_b128 v[72:75], v208 offset:14336
ds_read_b64_tr_b16 v[84:85], v220 offset:49152
v_mfma_f32_16x16x32_bf16 v[80:83], v[76:79], v[68:71], v[80:83]
ds_read_b64_tr_b16 v[86:87], v220 offset:51200
ds_read_b64_tr_b16 v[20:21], v219 offset:49152
v_mfma_f32_16x16x32_bf16 v[36:39], v[32:35], v[68:71], v[36:39]
ds_read_b64_tr_b16 v[22:23], v219 offset:51200
ds_read_b64_tr_b16 v[24:25], v218 offset:49152
v_mfma_f32_16x16x32_bf16 v[92:95], v[32:35], v[52:55], v[92:95]
ds_read_b64_tr_b16 v[26:27], v218 offset:51200
ds_read_b64_tr_b16 v[28:29], v217 offset:49152
v_mfma_f32_16x16x32_bf16 v[100:103], v[32:35], v[8:11], v[100:103]
ds_read_b64_tr_b16 v[30:31], v217 offset:51200
ds_read_b64_tr_b16 v[44:45], v222 offset:0
v_mfma_f32_16x16x32_bf16 v[48:51], v[88:91], v[8:11], v[48:51]
ds_read_b64_tr_b16 v[46:47], v222 offset:2048
ds_read_b64_tr_b16 v[76:77], v221 offset:0
v_mfma_f32_16x16x32_bf16 v[124:127], v[88:91], v[52:55], v[124:127]
ds_read_b64_tr_b16 v[78:79], v221 offset:2048
v_mfma_f32_16x16x32_bf16 v[128:131], v[88:91], v[68:71], v[128:131]
v_mul_f32 v40, v40, v252
v_mul_f32 v41, v41, v252
v_mfma_f32_16x16x32_bf16 v[132:135], v[96:99], v[68:71], v[132:135]
v_mul_f32 v42, v42, v252
v_mul_f32 v43, v43, v252
v_mfma_f32_16x16x32_bf16 v[16:19], v[96:99], v[52:55], v[16:19]
v_cvt_pk_bf16_f32 v40, v40, v41
v_cvt_pk_bf16_f32 v41, v42, v43
v_mfma_f32_16x16x32_bf16 v[136:139], v[96:99], v[8:11], v[136:139]
v_mul_f32 v116, v116, v252
v_mul_f32 v117, v117, v252
v_mfma_f32_16x16x32_bf16 v[60:63], v[104:107], v[8:11], v[60:63]
v_mul_f32 v118, v118, v252
v_mul_f32 v119, v119, v252
v_mfma_f32_16x16x32_bf16 v[140:143], v[104:107], v[52:55], v[140:143]
v_cvt_pk_bf16_f32 v42, v116, v117
v_cvt_pk_bf16_f32 v43, v118, v119
v_mfma_f32_16x16x32_bf16 v[144:147], v[104:107], v[68:71], v[144:147]
buffer_store_dwordx4 v[40:43], v207, s[72:75], s93 offen offset:1024 sc1
v_mfma_f32_16x16x32_bf16 v[148:151], v[120:123], v[68:71], v[148:151]
ds_write_b128 v207, v[40:43] offset:37888
v_mfma_f32_16x16x32_bf16 v[108:111], v[120:123], v[52:55], v[108:111]
v_mfma_f32_16x16x32_bf16 v[152:155], v[120:123], v[8:11], v[152:155]
s_waitcnt lgkmcnt(0)
v_mfma_f32_16x16x32_bf16 v[4:7], v[84:87], v[156:159], v[4:7]
ds_read_b128 v[32:35], v208 offset:18432
ds_read_b128 v[88:91], v208 offset:19456
v_mfma_f32_16x16x32_bf16 v[64:67], v[84:87], v[160:163], v[64:67]
ds_read_b128 v[96:99], v208 offset:20480
ds_read_b64_tr_b16 v[104:105], v220 offset:57344
v_mfma_f32_16x16x32_bf16 v[80:83], v[84:87], v[72:75], v[80:83]
ds_read_b64_tr_b16 v[106:107], v220 offset:59392
ds_read_b64_tr_b16 v[40:41], v219 offset:57344
v_mfma_f32_16x16x32_bf16 v[36:39], v[20:23], v[72:75], v[36:39]
ds_read_b64_tr_b16 v[42:43], v219 offset:59392
ds_read_b64_tr_b16 v[8:9], v218 offset:57344
v_mfma_f32_16x16x32_bf16 v[92:95], v[20:23], v[160:163], v[92:95]
ds_read_b64_tr_b16 v[10:11], v218 offset:59392
ds_read_b64_tr_b16 v[52:53], v217 offset:57344
v_mfma_f32_16x16x32_bf16 v[100:103], v[20:23], v[156:159], v[100:103]
ds_read_b64_tr_b16 v[54:55], v217 offset:59392
ds_read_b64_tr_b16 v[68:69], v222 offset:4096
v_mfma_f32_16x16x32_bf16 v[48:51], v[24:27], v[156:159], v[48:51]
ds_read_b64_tr_b16 v[70:71], v222 offset:6144
ds_read_b64_tr_b16 v[84:85], v221 offset:4096
v_mfma_f32_16x16x32_bf16 v[124:127], v[24:27], v[160:163], v[124:127]
ds_read_b64_tr_b16 v[86:87], v221 offset:6144
v_mfma_f32_16x16x32_bf16 v[128:131], v[24:27], v[72:75], v[128:131]
v_mul_f32 v56, v56, v251
v_mul_f32 v57, v57, v251
v_mfma_f32_16x16x32_bf16 v[132:135], v[28:31], v[72:75], v[132:135]
v_mul_f32 v58, v58, v251
v_mul_f32 v59, v59, v251
v_mfma_f32_16x16x32_bf16 v[16:19], v[28:31], v[160:163], v[16:19]
v_cvt_pk_bf16_f32 v56, v56, v57
v_cvt_pk_bf16_f32 v57, v58, v59
v_mfma_f32_16x16x32_bf16 v[136:139], v[28:31], v[156:159], v[136:139]
v_mul_f32 v12, v12, v251
v_mul_f32 v13, v13, v251
v_mfma_f32_16x16x32_bf16 v[60:63], v[44:47], v[156:159], v[60:63]
v_mul_f32 v14, v14, v251
v_mul_f32 v15, v15, v251
v_mfma_f32_16x16x32_bf16 v[140:143], v[44:47], v[160:163], v[140:143]
v_cvt_pk_bf16_f32 v58, v12, v13
v_cvt_pk_bf16_f32 v59, v14, v15
v_mfma_f32_16x16x32_bf16 v[144:147], v[44:47], v[72:75], v[144:147]
buffer_store_dwordx4 v[56:59], v207, s[72:75], s93 offen offset:2048 sc1
v_mfma_f32_16x16x32_bf16 v[148:151], v[76:79], v[72:75], v[148:151]
ds_write_b128 v207, v[56:59] offset:38912
v_mfma_f32_16x16x32_bf16 v[108:111], v[76:79], v[160:163], v[108:111]
v_mfma_f32_16x16x32_bf16 v[152:155], v[76:79], v[156:159], v[152:155]
s_waitcnt lgkmcnt(0)
s_waitcnt vmcnt(6)
s_barrier
v_mfma_f32_16x16x32_bf16 v[4:7], v[104:107], v[32:35], v[4:7]
ds_read_b128 v[20:23], v208 offset:24576
ds_read_b128 v[12:15], v208 offset:25600
v_mfma_f32_16x16x32_bf16 v[64:67], v[104:107], v[88:91], v[64:67]
ds_read_b128 v[24:27], v208 offset:26624
v_mfma_f32_16x16x32_bf16 v[80:83], v[104:107], v[96:99], v[80:83]
ds_read_b64_tr_b16 v[28:29], v220 offset:24576
v_mfma_f32_16x16x32_bf16 v[36:39], v[40:43], v[96:99], v[36:39]
ds_read_b64_tr_b16 v[30:31], v220 offset:26624
v_mfma_f32_16x16x32_bf16 v[92:95], v[40:43], v[88:91], v[92:95]
ds_read_b64_tr_b16 v[44:45], v219 offset:24576
ds_read_b64_tr_b16 v[46:47], v219 offset:26624
v_mfma_f32_16x16x32_bf16 v[100:103], v[40:43], v[32:35], v[100:103]
ds_read_b64_tr_b16 v[56:57], v218 offset:24576
v_mfma_f32_16x16x32_bf16 v[48:51], v[8:11], v[32:35], v[48:51]
ds_read_b64_tr_b16 v[58:59], v218 offset:26624
v_mfma_f32_16x16x32_bf16 v[124:127], v[8:11], v[88:91], v[124:127]
ds_read_b64_tr_b16 v[72:73], v217 offset:24576
v_mfma_f32_16x16x32_bf16 v[128:131], v[8:11], v[96:99], v[128:131]
ds_read_b64_tr_b16 v[74:75], v217 offset:26624
ds_read_b64_tr_b16 v[76:77], v216 offset:40960
v_mfma_f32_16x16x32_bf16 v[132:135], v[52:55], v[96:99], v[132:135]
ds_read_b64_tr_b16 v[78:79], v216 offset:43008
v_mfma_f32_16x16x32_bf16 v[16:19], v[52:55], v[88:91], v[16:19]
ds_read_b64_tr_b16 v[40:41], v215 offset:40960
v_mfma_f32_16x16x32_bf16 v[136:139], v[52:55], v[32:35], v[136:139]
ds_read_b64_tr_b16 v[42:43], v215 offset:43008
v_mfma_f32_16x16x32_bf16 v[60:63], v[68:71], v[32:35], v[60:63]
v_mfma_f32_16x16x32_bf16 v[140:143], v[68:71], v[88:91], v[140:143]
v_mfma_f32_16x16x32_bf16 v[144:147], v[68:71], v[96:99], v[144:147]
v_mfma_f32_16x16x32_bf16 v[148:151], v[84:87], v[96:99], v[148:151]
v_mfma_f32_16x16x32_bf16 v[108:111], v[84:87], v[88:91], v[108:111]
v_mfma_f32_16x16x32_bf16 v[152:155], v[84:87], v[32:35], v[152:155]
s_waitcnt lgkmcnt(0)
v_mfma_f32_16x16x32_bf16 v[4:7], v[28:31], v[20:23], v[4:7]
ds_read_b128 v[8:11], v208 offset:30720
ds_read_b128 v[104:107], v208 offset:31744
v_mfma_f32_16x16x32_bf16 v[64:67], v[28:31], v[12:15], v[64:67]
ds_read_b128 v[52:55], v208 offset:32768
v_mfma_f32_16x16x32_bf16 v[80:83], v[28:31], v[24:27], v[80:83]
ds_read_b64_tr_b16 v[112:113], v220 offset:32768
v_mfma_f32_16x16x32_bf16 v[36:39], v[44:47], v[24:27], v[36:39]
ds_read_b64_tr_b16 v[114:115], v220 offset:34816
v_mfma_f32_16x16x32_bf16 v[92:95], v[44:47], v[12:15], v[92:95]
ds_read_b64_tr_b16 v[32:33], v219 offset:32768
ds_read_b64_tr_b16 v[34:35], v219 offset:34816
v_mfma_f32_16x16x32_bf16 v[100:103], v[44:47], v[20:23], v[100:103]
ds_read_b64_tr_b16 v[68:69], v218 offset:32768
v_mfma_f32_16x16x32_bf16 v[48:51], v[56:59], v[20:23], v[48:51]
ds_read_b64_tr_b16 v[70:71], v218 offset:34816
v_mfma_f32_16x16x32_bf16 v[124:127], v[56:59], v[12:15], v[124:127]
ds_read_b64_tr_b16 v[28:29], v217 offset:32768
v_mfma_f32_16x16x32_bf16 v[128:131], v[56:59], v[24:27], v[128:131]
ds_read_b64_tr_b16 v[30:31], v217 offset:34816
ds_read_b64_tr_b16 v[84:85], v216 offset:45056
v_mfma_f32_16x16x32_bf16 v[132:135], v[72:75], v[24:27], v[132:135]
ds_read_b64_tr_b16 v[86:87], v216 offset:47104
v_mfma_f32_16x16x32_bf16 v[16:19], v[72:75], v[12:15], v[16:19]
ds_read_b64_tr_b16 v[44:45], v215 offset:45056
v_mfma_f32_16x16x32_bf16 v[136:139], v[72:75], v[20:23], v[136:139]
ds_read_b64_tr_b16 v[46:47], v215 offset:47104
v_mfma_f32_16x16x32_bf16 v[60:63], v[76:79], v[20:23], v[60:63]
v_mfma_f32_16x16x32_bf16 v[140:143], v[76:79], v[12:15], v[140:143]
v_mfma_f32_16x16x32_bf16 v[144:147], v[76:79], v[24:27], v[144:147]
v_mfma_f32_16x16x32_bf16 v[148:151], v[40:43], v[24:27], v[148:151]
v_mfma_f32_16x16x32_bf16 v[108:111], v[40:43], v[12:15], v[108:111]
v_mfma_f32_16x16x32_bf16 v[152:155], v[40:43], v[20:23], v[152:155]
s_waitcnt lgkmcnt(0)
s_waitcnt vmcnt(3)
s_barrier
v_mfma_f32_16x16x32_bf16 v[4:7], v[112:115], v[8:11], v[4:7]
ds_read_b128 v[56:59], v208 offset:36864
ds_read_b128 v[72:75], v208 offset:37888
v_mfma_f32_16x16x32_bf16 v[64:67], v[112:115], v[104:107], v[64:67]
ds_read_b128 v[88:91], v208 offset:38912
v_mfma_f32_16x16x32_bf16 v[80:83], v[112:115], v[52:55], v[80:83]
ds_read_b64_tr_b16 v[24:25], v226 offset:8192
v_mfma_f32_16x16x32_bf16 v[36:39], v[32:35], v[52:55], v[36:39]
ds_read_b64_tr_b16 v[26:27], v226 offset:10240
v_mfma_f32_16x16x32_bf16 v[92:95], v[32:35], v[104:107], v[92:95]
ds_read_b64_tr_b16 v[12:13], v225 offset:8192
ds_read_b64_tr_b16 v[14:15], v225 offset:10240
v_mfma_f32_16x16x32_bf16 v[100:103], v[32:35], v[8:11], v[100:103]
ds_read_b64_tr_b16 v[20:21], v224 offset:8192
v_mfma_f32_16x16x32_bf16 v[48:51], v[68:71], v[8:11], v[48:51]
ds_read_b64_tr_b16 v[22:23], v224 offset:10240
v_mfma_f32_16x16x32_bf16 v[124:127], v[68:71], v[104:107], v[124:127]
ds_read_b64_tr_b16 v[40:41], v223 offset:8192
v_mfma_f32_16x16x32_bf16 v[128:131], v[68:71], v[52:55], v[128:131]
ds_read_b64_tr_b16 v[42:43], v223 offset:10240
ds_read_b64_tr_b16 v[76:77], v210 offset:0
v_mfma_f32_16x16x32_bf16 v[132:135], v[28:31], v[52:55], v[132:135]
ds_read_b64_tr_b16 v[78:79], v210 offset:2048
v_mfma_f32_16x16x32_bf16 v[16:19], v[28:31], v[104:107], v[16:19]
ds_read_b64_tr_b16 v[32:33], v209 offset:0
v_mfma_f32_16x16x32_bf16 v[136:139], v[28:31], v[8:11], v[136:139]
ds_read_b64_tr_b16 v[34:35], v209 offset:2048
v_mfma_f32_16x16x32_bf16 v[60:63], v[84:87], v[8:11], v[60:63]
v_mfma_f32_16x16x32_bf16 v[140:143], v[84:87], v[104:107], v[140:143]
v_mfma_f32_16x16x32_bf16 v[144:147], v[84:87], v[52:55], v[144:147]
v_mfma_f32_16x16x32_bf16 v[148:151], v[44:47], v[52:55], v[148:151]
v_mfma_f32_16x16x32_bf16 v[108:111], v[44:47], v[104:107], v[108:111]
v_mfma_f32_16x16x32_bf16 v[152:155], v[44:47], v[8:11], v[152:155]
s_waitcnt lgkmcnt(0)
v_mfma_f32_16x16x32_bf16 v[4:7], v[24:27], v[56:59], v[4:7]
ds_read_b128 v[68:71], v208 offset:43008
ds_read_b128 v[96:99], v208 offset:44032
v_mfma_f32_16x16x32_bf16 v[64:67], v[24:27], v[72:75], v[64:67]
ds_read_b128 v[28:31], v208 offset:45056
v_mfma_f32_16x16x32_bf16 v[80:83], v[24:27], v[88:91], v[80:83]
ds_read_b64_tr_b16 v[112:113], v226 offset:16384
v_mfma_f32_16x16x32_bf16 v[36:39], v[12:15], v[88:91], v[36:39]
ds_read_b64_tr_b16 v[114:115], v226 offset:18432
v_mfma_f32_16x16x32_bf16 v[92:95], v[12:15], v[72:75], v[92:95]
ds_read_b64_tr_b16 v[8:9], v225 offset:16384
ds_read_b64_tr_b16 v[10:11], v225 offset:18432
v_mfma_f32_16x16x32_bf16 v[100:103], v[12:15], v[56:59], v[100:103]
ds_read_b64_tr_b16 v[44:45], v224 offset:16384
v_mfma_f32_16x16x32_bf16 v[48:51], v[20:23], v[56:59], v[48:51]
ds_read_b64_tr_b16 v[46:47], v224 offset:18432
v_mfma_f32_16x16x32_bf16 v[124:127], v[20:23], v[72:75], v[124:127]
ds_read_b64_tr_b16 v[24:25], v223 offset:16384
v_mfma_f32_16x16x32_bf16 v[128:131], v[20:23], v[88:91], v[128:131]
ds_read_b64_tr_b16 v[26:27], v223 offset:18432
ds_read_b64_tr_b16 v[52:53], v210 offset:4096
v_mfma_f32_16x16x32_bf16 v[132:135], v[40:43], v[88:91], v[132:135]
ds_read_b64_tr_b16 v[54:55], v210 offset:6144
v_mfma_f32_16x16x32_bf16 v[16:19], v[40:43], v[72:75], v[16:19]
ds_read_b64_tr_b16 v[12:13], v209 offset:4096
v_mfma_f32_16x16x32_bf16 v[136:139], v[40:43], v[56:59], v[136:139]
ds_read_b64_tr_b16 v[14:15], v209 offset:6144
v_mfma_f32_16x16x32_bf16 v[60:63], v[76:79], v[56:59], v[60:63]
v_mfma_f32_16x16x32_bf16 v[140:143], v[76:79], v[72:75], v[140:143]
v_mfma_f32_16x16x32_bf16 v[144:147], v[76:79], v[88:91], v[144:147]
v_mfma_f32_16x16x32_bf16 v[148:151], v[32:35], v[88:91], v[148:151]
v_mfma_f32_16x16x32_bf16 v[108:111], v[32:35], v[72:75], v[108:111]
v_mfma_f32_16x16x32_bf16 v[152:155], v[32:35], v[56:59], v[152:155]
s_waitcnt lgkmcnt(0)
s_waitcnt vmcnt(0)
s_barrier
v_mfma_f32_16x16x32_bf16 v[4:7], v[112:115], v[68:71], v[4:7]
ds_read_b128 v[20:23], v208 offset:0
ds_read_b128 v[40:43], v208 offset:1024
v_mfma_f32_16x16x32_bf16 v[64:67], v[112:115], v[96:99], v[64:67]
ds_read_b128 v[84:87], v208 offset:2048
v_mfma_f32_16x16x32_bf16 v[80:83], v[112:115], v[28:31], v[80:83]
ds_read_b64_tr_b16 v[76:77], v214 offset:8192
v_mfma_f32_16x16x32_bf16 v[36:39], v[8:11], v[28:31], v[36:39]
ds_read_b64_tr_b16 v[78:79], v214 offset:10240
v_mfma_f32_16x16x32_bf16 v[92:95], v[8:11], v[96:99], v[92:95]
ds_read_b64_tr_b16 v[32:33], v213 offset:8192
ds_read_b64_tr_b16 v[34:35], v213 offset:10240
v_mfma_f32_16x16x32_bf16 v[100:103], v[8:11], v[68:71], v[100:103]
ds_read_b64_tr_b16 v[56:57], v212 offset:8192
v_mfma_f32_16x16x32_bf16 v[48:51], v[44:47], v[68:71], v[48:51]
ds_read_b64_tr_b16 v[58:59], v212 offset:10240
v_mfma_f32_16x16x32_bf16 v[124:127], v[44:47], v[96:99], v[124:127]
ds_read_b64_tr_b16 v[72:73], v211 offset:8192
v_mfma_f32_16x16x32_bf16 v[128:131], v[44:47], v[28:31], v[128:131]
ds_read_b64_tr_b16 v[74:75], v211 offset:10240
ds_read_b64_tr_b16 v[88:89], v216 offset:0
v_mfma_f32_16x16x32_bf16 v[132:135], v[24:27], v[28:31], v[132:135]
ds_read_b64_tr_b16 v[90:91], v216 offset:2048
v_mfma_f32_16x16x32_bf16 v[16:19], v[24:27], v[96:99], v[16:19]
ds_read_b64_tr_b16 v[8:9], v215 offset:0
v_mfma_f32_16x16x32_bf16 v[136:139], v[24:27], v[68:71], v[136:139]
ds_read_b64_tr_b16 v[10:11], v215 offset:2048
v_mfma_f32_16x16x32_bf16 v[60:63], v[52:55], v[68:71], v[60:63]
v_mfma_f32_16x16x32_bf16 v[140:143], v[52:55], v[96:99], v[140:143]
v_mfma_f32_16x16x32_bf16 v[144:147], v[52:55], v[28:31], v[144:147]
v_mfma_f32_16x16x32_bf16 v[148:151], v[12:15], v[28:31], v[148:151]
v_mfma_f32_16x16x32_bf16 v[108:111], v[12:15], v[96:99], v[108:111]
v_mfma_f32_16x16x32_bf16 v[152:155], v[12:15], v[68:71], v[152:155]
s_waitcnt lgkmcnt(0)
v_mfma_f32_16x16x32_bf16 v[4:7], v[76:79], v[20:23], v[4:7]
ds_read_b128 v[44:47], v208 offset:6144
ds_read_b128 v[104:107], v208 offset:7168
v_mfma_f32_16x16x32_bf16 v[64:67], v[76:79], v[40:43], v[64:67]
ds_read_b128 v[24:27], v208 offset:8192
v_mfma_f32_16x16x32_bf16 v[80:83], v[76:79], v[84:87], v[80:83]
ds_read_b64_tr_b16 v[112:113], v214 offset:16384
v_mfma_f32_16x16x32_bf16 v[36:39], v[32:35], v[84:87], v[36:39]
ds_read_b64_tr_b16 v[114:115], v214 offset:18432
v_mfma_f32_16x16x32_bf16 v[92:95], v[32:35], v[40:43], v[92:95]
ds_read_b64_tr_b16 v[12:13], v213 offset:16384
ds_read_b64_tr_b16 v[14:15], v213 offset:18432
v_mfma_f32_16x16x32_bf16 v[100:103], v[32:35], v[20:23], v[100:103]
ds_read_b64_tr_b16 v[28:29], v212 offset:16384
v_mfma_f32_16x16x32_bf16 v[48:51], v[56:59], v[20:23], v[48:51]
ds_read_b64_tr_b16 v[30:31], v212 offset:18432
v_mfma_f32_16x16x32_bf16 v[124:127], v[56:59], v[40:43], v[124:127]
ds_read_b64_tr_b16 v[52:53], v211 offset:16384
v_mfma_f32_16x16x32_bf16 v[128:131], v[56:59], v[84:87], v[128:131]
ds_read_b64_tr_b16 v[54:55], v211 offset:18432
ds_read_b64_tr_b16 v[68:69], v216 offset:4096
v_mfma_f32_16x16x32_bf16 v[132:135], v[72:75], v[84:87], v[132:135]
ds_read_b64_tr_b16 v[70:71], v216 offset:6144
v_mfma_f32_16x16x32_bf16 v[16:19], v[72:75], v[40:43], v[16:19]
ds_read_b64_tr_b16 v[32:33], v215 offset:4096
v_mfma_f32_16x16x32_bf16 v[136:139], v[72:75], v[20:23], v[136:139]
ds_read_b64_tr_b16 v[34:35], v215 offset:6144
v_mfma_f32_16x16x32_bf16 v[60:63], v[88:91], v[20:23], v[60:63]
v_mfma_f32_16x16x32_bf16 v[140:143], v[88:91], v[40:43], v[140:143]
v_mfma_f32_16x16x32_bf16 v[144:147], v[88:91], v[84:87], v[144:147]
v_mfma_f32_16x16x32_bf16 v[148:151], v[8:11], v[84:87], v[148:151]
v_mfma_f32_16x16x32_bf16 v[108:111], v[8:11], v[40:43], v[108:111]
v_mfma_f32_16x16x32_bf16 v[152:155], v[8:11], v[20:23], v[152:155]
s_waitcnt lgkmcnt(0)
s_barrier
v_mfma_f32_16x16x32_bf16 v[4:7], v[112:115], v[44:47], v[4:7]
ds_read_b128 v[56:59], v208 offset:12288
v_mfma_f32_16x16x32_bf16 v[64:67], v[112:115], v[104:107], v[64:67]
ds_read_b128 v[72:75], v208 offset:13312
v_mfma_f32_16x16x32_bf16 v[80:83], v[112:115], v[24:27], v[80:83]
ds_read_b128 v[76:79], v208 offset:14336
v_mfma_f32_16x16x32_bf16 v[36:39], v[12:15], v[24:27], v[36:39]
ds_read_b64_tr_b16 v[84:85], v220 offset:8192
v_mfma_f32_16x16x32_bf16 v[92:95], v[12:15], v[104:107], v[92:95]
ds_read_b64_tr_b16 v[86:87], v220 offset:10240
v_mfma_f32_16x16x32_bf16 v[100:103], v[12:15], v[44:47], v[100:103]
ds_read_b64_tr_b16 v[8:9], v219 offset:8192
v_mfma_f32_16x16x32_bf16 v[48:51], v[28:31], v[44:47], v[48:51]
ds_read_b64_tr_b16 v[10:11], v219 offset:10240
v_mfma_f32_16x16x32_bf16 v[124:127], v[28:31], v[104:107], v[124:127]
ds_read_b64_tr_b16 v[20:21], v218 offset:8192
v_mfma_f32_16x16x32_bf16 v[128:131], v[28:31], v[24:27], v[128:131]
ds_read_b64_tr_b16 v[22:23], v218 offset:10240
v_mfma_f32_16x16x32_bf16 v[132:135], v[52:55], v[24:27], v[132:135]
ds_read_b64_tr_b16 v[40:41], v217 offset:8192
v_mfma_f32_16x16x32_bf16 v[16:19], v[52:55], v[104:107], v[16:19]
ds_read_b64_tr_b16 v[42:43], v217 offset:10240
v_mfma_f32_16x16x32_bf16 v[136:139], v[52:55], v[44:47], v[136:139]
v_mfma_f32_16x16x32_bf16 v[60:63], v[68:71], v[44:47], v[60:63]
v_mfma_f32_16x16x32_bf16 v[140:143], v[68:71], v[104:107], v[140:143]
v_mfma_f32_16x16x32_bf16 v[144:147], v[68:71], v[24:27], v[144:147]
v_mfma_f32_16x16x32_bf16 v[148:151], v[32:35], v[24:27], v[148:151]
v_mfma_f32_16x16x32_bf16 v[108:111], v[32:35], v[104:107], v[108:111]
v_mfma_f32_16x16x32_bf16 v[152:155], v[32:35], v[44:47], v[152:155]
s_waitcnt lgkmcnt(0)
v_mfma_f32_16x16x32_bf16 v[4:7], v[84:87], v[56:59], v[4:7]
ds_read_b128 v[12:15], v208 offset:18432
ds_read_b128 v[28:31], v208 offset:19456
v_mfma_f32_16x16x32_bf16 v[64:67], v[84:87], v[72:75], v[64:67]
ds_read_b128 v[52:55], v208 offset:20480
v_mfma_f32_16x16x32_bf16 v[80:83], v[84:87], v[76:79], v[80:83]
ds_read_b64_tr_b16 v[88:89], v220 offset:16384
ds_read_b64_tr_b16 v[90:91], v220 offset:18432
v_mfma_f32_16x16x32_bf16 v[36:39], v[8:11], v[76:79], v[36:39]
ds_read_b64_tr_b16 v[24:25], v219 offset:16384
v_mfma_f32_16x16x32_bf16 v[92:95], v[8:11], v[72:75], v[92:95]
ds_read_b64_tr_b16 v[26:27], v219 offset:18432
v_mfma_f32_16x16x32_bf16 v[100:103], v[8:11], v[56:59], v[100:103]
ds_read_b64_tr_b16 v[32:33], v218 offset:16384
ds_read_b64_tr_b16 v[34:35], v218 offset:18432
v_mfma_f32_16x16x32_bf16 v[48:51], v[20:23], v[56:59], v[48:51]
ds_read_b64_tr_b16 v[44:45], v217 offset:16384
v_mfma_f32_16x16x32_bf16 v[124:127], v[20:23], v[72:75], v[124:127]
ds_read_b64_tr_b16 v[46:47], v217 offset:18432
v_mfma_f32_16x16x32_bf16 v[128:131], v[20:23], v[76:79], v[128:131]
v_mfma_f32_16x16x32_bf16 v[132:135], v[40:43], v[76:79], v[132:135]
v_mfma_f32_16x16x32_bf16 v[16:19], v[40:43], v[72:75], v[16:19]
v_mfma_f32_16x16x32_bf16 v[136:139], v[40:43], v[56:59], v[136:139]
s_waitcnt lgkmcnt(0)
s_barrier
v_mfma_f32_16x16x32_bf16 v[4:7], v[88:91], v[12:15], v[4:7]
ds_read_b128 v[8:11], v208 offset:24576
ds_read_b128 v[68:71], v208 offset:25600
v_mfma_f32_16x16x32_bf16 v[64:67], v[88:91], v[28:31], v[64:67]
ds_read_b128 v[84:87], v208 offset:26624
v_mfma_f32_16x16x32_bf16 v[80:83], v[88:91], v[52:55], v[80:83]
ds_read_b64_tr_b16 v[20:21], v220 offset:49152
ds_read_b64_tr_b16 v[22:23], v220 offset:51200
v_mfma_f32_16x16x32_bf16 v[36:39], v[24:27], v[52:55], v[36:39]
ds_read_b64_tr_b16 v[40:41], v219 offset:49152
v_mfma_f32_16x16x32_bf16 v[92:95], v[24:27], v[28:31], v[92:95]
ds_read_b64_tr_b16 v[42:43], v219 offset:51200
v_mfma_f32_16x16x32_bf16 v[100:103], v[24:27], v[12:15], v[100:103]
ds_read_b64_tr_b16 v[56:57], v218 offset:49152
ds_read_b64_tr_b16 v[58:59], v218 offset:51200
v_mfma_f32_16x16x32_bf16 v[48:51], v[32:35], v[12:15], v[48:51]
ds_read_b64_tr_b16 v[72:73], v217 offset:49152
v_mfma_f32_16x16x32_bf16 v[124:127], v[32:35], v[28:31], v[124:127]
ds_read_b64_tr_b16 v[74:75], v217 offset:51200
v_mfma_f32_16x16x32_bf16 v[128:131], v[32:35], v[52:55], v[128:131]
v_mfma_f32_16x16x32_bf16 v[132:135], v[44:47], v[52:55], v[132:135]
v_mfma_f32_16x16x32_bf16 v[16:19], v[44:47], v[28:31], v[16:19]
v_mfma_f32_16x16x32_bf16 v[136:139], v[44:47], v[12:15], v[136:139]
s_waitcnt lgkmcnt(0)
v_mfma_f32_16x16x32_bf16 v[4:7], v[20:23], v[8:11], v[4:7]
ds_read_b128 v[24:27], v208 offset:30720
ds_read_b128 v[76:79], v208 offset:31744
v_mfma_f32_16x16x32_bf16 v[64:67], v[20:23], v[68:71], v[64:67]
ds_read_b128 v[88:91], v208 offset:32768
v_mfma_f32_16x16x32_bf16 v[80:83], v[20:23], v[84:87], v[80:83]
ds_read_b64_tr_b16 v[96:97], v220 offset:57344
ds_read_b64_tr_b16 v[98:99], v220 offset:59392
v_mfma_f32_16x16x32_bf16 v[36:39], v[40:43], v[84:87], v[36:39]
ds_read_b64_tr_b16 v[28:29], v219 offset:57344
v_mfma_f32_16x16x32_bf16 v[92:95], v[40:43], v[68:71], v[92:95]
ds_read_b64_tr_b16 v[30:31], v219 offset:59392
v_mfma_f32_16x16x32_bf16 v[100:103], v[40:43], v[8:11], v[100:103]
ds_read_b64_tr_b16 v[12:13], v218 offset:57344
ds_read_b64_tr_b16 v[14:15], v218 offset:59392
v_mfma_f32_16x16x32_bf16 v[48:51], v[56:59], v[8:11], v[48:51]
ds_read_b64_tr_b16 v[32:33], v217 offset:57344
v_mfma_f32_16x16x32_bf16 v[124:127], v[56:59], v[68:71], v[124:127]
ds_read_b64_tr_b16 v[34:35], v217 offset:59392
v_mfma_f32_16x16x32_bf16 v[128:131], v[56:59], v[84:87], v[128:131]
v_mfma_f32_16x16x32_bf16 v[132:135], v[72:75], v[84:87], v[132:135]
v_mfma_f32_16x16x32_bf16 v[16:19], v[72:75], v[68:71], v[16:19]
v_mfma_f32_16x16x32_bf16 v[136:139], v[72:75], v[8:11], v[136:139]
s_waitcnt lgkmcnt(0)
s_barrier
v_mfma_f32_16x16x32_bf16 v[4:7], v[96:99], v[24:27], v[4:7]
ds_read_b128 v[20:23], v208 offset:36864
ds_read_b128 v[40:43], v208 offset:37888
v_mfma_f32_16x16x32_bf16 v[64:67], v[96:99], v[76:79], v[64:67]
ds_read_b128 v[44:47], v208 offset:38912
ds_read_b64_tr_b16 v[52:53], v226 offset:0
v_mfma_f32_16x16x32_bf16 v[80:83], v[96:99], v[88:91], v[80:83]
ds_read_b64_tr_b16 v[54:55], v226 offset:2048
ds_read_b64_tr_b16 v[56:57], v225 offset:0
v_mfma_f32_16x16x32_bf16 v[36:39], v[28:31], v[88:91], v[36:39]
ds_read_b64_tr_b16 v[58:59], v225 offset:2048
ds_read_b64_tr_b16 v[8:9], v224 offset:0
v_mfma_f32_16x16x32_bf16 v[92:95], v[28:31], v[76:79], v[92:95]
ds_read_b64_tr_b16 v[10:11], v224 offset:2048
ds_read_b64_tr_b16 v[68:69], v223 offset:0
v_mfma_f32_16x16x32_bf16 v[100:103], v[28:31], v[24:27], v[100:103]
ds_read_b64_tr_b16 v[70:71], v223 offset:2048
ds_read_b64_tr_b16 v[72:73], v216 offset:32768
v_mfma_f32_16x16x32_bf16 v[48:51], v[12:15], v[24:27], v[48:51]
ds_read_b64_tr_b16 v[74:75], v216 offset:34816
ds_read_b64_tr_b16 v[84:85], v215 offset:32768
v_mfma_f32_16x16x32_bf16 v[124:127], v[12:15], v[76:79], v[124:127]
ds_read_b64_tr_b16 v[86:87], v215 offset:34816
v_mfma_f32_16x16x32_bf16 v[128:131], v[12:15], v[88:91], v[128:131]
v_mfma_f32_16x16x32_bf16 v[132:135], v[32:35], v[88:91], v[132:135]
v_mfma_f32_16x16x32_bf16 v[16:19], v[32:35], v[76:79], v[16:19]
v_mfma_f32_16x16x32_bf16 v[136:139], v[32:35], v[24:27], v[136:139]
s_waitcnt lgkmcnt(0)
v_mfma_f32_16x16x32_bf16 v[4:7], v[52:55], v[20:23], v[4:7]
ds_read_b128 v[28:31], v208 offset:43008
ds_read_b128 v[96:99], v208 offset:44032
v_mfma_f32_16x16x32_bf16 v[64:67], v[52:55], v[40:43], v[64:67]
ds_read_b128 v[104:107], v208 offset:45056
v_mfma_f32_16x16x32_bf16 v[80:83], v[52:55], v[44:47], v[80:83]
ds_read_b64_tr_b16 v[112:113], v220 offset:24576
v_mfma_f32_16x16x32_bf16 v[36:39], v[56:59], v[44:47], v[36:39]
ds_read_b64_tr_b16 v[114:115], v220 offset:26624
v_mfma_f32_16x16x32_bf16 v[92:95], v[56:59], v[40:43], v[92:95]
ds_read_b64_tr_b16 v[12:13], v219 offset:24576
ds_read_b64_tr_b16 v[14:15], v219 offset:26624
v_mfma_f32_16x16x32_bf16 v[100:103], v[56:59], v[20:23], v[100:103]
ds_read_b64_tr_b16 v[24:25], v218 offset:24576
v_mfma_f32_16x16x32_bf16 v[48:51], v[8:11], v[20:23], v[48:51]
ds_read_b64_tr_b16 v[26:27], v218 offset:26624
v_mfma_f32_16x16x32_bf16 v[124:127], v[8:11], v[40:43], v[124:127]
ds_read_b64_tr_b16 v[32:33], v217 offset:24576
v_mfma_f32_16x16x32_bf16 v[128:131], v[8:11], v[44:47], v[128:131]
ds_read_b64_tr_b16 v[34:35], v217 offset:26624
ds_read_b64_tr_b16 v[52:53], v216 offset:36864
v_mfma_f32_16x16x32_bf16 v[132:135], v[68:71], v[44:47], v[132:135]
ds_read_b64_tr_b16 v[54:55], v216 offset:38912
v_mfma_f32_16x16x32_bf16 v[16:19], v[68:71], v[40:43], v[16:19]
ds_read_b64_tr_b16 v[56:57], v215 offset:36864
v_mfma_f32_16x16x32_bf16 v[136:139], v[68:71], v[20:23], v[136:139]
ds_read_b64_tr_b16 v[58:59], v215 offset:38912
v_mfma_f32_16x16x32_bf16 v[60:63], v[72:75], v[20:23], v[60:63]
v_mfma_f32_16x16x32_bf16 v[140:143], v[72:75], v[40:43], v[140:143]
v_mfma_f32_16x16x32_bf16 v[144:147], v[72:75], v[44:47], v[144:147]
v_mfma_f32_16x16x32_bf16 v[148:151], v[84:87], v[44:47], v[148:151]
v_mfma_f32_16x16x32_bf16 v[108:111], v[84:87], v[40:43], v[108:111]
v_mfma_f32_16x16x32_bf16 v[152:155], v[84:87], v[20:23], v[152:155]
s_waitcnt lgkmcnt(0)
s_barrier
v_mfma_f32_16x16x32_bf16 v[4:7], v[112:115], v[28:31], v[4:7]
ds_read_b128 v[8:11], v208 offset:0
v_mfma_f32_16x16x32_bf16 v[64:67], v[112:115], v[96:99], v[64:67]
ds_read_b128 v[68:71], v208 offset:1024
v_mfma_f32_16x16x32_bf16 v[80:83], v[112:115], v[104:107], v[80:83]
ds_read_b128 v[76:79], v208 offset:2048
v_mfma_f32_16x16x32_bf16 v[36:39], v[12:15], v[104:107], v[36:39]
ds_read_b64_tr_b16 v[44:45], v220 offset:40960
v_mfma_f32_16x16x32_bf16 v[92:95], v[12:15], v[96:99], v[92:95]
ds_read_b64_tr_b16 v[46:47], v220 offset:43008
v_mfma_f32_16x16x32_bf16 v[100:103], v[12:15], v[28:31], v[100:103]
ds_read_b64_tr_b16 v[20:21], v219 offset:40960
v_mfma_f32_16x16x32_bf16 v[48:51], v[24:27], v[28:31], v[48:51]
ds_read_b64_tr_b16 v[22:23], v219 offset:43008
v_mfma_f32_16x16x32_bf16 v[124:127], v[24:27], v[96:99], v[124:127]
ds_read_b64_tr_b16 v[40:41], v218 offset:40960
v_mfma_f32_16x16x32_bf16 v[128:131], v[24:27], v[104:107], v[128:131]
ds_read_b64_tr_b16 v[42:43], v218 offset:43008
v_mfma_f32_16x16x32_bf16 v[132:135], v[32:35], v[104:107], v[132:135]
ds_read_b64_tr_b16 v[72:73], v217 offset:40960
v_mfma_f32_16x16x32_bf16 v[16:19], v[32:35], v[96:99], v[16:19]
ds_read_b64_tr_b16 v[74:75], v217 offset:43008
v_mfma_f32_16x16x32_bf16 v[136:139], v[32:35], v[28:31], v[136:139]
v_mfma_f32_16x16x32_bf16 v[60:63], v[52:55], v[28:31], v[60:63]
v_mfma_f32_16x16x32_bf16 v[140:143], v[52:55], v[96:99], v[140:143]
v_mfma_f32_16x16x32_bf16 v[144:147], v[52:55], v[104:107], v[144:147]
v_mfma_f32_16x16x32_bf16 v[148:151], v[56:59], v[104:107], v[148:151]
v_mfma_f32_16x16x32_bf16 v[108:111], v[56:59], v[96:99], v[108:111]
v_mfma_f32_16x16x32_bf16 v[152:155], v[56:59], v[28:31], v[152:155]
s_waitcnt lgkmcnt(0)
v_mfma_f32_16x16x32_bf16 v[4:7], v[44:47], v[8:11], v[4:7]
ds_read_b128 v[12:15], v208 offset:6144
ds_read_b128 v[24:27], v208 offset:7168
v_mfma_f32_16x16x32_bf16 v[64:67], v[44:47], v[68:71], v[64:67]
ds_read_b128 v[32:35], v208 offset:8192
v_mfma_f32_16x16x32_bf16 v[80:83], v[44:47], v[76:79], v[80:83]
ds_read_b64_tr_b16 v[84:85], v226 offset:8192
ds_read_b64_tr_b16 v[86:87], v226 offset:10240
v_mfma_f32_16x16x32_bf16 v[36:39], v[20:23], v[76:79], v[36:39]
ds_read_b64_tr_b16 v[52:53], v225 offset:8192
v_mfma_f32_16x16x32_bf16 v[92:95], v[20:23], v[68:71], v[92:95]
ds_read_b64_tr_b16 v[54:55], v225 offset:10240
v_mfma_f32_16x16x32_bf16 v[100:103], v[20:23], v[8:11], v[100:103]
ds_read_b64_tr_b16 v[28:29], v224 offset:8192
ds_read_b64_tr_b16 v[30:31], v224 offset:10240
v_mfma_f32_16x16x32_bf16 v[48:51], v[40:43], v[8:11], v[48:51]
ds_read_b64_tr_b16 v[56:57], v223 offset:8192
v_mfma_f32_16x16x32_bf16 v[124:127], v[40:43], v[68:71], v[124:127]
ds_read_b64_tr_b16 v[58:59], v223 offset:10240
v_mfma_f32_16x16x32_bf16 v[128:131], v[40:43], v[76:79], v[128:131]
v_mfma_f32_16x16x32_bf16 v[132:135], v[72:75], v[76:79], v[132:135]
v_mfma_f32_16x16x32_bf16 v[16:19], v[72:75], v[68:71], v[16:19]
v_mfma_f32_16x16x32_bf16 v[136:139], v[72:75], v[8:11], v[136:139]
s_waitcnt lgkmcnt(0)
s_barrier
v_mfma_f32_16x16x32_bf16 v[4:7], v[84:87], v[12:15], v[4:7]
ds_read_b128 v[20:23], v208 offset:12288
ds_read_b128 v[44:47], v208 offset:13312
v_mfma_f32_16x16x32_bf16 v[64:67], v[84:87], v[24:27], v[64:67]
ds_read_b128 v[88:91], v208 offset:14336
ds_read_b64_tr_b16 v[96:97], v226 offset:16384
v_mfma_f32_16x16x32_bf16 v[80:83], v[84:87], v[32:35], v[80:83]
ds_read_b64_tr_b16 v[98:99], v226 offset:18432
ds_read_b64_tr_b16 v[40:41], v225 offset:16384
v_mfma_f32_16x16x32_bf16 v[36:39], v[52:55], v[32:35], v[36:39]
ds_read_b64_tr_b16 v[42:43], v225 offset:18432
ds_read_b64_tr_b16 v[8:9], v224 offset:16384
v_mfma_f32_16x16x32_bf16 v[92:95], v[52:55], v[24:27], v[92:95]
ds_read_b64_tr_b16 v[10:11], v224 offset:18432
ds_read_b64_tr_b16 v[68:69], v223 offset:16384
v_mfma_f32_16x16x32_bf16 v[100:103], v[52:55], v[12:15], v[100:103]
ds_read_b64_tr_b16 v[70:71], v223 offset:18432
ds_read_b64_tr_b16 v[72:73], v210 offset:8192
v_mfma_f32_16x16x32_bf16 v[48:51], v[28:31], v[12:15], v[48:51]
ds_read_b64_tr_b16 v[74:75], v210 offset:10240
ds_read_b64_tr_b16 v[76:77], v209 offset:8192
v_mfma_f32_16x16x32_bf16 v[124:127], v[28:31], v[24:27], v[124:127]
ds_read_b64_tr_b16 v[78:79], v209 offset:10240
v_mfma_f32_16x16x32_bf16 v[128:131], v[28:31], v[32:35], v[128:131]
v_mfma_f32_16x16x32_bf16 v[132:135], v[56:59], v[32:35], v[132:135]
v_mfma_f32_16x16x32_bf16 v[16:19], v[56:59], v[24:27], v[16:19]
v_mfma_f32_16x16x32_bf16 v[136:139], v[56:59], v[12:15], v[136:139]
s_waitcnt lgkmcnt(0)
v_mfma_f32_16x16x32_bf16 v[4:7], v[96:99], v[20:23], v[4:7]
ds_read_b128 v[52:55], v208 offset:18432
ds_read_b128 v[84:87], v208 offset:19456
v_mfma_f32_16x16x32_bf16 v[64:67], v[96:99], v[44:47], v[64:67]
ds_read_b128 v[104:107], v208 offset:20480
v_mfma_f32_16x16x32_bf16 v[80:83], v[96:99], v[88:91], v[80:83]
ds_read_b64_tr_b16 v[112:113], v214 offset:0
v_mfma_f32_16x16x32_bf16 v[36:39], v[40:43], v[88:91], v[36:39]
ds_read_b64_tr_b16 v[114:115], v214 offset:2048
v_mfma_f32_16x16x32_bf16 v[92:95], v[40:43], v[44:47], v[92:95]
ds_read_b64_tr_b16 v[12:13], v213 offset:0
ds_read_b64_tr_b16 v[14:15], v213 offset:2048
v_mfma_f32_16x16x32_bf16 v[100:103], v[40:43], v[20:23], v[100:103]
ds_read_b64_tr_b16 v[24:25], v212 offset:0
v_mfma_f32_16x16x32_bf16 v[48:51], v[8:11], v[20:23], v[48:51]
ds_read_b64_tr_b16 v[26:27], v212 offset:2048
v_mfma_f32_16x16x32_bf16 v[124:127], v[8:11], v[44:47], v[124:127]
ds_read_b64_tr_b16 v[28:29], v211 offset:0
v_mfma_f32_16x16x32_bf16 v[128:131], v[8:11], v[88:91], v[128:131]
ds_read_b64_tr_b16 v[30:31], v211 offset:2048
ds_read_b64_tr_b16 v[32:33], v210 offset:12288
v_mfma_f32_16x16x32_bf16 v[132:135], v[68:71], v[88:91], v[132:135]
ds_read_b64_tr_b16 v[34:35], v210 offset:14336
v_mfma_f32_16x16x32_bf16 v[16:19], v[68:71], v[44:47], v[16:19]
ds_read_b64_tr_b16 v[40:41], v209 offset:12288
v_mfma_f32_16x16x32_bf16 v[136:139], v[68:71], v[20:23], v[136:139]
ds_read_b64_tr_b16 v[42:43], v209 offset:14336
v_mfma_f32_16x16x32_bf16 v[60:63], v[72:75], v[20:23], v[60:63]
v_mfma_f32_16x16x32_bf16 v[140:143], v[72:75], v[44:47], v[140:143]
v_mfma_f32_16x16x32_bf16 v[144:147], v[72:75], v[88:91], v[144:147]
v_mfma_f32_16x16x32_bf16 v[148:151], v[76:79], v[88:91], v[148:151]
v_mfma_f32_16x16x32_bf16 v[108:111], v[76:79], v[44:47], v[108:111]
v_mfma_f32_16x16x32_bf16 v[152:155], v[76:79], v[20:23], v[152:155]
s_waitcnt lgkmcnt(0)
s_barrier
v_mfma_f32_16x16x32_bf16 v[4:7], v[112:115], v[52:55], v[4:7]
ds_read_b128 v[8:11], v208 offset:24576
ds_read_b128 v[56:59], v208 offset:25600
v_mfma_f32_16x16x32_bf16 v[64:67], v[112:115], v[84:87], v[64:67]
ds_read_b128 v[68:71], v208 offset:26624
v_mfma_f32_16x16x32_bf16 v[80:83], v[112:115], v[104:107], v[80:83]
ds_read_b64_tr_b16 v[72:73], v214 offset:16384
v_mfma_f32_16x16x32_bf16 v[36:39], v[12:15], v[104:107], v[36:39]
ds_read_b64_tr_b16 v[74:75], v214 offset:18432
v_mfma_f32_16x16x32_bf16 v[92:95], v[12:15], v[84:87], v[92:95]
ds_read_b64_tr_b16 v[20:21], v213 offset:16384
ds_read_b64_tr_b16 v[22:23], v213 offset:18432
v_mfma_f32_16x16x32_bf16 v[100:103], v[12:15], v[52:55], v[100:103]
ds_read_b64_tr_b16 v[44:45], v212 offset:16384
v_mfma_f32_16x16x32_bf16 v[48:51], v[24:27], v[52:55], v[48:51]
ds_read_b64_tr_b16 v[46:47], v212 offset:18432
v_mfma_f32_16x16x32_bf16 v[124:127], v[24:27], v[84:87], v[124:127]
ds_read_b64_tr_b16 v[76:77], v211 offset:16384
v_mfma_f32_16x16x32_bf16 v[128:131], v[24:27], v[104:107], v[128:131]
ds_read_b64_tr_b16 v[78:79], v211 offset:18432
ds_read_b64_tr_b16 v[88:89], v216 offset:8192
v_mfma_f32_16x16x32_bf16 v[132:135], v[28:31], v[104:107], v[132:135]
ds_read_b64_tr_b16 v[90:91], v216 offset:10240
v_mfma_f32_16x16x32_bf16 v[16:19], v[28:31], v[84:87], v[16:19]
ds_read_b64_tr_b16 v[12:13], v215 offset:8192
v_mfma_f32_16x16x32_bf16 v[136:139], v[28:31], v[52:55], v[136:139]
ds_read_b64_tr_b16 v[14:15], v215 offset:10240
v_mfma_f32_16x16x32_bf16 v[60:63], v[32:35], v[52:55], v[60:63]
v_mfma_f32_16x16x32_bf16 v[140:143], v[32:35], v[84:87], v[140:143]
v_mfma_f32_16x16x32_bf16 v[144:147], v[32:35], v[104:107], v[144:147]
v_mfma_f32_16x16x32_bf16 v[148:151], v[40:43], v[104:107], v[148:151]
v_mfma_f32_16x16x32_bf16 v[108:111], v[40:43], v[84:87], v[108:111]
v_mfma_f32_16x16x32_bf16 v[152:155], v[40:43], v[52:55], v[152:155]
s_waitcnt lgkmcnt(0)
v_mfma_f32_16x16x32_bf16 v[4:7], v[72:75], v[8:11], v[4:7]
ds_read_b128 v[24:27], v208 offset:30720
ds_read_b128 v[96:99], v208 offset:31744
v_mfma_f32_16x16x32_bf16 v[64:67], v[72:75], v[56:59], v[64:67]
ds_read_b128 v[28:31], v208 offset:32768
v_mfma_f32_16x16x32_bf16 v[80:83], v[72:75], v[68:71], v[80:83]
ds_read_b64_tr_b16 v[112:113], v220 offset:0
v_mfma_f32_16x16x32_bf16 v[36:39], v[20:23], v[68:71], v[36:39]
ds_read_b64_tr_b16 v[114:115], v220 offset:2048
v_mfma_f32_16x16x32_bf16 v[92:95], v[20:23], v[56:59], v[92:95]
ds_read_b64_tr_b16 v[32:33], v219 offset:0
ds_read_b64_tr_b16 v[34:35], v219 offset:2048
v_mfma_f32_16x16x32_bf16 v[100:103], v[20:23], v[8:11], v[100:103]
ds_read_b64_tr_b16 v[40:41], v218 offset:0
v_mfma_f32_16x16x32_bf16 v[48:51], v[44:47], v[8:11], v[48:51]
ds_read_b64_tr_b16 v[42:43], v218 offset:2048
v_mfma_f32_16x16x32_bf16 v[124:127], v[44:47], v[56:59], v[124:127]
ds_read_b64_tr_b16 v[52:53], v217 offset:0
v_mfma_f32_16x16x32_bf16 v[128:131], v[44:47], v[68:71], v[128:131]
ds_read_b64_tr_b16 v[54:55], v217 offset:2048
ds_read_b64_tr_b16 v[72:73], v216 offset:12288
v_mfma_f32_16x16x32_bf16 v[132:135], v[76:79], v[68:71], v[132:135]
ds_read_b64_tr_b16 v[74:75], v216 offset:14336
v_mfma_f32_16x16x32_bf16 v[16:19], v[76:79], v[56:59], v[16:19]
ds_read_b64_tr_b16 v[20:21], v215 offset:12288
v_mfma_f32_16x16x32_bf16 v[136:139], v[76:79], v[8:11], v[136:139]
ds_read_b64_tr_b16 v[22:23], v215 offset:14336
v_mfma_f32_16x16x32_bf16 v[60:63], v[88:91], v[8:11], v[60:63]
v_mfma_f32_16x16x32_bf16 v[140:143], v[88:91], v[56:59], v[140:143]
v_mfma_f32_16x16x32_bf16 v[144:147], v[88:91], v[68:71], v[144:147]
v_mfma_f32_16x16x32_bf16 v[148:151], v[12:15], v[68:71], v[148:151]
v_mfma_f32_16x16x32_bf16 v[108:111], v[12:15], v[56:59], v[108:111]
v_mfma_f32_16x16x32_bf16 v[152:155], v[12:15], v[8:11], v[152:155]
s_waitcnt lgkmcnt(0)
s_barrier
v_mfma_f32_16x16x32_bf16 v[4:7], v[112:115], v[24:27], v[4:7]
ds_read_b128 v[44:47], v208 offset:36864
v_mfma_f32_16x16x32_bf16 v[64:67], v[112:115], v[96:99], v[64:67]
ds_read_b128 v[76:79], v208 offset:37888
v_mfma_f32_16x16x32_bf16 v[80:83], v[112:115], v[28:31], v[80:83]
ds_read_b128 v[84:87], v208 offset:38912
v_mfma_f32_16x16x32_bf16 v[36:39], v[32:35], v[28:31], v[36:39]
ds_read_b64_tr_b16 v[68:69], v220 offset:16384
v_mfma_f32_16x16x32_bf16 v[92:95], v[32:35], v[96:99], v[92:95]
ds_read_b64_tr_b16 v[70:71], v220 offset:18432
v_mfma_f32_16x16x32_bf16 v[100:103], v[32:35], v[24:27], v[100:103]
ds_read_b64_tr_b16 v[8:9], v219 offset:16384
v_mfma_f32_16x16x32_bf16 v[48:51], v[40:43], v[24:27], v[48:51]
ds_read_b64_tr_b16 v[10:11], v219 offset:18432
v_mfma_f32_16x16x32_bf16 v[124:127], v[40:43], v[96:99], v[124:127]
ds_read_b64_tr_b16 v[12:13], v218 offset:16384
v_mfma_f32_16x16x32_bf16 v[128:131], v[40:43], v[28:31], v[128:131]
ds_read_b64_tr_b16 v[14:15], v218 offset:18432
v_mfma_f32_16x16x32_bf16 v[132:135], v[52:55], v[28:31], v[132:135]
ds_read_b64_tr_b16 v[56:57], v217 offset:16384
v_mfma_f32_16x16x32_bf16 v[16:19], v[52:55], v[96:99], v[16:19]
ds_read_b64_tr_b16 v[58:59], v217 offset:18432
v_mfma_f32_16x16x32_bf16 v[136:139], v[52:55], v[24:27], v[136:139]
v_mfma_f32_16x16x32_bf16 v[60:63], v[72:75], v[24:27], v[60:63]
v_mfma_f32_16x16x32_bf16 v[140:143], v[72:75], v[96:99], v[140:143]
v_mfma_f32_16x16x32_bf16 v[144:147], v[72:75], v[28:31], v[144:147]
v_mfma_f32_16x16x32_bf16 v[148:151], v[20:23], v[28:31], v[148:151]
v_mfma_f32_16x16x32_bf16 v[108:111], v[20:23], v[96:99], v[108:111]
v_mfma_f32_16x16x32_bf16 v[152:155], v[20:23], v[24:27], v[152:155]
s_waitcnt lgkmcnt(0)
v_mfma_f32_16x16x32_bf16 v[4:7], v[68:71], v[44:47], v[4:7]
ds_read_b128 v[32:35], v208 offset:43008
ds_read_b128 v[40:43], v208 offset:44032
v_mfma_f32_16x16x32_bf16 v[64:67], v[68:71], v[76:79], v[64:67]
ds_read_b128 v[52:55], v208 offset:45056
v_mfma_f32_16x16x32_bf16 v[80:83], v[68:71], v[84:87], v[80:83]
ds_read_b64_tr_b16 v[88:89], v220 offset:49152
ds_read_b64_tr_b16 v[90:91], v220 offset:51200
v_mfma_f32_16x16x32_bf16 v[36:39], v[8:11], v[84:87], v[36:39]
ds_read_b64_tr_b16 v[28:29], v219 offset:49152
v_mfma_f32_16x16x32_bf16 v[92:95], v[8:11], v[76:79], v[92:95]
ds_read_b64_tr_b16 v[30:31], v219 offset:51200
v_mfma_f32_16x16x32_bf16 v[100:103], v[8:11], v[44:47], v[100:103]
ds_read_b64_tr_b16 v[20:21], v218 offset:49152
ds_read_b64_tr_b16 v[22:23], v218 offset:51200
v_cvt_pk_bf16_f32 v60, v60, v61
v_cvt_pk_bf16_f32 v61, v62, v63
v_cvt_pk_bf16_f32 v62, v152, v153
v_mfma_f32_16x16x32_bf16 v[48:51], v[12:15], v[44:47], v[48:51]
ds_read_b64_tr_b16 v[24:25], v217 offset:49152
v_cvt_pk_bf16_f32 v63, v154, v155
buffer_store_dwordx4 v[60:63], v254, s[72:75], s89 offen offset:0 sc1
v_mfma_f32_16x16x32_bf16 v[124:127], v[12:15], v[76:79], v[124:127]
ds_read_b64_tr_b16 v[26:27], v217 offset:51200
v_cvt_pk_bf16_f32 v140, v140, v141
v_cvt_pk_bf16_f32 v141, v142, v143
v_mfma_f32_16x16x32_bf16 v[128:131], v[12:15], v[84:87], v[128:131]
v_cvt_pk_bf16_f32 v142, v108, v109
v_cvt_pk_bf16_f32 v143, v110, v111
v_mfma_f32_16x16x32_bf16 v[132:135], v[56:59], v[84:87], v[132:135]
buffer_store_dwordx4 v[140:143], v254, s[72:75], s89 offen offset:256 sc1
v_cvt_pk_bf16_f32 v144, v144, v145
v_mfma_f32_16x16x32_bf16 v[16:19], v[56:59], v[76:79], v[16:19]
v_cvt_pk_bf16_f32 v145, v146, v147
v_cvt_pk_bf16_f32 v146, v148, v149
v_mfma_f32_16x16x32_bf16 v[136:139], v[56:59], v[44:47], v[136:139]
v_cvt_pk_bf16_f32 v147, v150, v151
buffer_store_dwordx4 v[144:147], v254, s[72:75], s89 offen offset:512 sc1
s_waitcnt lgkmcnt(0)
s_barrier
v_mfma_f32_16x16x32_bf16 v[4:7], v[88:91], v[32:35], v[4:7]
ds_read_b128 v[8:11], v208 offset:0
ds_read_b128 v[12:15], v208 offset:1024
v_mfma_f32_16x16x32_bf16 v[64:67], v[88:91], v[40:43], v[64:67]
ds_read_b128 v[60:63], v208 offset:2048
v_mfma_f32_16x16x32_bf16 v[80:83], v[88:91], v[52:55], v[80:83]
ds_read_b64_tr_b16 v[68:69], v220 offset:57344
ds_read_b64_tr_b16 v[70:71], v220 offset:59392
v_mfma_f32_16x16x32_bf16 v[36:39], v[28:31], v[52:55], v[36:39]
ds_read_b64_tr_b16 v[44:45], v219 offset:57344
v_mfma_f32_16x16x32_bf16 v[92:95], v[28:31], v[40:43], v[92:95]
ds_read_b64_tr_b16 v[46:47], v219 offset:59392
v_mfma_f32_16x16x32_bf16 v[100:103], v[28:31], v[32:35], v[100:103]
ds_read_b64_tr_b16 v[56:57], v218 offset:57344
ds_read_b64_tr_b16 v[58:59], v218 offset:59392
v_mfma_f32_16x16x32_bf16 v[48:51], v[20:23], v[32:35], v[48:51]
ds_read_b64_tr_b16 v[72:73], v217 offset:57344
v_mfma_f32_16x16x32_bf16 v[124:127], v[20:23], v[40:43], v[124:127]
ds_read_b64_tr_b16 v[74:75], v217 offset:59392
v_mfma_f32_16x16x32_bf16 v[128:131], v[20:23], v[52:55], v[128:131]
v_mfma_f32_16x16x32_bf16 v[132:135], v[24:27], v[52:55], v[132:135]
v_mfma_f32_16x16x32_bf16 v[16:19], v[24:27], v[40:43], v[16:19]
v_mfma_f32_16x16x32_bf16 v[136:139], v[24:27], v[32:35], v[136:139]
s_waitcnt lgkmcnt(0)
v_mfma_f32_16x16x32_bf16 v[4:7], v[68:71], v[8:11], v[4:7]
ds_read_b128 v[28:31], v208 offset:6144
ds_read_b128 v[76:79], v208 offset:7168
v_mfma_f32_16x16x32_bf16 v[64:67], v[68:71], v[12:15], v[64:67]
ds_read_b128 v[84:87], v208 offset:8192
v_mfma_f32_16x16x32_bf16 v[80:83], v[68:71], v[60:63], v[80:83]
ds_read_b64_tr_b16 v[88:89], v226 offset:0
ds_read_b64_tr_b16 v[90:91], v226 offset:2048
v_mfma_f32_16x16x32_bf16 v[36:39], v[44:47], v[60:63], v[36:39]
ds_read_b64_tr_b16 v[20:21], v225 offset:0
v_mfma_f32_16x16x32_bf16 v[92:95], v[44:47], v[12:15], v[92:95]
ds_read_b64_tr_b16 v[22:23], v225 offset:2048
v_mfma_f32_16x16x32_bf16 v[100:103], v[44:47], v[8:11], v[100:103]
ds_read_b64_tr_b16 v[24:25], v224 offset:0
ds_read_b64_tr_b16 v[26:27], v224 offset:2048
v_mfma_f32_16x16x32_bf16 v[48:51], v[56:59], v[8:11], v[48:51]
ds_read_b64_tr_b16 v[32:33], v223 offset:0
v_mfma_f32_16x16x32_bf16 v[124:127], v[56:59], v[12:15], v[124:127]
ds_read_b64_tr_b16 v[34:35], v223 offset:2048
v_mfma_f32_16x16x32_bf16 v[128:131], v[56:59], v[60:63], v[128:131]
v_mfma_f32_16x16x32_bf16 v[132:135], v[72:75], v[60:63], v[132:135]
v_mfma_f32_16x16x32_bf16 v[16:19], v[72:75], v[12:15], v[16:19]
v_mfma_f32_16x16x32_bf16 v[136:139], v[72:75], v[8:11], v[136:139]
s_waitcnt lgkmcnt(0)
s_barrier
v_mfma_f32_16x16x32_bf16 v[4:7], v[88:91], v[28:31], v[4:7]
ds_read_b128 v[40:43], v208 offset:12288
ds_read_b128 v[44:47], v208 offset:13312
v_mfma_f32_16x16x32_bf16 v[64:67], v[88:91], v[76:79], v[64:67]
ds_read_b128 v[52:55], v208 offset:14336
v_mfma_f32_16x16x32_bf16 v[80:83], v[88:91], v[84:87], v[80:83]
ds_read_b64_tr_b16 v[56:57], v220 offset:24576
ds_read_b64_tr_b16 v[58:59], v220 offset:26624
v_mfma_f32_16x16x32_bf16 v[36:39], v[20:23], v[84:87], v[36:39]
ds_read_b64_tr_b16 v[8:9], v219 offset:24576
v_mfma_f32_16x16x32_bf16 v[92:95], v[20:23], v[76:79], v[92:95]
ds_read_b64_tr_b16 v[10:11], v219 offset:26624
v_mfma_f32_16x16x32_bf16 v[100:103], v[20:23], v[28:31], v[100:103]
ds_read_b64_tr_b16 v[12:13], v218 offset:24576
ds_read_b64_tr_b16 v[14:15], v218 offset:26624
v_mfma_f32_16x16x32_bf16 v[48:51], v[24:27], v[28:31], v[48:51]
ds_read_b64_tr_b16 v[60:61], v217 offset:24576
v_mfma_f32_16x16x32_bf16 v[124:127], v[24:27], v[76:79], v[124:127]
ds_read_b64_tr_b16 v[62:63], v217 offset:26624
v_mfma_f32_16x16x32_bf16 v[128:131], v[24:27], v[84:87], v[128:131]
v_mfma_f32_16x16x32_bf16 v[132:135], v[32:35], v[84:87], v[132:135]
v_mfma_f32_16x16x32_bf16 v[16:19], v[32:35], v[76:79], v[16:19]
v_mfma_f32_16x16x32_bf16 v[136:139], v[32:35], v[28:31], v[136:139]
s_waitcnt lgkmcnt(0)
v_mfma_f32_16x16x32_bf16 v[4:7], v[56:59], v[40:43], v[4:7]
ds_read_b128 v[20:23], v208 offset:18432
ds_read_b128 v[68:71], v208 offset:19456
v_mfma_f32_16x16x32_bf16 v[64:67], v[56:59], v[44:47], v[64:67]
ds_read_b128 v[72:75], v208 offset:20480
v_mfma_f32_16x16x32_bf16 v[80:83], v[56:59], v[52:55], v[80:83]
ds_read_b64_tr_b16 v[88:89], v220 offset:32768
ds_read_b64_tr_b16 v[90:91], v220 offset:34816
v_mfma_f32_16x16x32_bf16 v[36:39], v[8:11], v[52:55], v[36:39]
ds_read_b64_tr_b16 v[24:25], v219 offset:32768
v_mfma_f32_16x16x32_bf16 v[92:95], v[8:11], v[44:47], v[92:95]
ds_read_b64_tr_b16 v[26:27], v219 offset:34816
v_mfma_f32_16x16x32_bf16 v[100:103], v[8:11], v[40:43], v[100:103]
ds_read_b64_tr_b16 v[28:29], v218 offset:32768
ds_read_b64_tr_b16 v[30:31], v218 offset:34816
v_mfma_f32_16x16x32_bf16 v[48:51], v[12:15], v[40:43], v[48:51]
ds_read_b64_tr_b16 v[32:33], v217 offset:32768
v_mfma_f32_16x16x32_bf16 v[124:127], v[12:15], v[44:47], v[124:127]
ds_read_b64_tr_b16 v[34:35], v217 offset:34816
v_mfma_f32_16x16x32_bf16 v[128:131], v[12:15], v[52:55], v[128:131]
v_mfma_f32_16x16x32_bf16 v[132:135], v[60:63], v[52:55], v[132:135]
v_mfma_f32_16x16x32_bf16 v[16:19], v[60:63], v[44:47], v[16:19]
v_mfma_f32_16x16x32_bf16 v[136:139], v[60:63], v[40:43], v[136:139]
s_waitcnt lgkmcnt(0)
s_barrier
v_mfma_f32_16x16x32_bf16 v[4:7], v[88:91], v[20:23], v[4:7]
ds_read_b128 v[8:11], v208 offset:24576
ds_read_b128 v[56:59], v208 offset:25600
v_mfma_f32_16x16x32_bf16 v[64:67], v[88:91], v[68:71], v[64:67]
ds_read_b128 v[76:79], v208 offset:26624
v_mfma_f32_16x16x32_bf16 v[80:83], v[88:91], v[72:75], v[80:83]
ds_read_b64_tr_b16 v[12:13], v220 offset:40960
ds_read_b64_tr_b16 v[14:15], v220 offset:43008
v_mfma_f32_16x16x32_bf16 v[36:39], v[24:27], v[72:75], v[36:39]
ds_read_b64_tr_b16 v[40:41], v219 offset:40960
v_mfma_f32_16x16x32_bf16 v[92:95], v[24:27], v[68:71], v[92:95]
ds_read_b64_tr_b16 v[42:43], v219 offset:43008
v_mfma_f32_16x16x32_bf16 v[100:103], v[24:27], v[20:23], v[100:103]
ds_read_b64_tr_b16 v[44:45], v218 offset:40960
ds_read_b64_tr_b16 v[46:47], v218 offset:43008
v_mfma_f32_16x16x32_bf16 v[48:51], v[28:31], v[20:23], v[48:51]
ds_read_b64_tr_b16 v[52:53], v217 offset:40960
v_mfma_f32_16x16x32_bf16 v[124:127], v[28:31], v[68:71], v[124:127]
ds_read_b64_tr_b16 v[54:55], v217 offset:43008
v_mfma_f32_16x16x32_bf16 v[128:131], v[28:31], v[72:75], v[128:131]
v_mfma_f32_16x16x32_bf16 v[132:135], v[32:35], v[72:75], v[132:135]
v_mfma_f32_16x16x32_bf16 v[16:19], v[32:35], v[68:71], v[16:19]
v_mfma_f32_16x16x32_bf16 v[136:139], v[32:35], v[20:23], v[136:139]
s_waitcnt lgkmcnt(0)
v_mfma_f32_16x16x32_bf16 v[4:7], v[12:15], v[8:11], v[4:7]
ds_read_b128 v[24:27], v208 offset:30720
ds_read_b128 v[60:63], v208 offset:31744
v_mfma_f32_16x16x32_bf16 v[64:67], v[12:15], v[56:59], v[64:67]
ds_read_b128 v[84:87], v208 offset:32768
v_mfma_f32_16x16x32_bf16 v[80:83], v[12:15], v[76:79], v[80:83]
ds_read_b64_tr_b16 v[88:89], v226 offset:8192
ds_read_b64_tr_b16 v[90:91], v226 offset:10240
v_mfma_f32_16x16x32_bf16 v[36:39], v[40:43], v[76:79], v[36:39]
ds_read_b64_tr_b16 v[28:29], v225 offset:8192
v_mfma_f32_16x16x32_bf16 v[92:95], v[40:43], v[56:59], v[92:95]
ds_read_b64_tr_b16 v[30:31], v225 offset:10240
v_mfma_f32_16x16x32_bf16 v[100:103], v[40:43], v[8:11], v[100:103]
ds_read_b64_tr_b16 v[20:21], v224 offset:8192
ds_read_b64_tr_b16 v[22:23], v224 offset:10240
v_mfma_f32_16x16x32_bf16 v[48:51], v[44:47], v[8:11], v[48:51]
ds_read_b64_tr_b16 v[32:33], v223 offset:8192
v_mfma_f32_16x16x32_bf16 v[124:127], v[44:47], v[56:59], v[124:127]
ds_read_b64_tr_b16 v[34:35], v223 offset:10240
v_mfma_f32_16x16x32_bf16 v[128:131], v[44:47], v[76:79], v[128:131]
v_mfma_f32_16x16x32_bf16 v[132:135], v[52:55], v[76:79], v[132:135]
v_mfma_f32_16x16x32_bf16 v[16:19], v[52:55], v[56:59], v[16:19]
v_mfma_f32_16x16x32_bf16 v[136:139], v[52:55], v[8:11], v[136:139]
s_waitcnt lgkmcnt(0)
s_waitcnt vmcnt(0)
s_barrier
v_mfma_f32_16x16x32_bf16 v[4:7], v[88:91], v[24:27], v[4:7]
ds_read_b128 v[12:15], v208 offset:36864
ds_read_b128 v[40:43], v208 offset:37888
v_mfma_f32_16x16x32_bf16 v[64:67], v[88:91], v[60:63], v[64:67]
ds_read_b128 v[68:71], v208 offset:38912
ds_read_b128 v[44:47], v208 offset:43008
v_mfma_f32_16x16x32_bf16 v[80:83], v[88:91], v[84:87], v[80:83]
ds_read_b128 v[56:59], v208 offset:44032
v_mfma_f32_16x16x32_bf16 v[36:39], v[28:31], v[84:87], v[36:39]
ds_read_b128 v[8:11], v208 offset:45056
ds_read_b64_tr_b16 v[52:53], v226 offset:16384
v_mfma_f32_16x16x32_bf16 v[92:95], v[28:31], v[60:63], v[92:95]
ds_read_b64_tr_b16 v[54:55], v226 offset:18432
v_mfma_f32_16x16x32_bf16 v[100:103], v[28:31], v[24:27], v[100:103]
ds_read_b64_tr_b16 v[72:73], v214 offset:0
ds_read_b64_tr_b16 v[74:75], v214 offset:2048
v_mfma_f32_16x16x32_bf16 v[48:51], v[20:23], v[24:27], v[48:51]
ds_read_b64_tr_b16 v[76:77], v225 offset:16384
v_mfma_f32_16x16x32_bf16 v[124:127], v[20:23], v[60:63], v[124:127]
ds_read_b64_tr_b16 v[78:79], v225 offset:18432
ds_read_b64_tr_b16 v[88:89], v213 offset:0
v_mfma_f32_16x16x32_bf16 v[128:131], v[20:23], v[84:87], v[128:131]
ds_read_b64_tr_b16 v[90:91], v213 offset:2048
v_mfma_f32_16x16x32_bf16 v[132:135], v[32:35], v[84:87], v[132:135]
v_mfma_f32_16x16x32_bf16 v[16:19], v[32:35], v[60:63], v[16:19]
v_mfma_f32_16x16x32_bf16 v[136:139], v[32:35], v[24:27], v[136:139]
s_waitcnt lgkmcnt(0)
v_mfma_f32_16x16x32_bf16 v[4:7], v[52:55], v[12:15], v[4:7]
ds_read_b64_tr_b16 v[28:29], v224 offset:16384
ds_read_b64_tr_b16 v[30:31], v224 offset:18432
v_mfma_f32_16x16x32_bf16 v[4:7], v[72:75], v[44:47], v[4:7]
ds_read_b64_tr_b16 v[96:97], v212 offset:0
v_mfma_f32_16x16x32_bf16 v[100:103], v[76:79], v[12:15], v[100:103]
ds_read_b64_tr_b16 v[98:99], v212 offset:2048
v_mfma_f32_16x16x32_bf16 v[100:103], v[88:91], v[44:47], v[100:103]
ds_read_b64_tr_b16 v[20:21], v223 offset:16384
ds_read_b64_tr_b16 v[22:23], v223 offset:18432
v_mfma_f32_16x16x32_bf16 v[64:67], v[52:55], v[40:43], v[64:67]
ds_read_b64_tr_b16 v[24:25], v211 offset:0
v_mfma_f32_16x16x32_bf16 v[64:67], v[72:75], v[56:59], v[64:67]
ds_read_b64_tr_b16 v[26:27], v211 offset:2048
v_mfma_f32_16x16x32_bf16 v[92:95], v[76:79], v[40:43], v[92:95]
v_cvt_pk_bf16_f32 v4, v4, v5
v_cvt_pk_bf16_f32 v5, v6, v7
v_mfma_f32_16x16x32_bf16 v[92:95], v[88:91], v[56:59], v[92:95]
v_cvt_pk_bf16_f32 v6, v100, v101
v_mfma_f32_16x16x32_bf16 v[80:83], v[52:55], v[68:71], v[80:83]
v_cvt_pk_bf16_f32 v7, v102, v103
v_mfma_f32_16x16x32_bf16 v[80:83], v[72:75], v[8:11], v[80:83]
buffer_store_dwordx4 v[4:7], v204, s[72:75], s82 offen offset:0 sc1
v_mfma_f32_16x16x32_bf16 v[36:39], v[76:79], v[68:71], v[36:39]
v_cvt_pk_bf16_f32 v64, v64, v65
v_cvt_pk_bf16_f32 v65, v66, v67
v_mfma_f32_16x16x32_bf16 v[36:39], v[88:91], v[8:11], v[36:39]
v_cvt_pk_bf16_f32 v66, v92, v93
s_waitcnt lgkmcnt(6)
v_mfma_f32_16x16x32_bf16 v[48:51], v[28:31], v[12:15], v[48:51]
v_cvt_pk_bf16_f32 v67, v94, v95
s_waitcnt lgkmcnt(4)
v_mfma_f32_16x16x32_bf16 v[48:51], v[96:99], v[44:47], v[48:51]
buffer_store_dwordx4 v[64:67], v204, s[72:75], s82 offen offset:256 sc1
s_waitcnt lgkmcnt(2)
v_mfma_f32_16x16x32_bf16 v[136:139], v[20:23], v[12:15], v[136:139]
v_cvt_pk_bf16_f32 v80, v80, v81
v_cvt_pk_bf16_f32 v81, v82, v83
s_waitcnt lgkmcnt(0)
v_mfma_f32_16x16x32_bf16 v[136:139], v[24:27], v[44:47], v[136:139]
v_cvt_pk_bf16_f32 v82, v36, v37
v_mfma_f32_16x16x32_bf16 v[124:127], v[28:31], v[40:43], v[124:127]
v_cvt_pk_bf16_f32 v83, v38, v39
v_mfma_f32_16x16x32_bf16 v[124:127], v[96:99], v[56:59], v[124:127]
buffer_store_dwordx4 v[80:83], v204, s[72:75], s82 offen offset:512 sc1
v_mfma_f32_16x16x32_bf16 v[16:19], v[20:23], v[40:43], v[16:19]
v_cvt_pk_bf16_f32 v48, v48, v49
v_cvt_pk_bf16_f32 v49, v50, v51
v_mfma_f32_16x16x32_bf16 v[16:19], v[24:27], v[56:59], v[16:19]
v_cvt_pk_bf16_f32 v50, v136, v137
v_mfma_f32_16x16x32_bf16 v[128:131], v[28:31], v[68:71], v[128:131]
v_cvt_pk_bf16_f32 v51, v138, v139
v_mfma_f32_16x16x32_bf16 v[128:131], v[96:99], v[8:11], v[128:131]
buffer_store_dwordx4 v[48:51], v204, s[72:75], s82 offen offset:768 sc1
v_cvt_pk_bf16_f32 v124, v124, v125
v_cvt_pk_bf16_f32 v125, v126, v127
v_mfma_f32_16x16x32_bf16 v[132:135], v[20:23], v[68:71], v[132:135]
v_cvt_pk_bf16_f32 v126, v16, v17
v_cvt_pk_bf16_f32 v127, v18, v19
v_mfma_f32_16x16x32_bf16 v[132:135], v[24:27], v[8:11], v[132:135]
buffer_store_dwordx4 v[124:127], v204, s[72:75], s82 offen offset:1024 sc1
v_cvt_pk_bf16_f32 v128, v128, v129
v_cvt_pk_bf16_f32 v129, v130, v131
s_nop 4
v_cvt_pk_bf16_f32 v130, v132, v133
v_cvt_pk_bf16_f32 v131, v134, v135
buffer_store_dwordx4 v[128:131], v204, s[72:75], s82 offen offset:1280 sc1
s_mov_b32 s15, 1
s_waitcnt vmcnt(0)
s_atomic_add s15, s[76:77], s86
s_atomic_add s15, s[76:77], s87
s_atomic_add s15, s[76:77], s88
s_mov_b64 exec, s[84:85]
ds_write_b128 v205, v[4:7] offset:0
ds_write_b128 v205, v[64:67] offset:256
ds_write_b128 v205, v[80:83] offset:512
ds_write_b128 v205, v[48:51] offset:768
ds_write_b128 v205, v[124:127] offset:1024
ds_write_b128 v205, v[128:131] offset:1280
s_mov_b64 exec, -1
s_waitcnt lgkmcnt(0)
s_barrier
ds_read_b64 v[8:9], v206 offset:0
ds_read_b64 v[10:11], v206 offset:64
ds_read_b64 v[12:13], v206 offset:1536
ds_read_b64 v[14:15], v206 offset:1600
ds_read_b64 v[4:5], v206 offset:3072
ds_read_b64 v[6:7], v206 offset:3136
ds_read_b64 v[16:17], v206 offset:4608
ds_read_b64 v[18:19], v206 offset:4672
s_waitcnt lgkmcnt(7)
v_lshlrev_b32 v20, 16, v8
v_and_b32 v21, 0xffff0000, v8
v_lshlrev_b32 v22, 16, v9
v_and_b32 v23, 0xffff0000, v9
s_waitcnt lgkmcnt(6)
v_lshlrev_b32 v24, 16, v10
v_and_b32 v25, 0xffff0000, v10
v_lshlrev_b32 v26, 16, v11
v_and_b32 v27, 0xffff0000, v11
s_waitcnt lgkmcnt(5)
v_lshlrev_b32 v28, 16, v12
v_and_b32 v29, 0xffff0000, v12
v_lshlrev_b32 v30, 16, v13
v_and_b32 v31, 0xffff0000, v13
s_waitcnt lgkmcnt(4)
v_lshlrev_b32 v32, 16, v14
v_and_b32 v33, 0xffff0000, v14
v_lshlrev_b32 v34, 16, v15
v_and_b32 v35, 0xffff0000, v15
v_pk_add_f32 v[20:21], v[20:21], v[28:29]
v_pk_add_f32 v[22:23], v[22:23], v[30:31]
v_pk_add_f32 v[24:25], v[24:25], v[32:33]
v_pk_add_f32 v[26:27], v[26:27], v[34:35]
s_waitcnt lgkmcnt(3)
v_lshlrev_b32 v28, 16, v4
v_and_b32 v29, 0xffff0000, v4
v_lshlrev_b32 v30, 16, v5
v_and_b32 v31, 0xffff0000, v5
s_waitcnt lgkmcnt(2)
v_lshlrev_b32 v32, 16, v6
v_and_b32 v33, 0xffff0000, v6
v_lshlrev_b32 v34, 16, v7
v_and_b32 v35, 0xffff0000, v7
v_pk_add_f32 v[20:21], v[20:21], v[28:29]
v_pk_add_f32 v[22:23], v[22:23], v[30:31]
v_pk_add_f32 v[24:25], v[24:25], v[32:33]
v_pk_add_f32 v[26:27], v[26:27], v[34:35]
s_waitcnt lgkmcnt(1)
v_lshlrev_b32 v28, 16, v16
v_and_b32 v29, 0xffff0000, v16
v_lshlrev_b32 v30, 16, v17
v_and_b32 v31, 0xffff0000, v17
s_waitcnt lgkmcnt(0)
v_lshlrev_b32 v32, 16, v18
v_and_b32 v33, 0xffff0000, v18
v_lshlrev_b32 v34, 16, v19
v_and_b32 v35, 0xffff0000, v19
v_pk_add_f32 v[20:21], v[20:21], v[28:29]
v_pk_add_f32 v[22:23], v[22:23], v[30:31]
v_pk_add_f32 v[24:25], v[24:25], v[32:33]
v_pk_add_f32 v[26:27], v[26:27], v[34:35]
v_cvt_pk_bf16_f32 v20, v20, v21
v_cvt_pk_bf16_f32 v21, v22, v23
v_cvt_pk_bf16_f32 v22, v24, v25
v_cvt_pk_bf16_f32 v23, v26, v27
buffer_store_dwordx4 v[20:23], v255, s[64:67], 0 offen offset:0 sc1
s_endpgm
L_code_end:
s_endpgm
.section .rodata,"a"
.p2align 6
.amdhsa_kernel concat_heads__mha_block_cached__gqa_block_cached__near_ridge_kernel
  .amdhsa_next_free_vgpr 256
  .amdhsa_next_free_sgpr 102
  .amdhsa_accum_offset 256
  .amdhsa_group_segment_fixed_size 0
  .amdhsa_kernarg_size 104
  .amdhsa_user_sgpr_count 2
  .amdhsa_user_sgpr_kernarg_segment_ptr 1
  .amdhsa_system_sgpr_workgroup_id_x 1
.end_amdhsa_kernel
```
